```python
import torch

def _softmax(x, axis=-1):
    return torch.softmax(x, dim=axis)
def _gelu(x):
    return torch.nn.functional.gelu(x, approximate="tanh")
def _silu(x):
    return torch.nn.functional.silu(x)
def _sigmoid(x):
    return torch.sigmoid(x)
def _layernorm(x, axis=-1, eps=1e-5):
    m = x.mean(dim=axis, keepdim=True)
    v = x.var(dim=axis, keepdim=True, unbiased=False)
    return (x - m) / torch.sqrt(v + eps)
def _scatter_add(tgt, idx, src, axis=0):
    return tgt.clone().index_add_(axis, idx, src)
def _segment_sum(src, seg, n):
    out = torch.zeros((n,) + src.shape[1:], dtype=src.dtype)
    return out.index_add_(0, seg, src)
def _pad(x, pw):
    flat = tuple(v for pair in reversed(pw) for v in pair)
    return torch.nn.functional.pad(x, flat)

kernel_name = 'sequential_preLN__grouped_kv_mqa__moe_arch_mod__prompt'

def setup_inputs():

    _w = (lambda a: (lambda t: t.to(torch.bfloat16) if t.is_floating_point() else t)(torch.as_tensor(a)))
    def _A_setup():
        B, S, D, H = 1, 2048, 576, 32
        Dh = D // H
        return {
            "x": _w((lambda *s: torch.randn(*s, dtype=torch.bfloat16) * 0.05)(B, S, D)),
            "wq": _w((lambda *s: torch.randn(*s, dtype=torch.bfloat16) * 0.05)(D, H * Dh)),
            "wk": _w((lambda *s: torch.randn(*s, dtype=torch.bfloat16) * 0.05)(D, Dh)),
            "wv": _w((lambda *s: torch.randn(*s, dtype=torch.bfloat16) * 0.05)(D, Dh)),
            "wo": _w((lambda *s: torch.randn(*s, dtype=torch.bfloat16) * 0.05)(H * Dh, D)),
        }
    _A_in = _A_setup()

    def _B_setup():
        B, S, D, F, C = 1, 2048, 576, 4608, 1
        return {
            "x": _w((lambda *s: torch.randn(*s, dtype=torch.bfloat16) * 0.05)(B, S, D)),
            "w_r": _w((lambda *s: torch.randn(*s, dtype=torch.bfloat16) * 0.05)(D)),
            "w_gate": _w((lambda *s: torch.randn(*s, dtype=torch.bfloat16) * 0.05)(D, F)),
            "w_up": _w((lambda *s: torch.randn(*s, dtype=torch.bfloat16) * 0.05)(D, F)),
            "w_down": _w((lambda *s: torch.randn(*s, dtype=torch.bfloat16) * 0.05)(F, D)),
        }
    _B_in = _B_setup()

    return {
        "A_x": _A_in["x"],
        "A_wq": _A_in["wq"],
        "A_wk": _A_in["wk"],
        "A_wv": _A_in["wv"],
        "A_wo": _A_in["wo"],
        "B_x": _B_in["x"],
        "B_w_r": _B_in["w_r"],
        "B_w_gate": _B_in["w_gate"],
        "B_w_up": _B_in["w_up"],
        "B_w_down": _B_in["w_down"],
    }

def reference(A_x, A_wq, A_wk, A_wv, A_wo, B_x, B_w_r, B_w_gate, B_w_up, B_w_down):
    def _A_ref(x, wq, wk, wv, wo):
        B, S, D = x.shape
        H = 32
        Dh = D // H
        q = (lambda x, *d: x.permute(*d))((x @ wq).reshape(B, S, H, Dh), 0, 2, 1, 3)
        k = x @ wk
        v = x @ wv
        scores = torch.einsum("bhqd,bkd->bhqk", q, k) * (Dh ** -0.5)
        p = _softmax(scores, axis=-1)
        o = torch.einsum("bhqk,bkd->bhqd", p, v)
        return (lambda x, *d: x.permute(*d))(o, 0, 2, 1, 3).reshape(B, S, H * Dh) @ wo

    def _B_ref(x, w_r, w_gate, w_up, w_down):
        B, S, D = x.shape
        C = 1
        r = x @ w_r
        idx = torch.argsort(-r, axis=-1)[:, :C]
        idx_e = (lambda x, n, axis: torch.repeat_interleave(x, n, dim=axis))(idx.reshape(B, C, 1), D, axis=2)
        x_sel = (lambda x, i, axis: torch.take_along_dim(x, i, dim=axis))(x, idx_e, axis=1)
        g = _silu(x_sel @ w_gate)
        u = x_sel @ w_up
        y = (g * u) @ w_down
        r_sel = _sigmoid((lambda x, i, axis: torch.take_along_dim(x, i, dim=axis))(r, idx, axis=1))
        y = y * r_sel.reshape(B, C, 1)
        b_off = (torch.arange(B) * S).reshape(B, 1)
        flat_idx = (idx + b_off).reshape(B * C)
        zero = (x * 0.0).reshape(B * S, D)
        upd = _scatter_add(zero, flat_idx, y.reshape(B * C, D), axis=0)
        return x + upd.reshape(B, S, D)

    x = A_x
    h = x + _A_ref(_layernorm(x, axis=-1), A_wq, A_wk, A_wv, A_wo)
    h2 = h + _B_ref(_layernorm(h, axis=-1), B_w_r, B_w_gate, B_w_up, B_w_down)
    return h2
```

```asm
; @launch grid=(256,1,1) block=(512,1,1) lds=162816
.amdgcn_target "amdgcn-amd-amdhsa--gfx950"
.text
.globl sequential_preLN__grouped_kv_mqa__moe_arch_mod__prompt_kernel
.p2align 8
.type sequential_preLN__grouped_kv_mqa__moe_arch_mod__prompt_kernel,@function
sequential_preLN__grouped_kv_mqa__moe_arch_mod__prompt_kernel:
L_entry:
    s_cmp_ge_u32 s2, 256
    s_cbranch_scc1 L_k2_exit
    s_load_dwordx2 s[28:29], s[0:1], 0
    s_load_dwordx2 s[60:61], s[0:1], 8
    s_load_dwordx4 s[8:11], s[0:1], 16
    s_load_dwordx2 s[12:13], s[0:1], 32
    s_load_dwordx4 s[4:7], s[0:1], 88
    s_mov_b32 s30, 2360448
    s_mov_b32 s31, 0x20000
    s_mov_b32 s62, 663552
    s_mov_b32 s63, 0x20000
    v_lshrrev_b32 v2, 6, v0
    v_and_b32 v1, 63, v0
    s_and_b32 s20, s2, 7
    v_readfirstlane_b32 s16, v2
    s_lshr_b32 s21, s2, 3
    s_cmp_lt_u32 s16, 4
    s_cbranch_scc1 L_older
    s_setprio 1
L_older:
    s_mul_i32 s22, s20, 29
    s_mul_i32 s23, s20, 3
    s_cmp_eq_u32 s20, 7
    s_cselect_b32 s24, 1, 0
    s_add_u32 s22, s22, s24
    s_sub_u32 s23, s23, s24
    s_cmp_ge_u32 s20, 6
    s_cselect_b32 s24, 30, 29
    s_cmp_ge_u32 s21, s24
    s_cbranch_scc1 L_k1_kv
    s_add_u32 s26, s22, s21
    s_mul_i32 s17, s26, 57
    s_lshr_b32 s17, s17, 9
    s_mul_i32 s18, s17, 9
    s_sub_u32 s18, s26, s18
    v_lshrrev_b32 v9, 3, v1
    v_and_b32 v10, 7, v1
    v_mul_u32_u24 v5, 1152, v9
    s_and_b32 s24, s16, 1
    s_lshl_b32 s25, s24, 2
    v_and_b32 v11, 2, v9
    v_xor_b32 v11, v11, v10
    v_xor_b32 v11, s25, v11
    v_lshl_add_u32 v6, v11, 4, v5
    v_lshrrev_b32 v11, 1, v9
    v_xor_b32 v11, v11, v10
    v_xor_b32 v11, s25, v11
    v_lshl_add_u32 v7, v11, 4, v5
    s_mul_i32 s20, s17, 79
    s_lshl_b32 s23, s16, 3
    s_add_u32 s23, s23, s20
    s_add_u32 s23, s23, 1
    s_mul_i32 s23, s23, 1152
    s_mul_i32 s27, s16, 9216
    s_lshl_b32 s44, s18, 7
    s_add_u32 s27, s27, s44
    s_lshl_b32 s21, s16, 10
    s_lshr_b32 s56, s16, 1
    s_mul_i32 s56, s56, 18432
    s_lshl_b32 s24, s24, 10
    s_add_u32 s56, s56, s24
    s_add_u32 s56, s56, 65536
    s_mul_i32 s57, s18, 4
    s_lshr_b32 s57, s57, 4
    s_mul_i32 s57, s57, 4
    s_mul_i32 s19, s17, 1
    s_add_u32 s19, s19, s57
    s_mul_i32 s57, s19, 57
    s_lshr_b32 s57, s57, 9
    s_mul_i32 s57, s57, 9
    s_sub_u32 s19, s19, s57
    s_lshl_b32 s57, s19, 7
    s_add_u32 s23, s23, s57
    s_mul_i32 s22, s19, 73728
    s_add_u32 s27, s27, s22
    s_sub_u32 s19, 9, s19
    s_cmp_ge_u32 s16, 4
    s_cbranch_scc1 L_k1_qs
    s_setprio 3
    s_waitcnt lgkmcnt(0)
    s_sub_u32 s28, s28, 1152
    s_subb_u32 s29, s29, 0
    s_add_u32 m0, s56, 0
    s_nop 0
    buffer_load_dwordx4 v7, s[28:31], s23 offen offset:0 lds
    s_add_u32 m0, s21, 0
    s_nop 0
    buffer_load_dwordx4 v6, s[60:63], s27 offen lds
    s_add_u32 s27, s27, 73728
    s_cmp_eq_u32 s19, 1
    s_cselect_b32 s22, 663552, 0
    s_sub_u32 s27, s27, s22
    s_cmp_lg_u32 s16, 0
    s_cbranch_scc1 L_nopf1
    s_getpc_b64 s[36:37]
L_pf1:
    s_sub_u32 s36, s36, L_pf1 - L_entry
    s_subb_u32 s37, s37, 0
    s_lshr_b32 s38, s2, 3
    s_mul_i32 s38, s38, ((L_slow - L_entry + 4095) / 4096) * 128
    v_lshl_add_u32 v2, v1, 7, s38
    s_bfm_b64 exec, (L_slow - L_entry + 4095) / 4096, 0
    global_load_dword v83, v2, s[36:37]
    s_mov_b64 exec, -1
L_nopf1:
    s_setprio 2
    s_add_u32 m0, s21, 8192
    s_nop 0
    buffer_load_dwordx4 v6, s[60:63], s27 offen lds
    s_add_u32 s27, s27, 73728
    s_cmp_eq_u32 s19, 2
    s_cselect_b32 s22, 663552, 0
    s_sub_u32 s27, s27, s22
    s_cmp_eq_u32 s19, 1
    s_cselect_b32 s22, 1152, 0
    s_sub_u32 s23, s23, s22
    s_add_u32 m0, s56, 1920
    s_nop 0
    buffer_load_dwordx4 v7, s[28:31], s23 offen offset:128 lds
    s_cmp_eq_u32 s19, 2
    s_cselect_b32 s22, 1152, 0
    s_sub_u32 s23, s23, s22
    s_add_u32 m0, s56, 3840
    s_nop 0
    buffer_load_dwordx4 v7, s[28:31], s23 offen offset:256 lds
    s_setprio 0
    v_and_b32 v2, 15, v1
    v_lshrrev_b32 v3, 4, v1
    s_lshr_b32 s46, s16, 1
    s_mul_i32 s47, s46, 36864
    s_add_u32 s47, s47, 65536
    s_and_b32 s45, s16, 1
    s_lshl_b32 s45, s45, 6
    v_lshrrev_b32 v11, 1, v2
    v_xor_b32 v11, v11, v3
    v_lshlrev_b32 v11, 4, v11
    v_lshl_add_u32 v11, v2, 7, v11
    v_add_u32 v34, s47, v11
    v_xor_b32 v35, 64, v34
    v_bfe_u32 v12, v1, 2, 2
    v_and_b32 v13, 3, v1
    v_lshl_add_u32 v9, v3, 3, v12
    v_lshlrev_b32 v9, 7, v9
    v_lshl_add_u32 v9, v13, 3, v9
    v_lshrrev_b32 v10, 1, v12
    v_and_b32 v11, 1, v3
    v_lshl_add_u32 v10, v11, 1, v10
    v_lshl_add_u32 v32, v10, 5, v9
    v_xor_b32 v32, s45, v32
    v_xor_b32 v33, 32, v32
    s_lshl_b32 s46, s46, 5
    v_add_u32 v4, s46, v2
    v_mul_u32_u24 v5, 144, v4
    v_lshl_add_u32 v5, v3, 3, v5
    v_add_u32 v5, s45, v5
    s_lshl_b32 s45, s45, 1
    s_add_u32 s45, s45, 161920
    v_lshl_add_u32 v14, v3, 4, s45
    s_lshl_b32 s46, s46, 3
    s_add_u32 s46, s46, 162176
    v_lshl_add_u32 v15, v2, 3, s46
    s_add_u32 m0, s21, 16384
    s_nop 0
    buffer_load_dwordx4 v6, s[60:63], s27 offen lds
    s_add_u32 s27, s27, 73728
    s_cmp_eq_u32 s19, 3
    s_cselect_b32 s22, 663552, 0
    s_sub_u32 s27, s27, s22
    s_cmp_eq_u32 s19, 3
    s_cselect_b32 s22, 1152, 0
    s_sub_u32 s23, s23, s22
    s_add_u32 m0, s56, 5760
    s_nop 0
    buffer_load_dwordx4 v7, s[28:31], s23 offen offset:384 lds
    s_cmp_eq_u32 s19, 4
    s_cselect_b32 s22, 1152, 0
    s_sub_u32 s23, s23, s22
    s_add_u32 m0, s56, 7680
    s_nop 0
    buffer_load_dwordx4 v7, s[28:31], s23 offen offset:512 lds
    s_waitcnt vmcnt(6)
    s_barrier
    ds_read_b128 a[24:27], v34 offset:0
    ds_read_b64_tr_b16 a[0:1], v32 offset:0
    ds_read_b64_tr_b16 a[2:3], v32 offset:512
    ds_read_b128 a[28:31], v34 offset:18432
    ds_read_b64_tr_b16 a[4:5], v33 offset:0
    ds_read_b64_tr_b16 a[6:7], v33 offset:512
    s_add_u32 m0, s21, 24576
    s_nop 0
    buffer_load_dwordx4 v6, s[60:63], s27 offen lds
    s_add_u32 s27, s27, 73728
    s_cmp_eq_u32 s19, 4
    s_cselect_b32 s22, 663552, 0
    s_sub_u32 s27, s27, s22
    s_cmp_eq_u32 s19, 5
    s_cselect_b32 s22, 1152, 0
    s_sub_u32 s23, s23, s22
    s_add_u32 m0, s56, 9600
    s_nop 0
    buffer_load_dwordx4 v7, s[28:31], s23 offen offset:640 lds
    ds_read_b128 a[32:35], v35 offset:0
    ds_read_b64_tr_b16 a[8:9], v32 offset:4096
    ds_read_b64_tr_b16 a[10:11], v32 offset:4608
    ds_read_b128 a[36:39], v35 offset:18432
    ds_read_b64_tr_b16 a[12:13], v33 offset:4096
    ds_read_b64_tr_b16 a[14:15], v33 offset:4608
    s_waitcnt vmcnt(5)
    s_barrier
    s_waitcnt lgkmcnt(9)
    v_mfma_f32_16x16x32_bf16 v[16:19], a[0:3], a[24:27], 0
    ds_read_b128 a[40:43], v34 offset:2048
    ds_read_b64_tr_b16 a[16:17], v32 offset:8192
    s_waitcnt lgkmcnt(10)
    v_mfma_f32_16x16x32_bf16 v[24:27], a[0:3], a[28:31], 0
    ds_read_b64_tr_b16 a[18:19], v32 offset:8704
    ds_read_b128 a[44:47], v34 offset:20480
    s_waitcnt lgkmcnt(10)
    v_mfma_f32_16x16x32_bf16 v[20:23], a[4:7], a[24:27], 0
    ds_read_b64_tr_b16 a[20:21], v33 offset:8192
    ds_read_b64_tr_b16 a[22:23], v33 offset:8704
    v_mfma_f32_16x16x32_bf16 v[28:31], a[4:7], a[28:31], 0
    s_add_u32 m0, s21, 32768
    s_nop 0
    buffer_load_dwordx4 v6, s[60:63], s27 offen lds
    s_add_u32 s27, s27, 73728
    s_cmp_eq_u32 s19, 5
    s_cselect_b32 s22, 663552, 0
    s_sub_u32 s27, s27, s22
    s_cmp_eq_u32 s19, 6
    s_cselect_b32 s22, 1152, 0
    s_sub_u32 s23, s23, s22
    s_add_u32 m0, s56, 11520
    s_nop 0
    buffer_load_dwordx4 v7, s[28:31], s23 offen offset:768 lds
    s_waitcnt lgkmcnt(9)
    v_mfma_f32_16x16x32_bf16 v[16:19], a[8:11], a[32:35], v[16:19]
    ds_read_b128 a[24:27], v35 offset:2048
    s_waitcnt lgkmcnt(9)
    v_mfma_f32_16x16x32_bf16 v[24:27], a[8:11], a[36:39], v[24:27]
    ds_read_b64_tr_b16 a[0:1], v32 offset:12288
    ds_read_b64_tr_b16 a[2:3], v32 offset:12800
    s_waitcnt lgkmcnt(9)
    v_mfma_f32_16x16x32_bf16 v[20:23], a[12:15], a[32:35], v[20:23]
    ds_read_b128 a[28:31], v35 offset:20480
    v_mfma_f32_16x16x32_bf16 v[28:31], a[12:15], a[36:39], v[28:31]
    ds_read_b64_tr_b16 a[4:5], v33 offset:12288
    ds_read_b64_tr_b16 a[6:7], v33 offset:12800
    s_waitcnt vmcnt(4)
    s_barrier
    s_waitcnt lgkmcnt(9)
    v_mfma_f32_16x16x32_bf16 v[16:19], a[16:19], a[40:43], v[16:19]
    ds_read_b128 a[32:35], v34 offset:4096
    ds_read_b64_tr_b16 a[8:9], v32 offset:16384
    s_waitcnt lgkmcnt(10)
    v_mfma_f32_16x16x32_bf16 v[24:27], a[16:19], a[44:47], v[24:27]
    ds_read_b64_tr_b16 a[10:11], v32 offset:16896
    ds_read_b128 a[36:39], v34 offset:22528
    s_waitcnt lgkmcnt(10)
    v_mfma_f32_16x16x32_bf16 v[20:23], a[20:23], a[40:43], v[20:23]
    ds_read_b64_tr_b16 a[12:13], v33 offset:16384
    ds_read_b64_tr_b16 a[14:15], v33 offset:16896
    v_mfma_f32_16x16x32_bf16 v[28:31], a[20:23], a[44:47], v[28:31]
    s_add_u32 m0, s21, 40960
    s_nop 0
    buffer_load_dwordx4 v6, s[60:63], s27 offen lds
    s_add_u32 s27, s27, 73728
    s_cmp_eq_u32 s19, 6
    s_cselect_b32 s22, 663552, 0
    s_sub_u32 s27, s27, s22
    s_cmp_eq_u32 s19, 7
    s_cselect_b32 s22, 1152, 0
    s_sub_u32 s23, s23, s22
    s_add_u32 m0, s56, 13440
    s_nop 0
    buffer_load_dwordx4 v7, s[28:31], s23 offen offset:896 lds
    s_waitcnt lgkmcnt(9)
    v_mfma_f32_16x16x32_bf16 v[16:19], a[0:3], a[24:27], v[16:19]
    ds_read_b128 a[40:43], v35 offset:4096
    s_waitcnt lgkmcnt(9)
    v_mfma_f32_16x16x32_bf16 v[24:27], a[0:3], a[28:31], v[24:27]
    ds_read_b64_tr_b16 a[16:17], v32 offset:20480
    ds_read_b64_tr_b16 a[18:19], v32 offset:20992
    s_waitcnt lgkmcnt(9)
    v_mfma_f32_16x16x32_bf16 v[20:23], a[4:7], a[24:27], v[20:23]
    ds_read_b128 a[44:47], v35 offset:22528
    v_mfma_f32_16x16x32_bf16 v[28:31], a[4:7], a[28:31], v[28:31]
    ds_read_b64_tr_b16 a[20:21], v33 offset:20480
    ds_read_b64_tr_b16 a[22:23], v33 offset:20992
    s_waitcnt vmcnt(4)
    s_barrier
    s_waitcnt lgkmcnt(9)
    v_mfma_f32_16x16x32_bf16 v[16:19], a[8:11], a[32:35], v[16:19]
    ds_read_b128 a[24:27], v34 offset:6144
    ds_read_b64_tr_b16 a[0:1], v32 offset:24576
    s_waitcnt lgkmcnt(10)
    v_mfma_f32_16x16x32_bf16 v[24:27], a[8:11], a[36:39], v[24:27]
    ds_read_b64_tr_b16 a[2:3], v32 offset:25088
    ds_read_b128 a[28:31], v34 offset:24576
    s_waitcnt lgkmcnt(10)
    v_mfma_f32_16x16x32_bf16 v[20:23], a[12:15], a[32:35], v[20:23]
    ds_read_b64_tr_b16 a[4:5], v33 offset:24576
    ds_read_b64_tr_b16 a[6:7], v33 offset:25088
    v_mfma_f32_16x16x32_bf16 v[28:31], a[12:15], a[36:39], v[28:31]
    s_add_u32 m0, s21, 49152
    s_nop 0
    buffer_load_dwordx4 v6, s[60:63], s27 offen lds
    s_add_u32 s27, s27, 73728
    s_cmp_eq_u32 s19, 7
    s_cselect_b32 s22, 663552, 0
    s_sub_u32 s27, s27, s22
    s_cmp_eq_u32 s19, 8
    s_cselect_b32 s22, 1152, 0
    s_sub_u32 s23, s23, s22
    s_add_u32 m0, s56, 15360
    s_nop 0
    buffer_load_dwordx4 v7, s[28:31], s23 offen offset:1024 lds
    s_waitcnt lgkmcnt(9)
    v_mfma_f32_16x16x32_bf16 v[16:19], a[16:19], a[40:43], v[16:19]
    ds_read_b128 a[32:35], v35 offset:6144
    s_waitcnt lgkmcnt(9)
    v_mfma_f32_16x16x32_bf16 v[24:27], a[16:19], a[44:47], v[24:27]
    ds_read_b64_tr_b16 a[8:9], v32 offset:28672
    ds_read_b64_tr_b16 a[10:11], v32 offset:29184
    s_waitcnt lgkmcnt(9)
    v_mfma_f32_16x16x32_bf16 v[20:23], a[20:23], a[40:43], v[20:23]
    ds_read_b128 a[36:39], v35 offset:24576
    v_mfma_f32_16x16x32_bf16 v[28:31], a[20:23], a[44:47], v[28:31]
    ds_read_b64_tr_b16 a[12:13], v33 offset:28672
    ds_read_b64_tr_b16 a[14:15], v33 offset:29184
    s_waitcnt vmcnt(4)
    s_barrier
    s_waitcnt lgkmcnt(9)
    v_mfma_f32_16x16x32_bf16 v[16:19], a[0:3], a[24:27], v[16:19]
    ds_read_b128 a[40:43], v34 offset:8192
    s_waitcnt lgkmcnt(9)
    v_mfma_f32_16x16x32_bf16 v[24:27], a[0:3], a[28:31], v[24:27]
    ds_read_b64_tr_b16 a[16:17], v32 offset:32768
    ds_read_b64_tr_b16 a[18:19], v32 offset:33280
    s_waitcnt lgkmcnt(9)
    v_mfma_f32_16x16x32_bf16 v[20:23], a[4:7], a[24:27], v[20:23]
    ds_read_b128 a[44:47], v34 offset:26624
    ds_read_b64_tr_b16 a[20:21], v33 offset:32768
    v_mfma_f32_16x16x32_bf16 v[28:31], a[4:7], a[28:31], v[28:31]
    ds_read_b64_tr_b16 a[22:23], v33 offset:33280
    s_add_u32 m0, s21, 57344
    s_nop 0
    buffer_load_dwordx4 v6, s[60:63], s27 offen lds
    s_add_u32 s27, s27, 73728
    s_cmp_eq_u32 s19, 8
    s_cselect_b32 s22, 663552, 0
    s_sub_u32 s27, s27, s22
    s_waitcnt lgkmcnt(9)
    v_mfma_f32_16x16x32_bf16 v[16:19], a[8:11], a[32:35], v[16:19]
    ds_read_b128 a[24:27], v35 offset:8192
    s_waitcnt lgkmcnt(9)
    v_mfma_f32_16x16x32_bf16 v[24:27], a[8:11], a[36:39], v[24:27]
    ds_read_b64_tr_b16 a[0:1], v32 offset:36864
    ds_read_b64_tr_b16 a[2:3], v32 offset:37376
    s_waitcnt lgkmcnt(9)
    v_mfma_f32_16x16x32_bf16 v[20:23], a[12:15], a[32:35], v[20:23]
    ds_read_b128 a[28:31], v35 offset:26624
    v_mfma_f32_16x16x32_bf16 v[28:31], a[12:15], a[36:39], v[28:31]
    ds_read_b64_tr_b16 a[4:5], v33 offset:36864
    ds_read_b64_tr_b16 a[6:7], v33 offset:37376
    s_waitcnt vmcnt(3)
    s_barrier
    s_waitcnt lgkmcnt(9)
    v_mfma_f32_16x16x32_bf16 v[16:19], a[16:19], a[40:43], v[16:19]
    ds_read_b128 a[32:35], v34 offset:10240
    s_waitcnt lgkmcnt(9)
    v_mfma_f32_16x16x32_bf16 v[24:27], a[16:19], a[44:47], v[24:27]
    ds_read_b64_tr_b16 a[8:9], v32 offset:40960
    ds_read_b64_tr_b16 a[10:11], v32 offset:41472
    s_waitcnt lgkmcnt(9)
    v_mfma_f32_16x16x32_bf16 v[20:23], a[20:23], a[40:43], v[20:23]
    ds_read_b128 a[36:39], v34 offset:28672
    ds_read_b64_tr_b16 a[12:13], v33 offset:40960
    v_mfma_f32_16x16x32_bf16 v[28:31], a[20:23], a[44:47], v[28:31]
    ds_read_b64_tr_b16 a[14:15], v33 offset:41472
    s_add_u32 m0, s21, 0
    s_nop 0
    buffer_load_dwordx4 v6, s[60:63], s27 offen lds
    s_waitcnt lgkmcnt(9)
    v_mfma_f32_16x16x32_bf16 v[16:19], a[0:3], a[24:27], v[16:19]
    ds_read_b128 a[40:43], v35 offset:10240
    s_waitcnt lgkmcnt(9)
    v_mfma_f32_16x16x32_bf16 v[24:27], a[0:3], a[28:31], v[24:27]
    ds_read_b64_tr_b16 a[16:17], v32 offset:45056
    ds_read_b64_tr_b16 a[18:19], v32 offset:45568
    s_waitcnt lgkmcnt(9)
    v_mfma_f32_16x16x32_bf16 v[20:23], a[4:7], a[24:27], v[20:23]
    ds_read_b128 a[44:47], v35 offset:28672
    v_mfma_f32_16x16x32_bf16 v[28:31], a[4:7], a[28:31], v[28:31]
    ds_read_b64_tr_b16 a[20:21], v33 offset:45056
    ds_read_b64_tr_b16 a[22:23], v33 offset:45568
    s_waitcnt vmcnt(2)
    s_barrier
    s_waitcnt lgkmcnt(9)
    v_mfma_f32_16x16x32_bf16 v[16:19], a[8:11], a[32:35], v[16:19]
    ds_read_b128 a[24:27], v34 offset:12288
    s_waitcnt lgkmcnt(9)
    v_mfma_f32_16x16x32_bf16 v[24:27], a[8:11], a[36:39], v[24:27]
    ds_read_b64_tr_b16 a[0:1], v32 offset:49152
    ds_read_b64_tr_b16 a[2:3], v32 offset:49664
    s_waitcnt lgkmcnt(9)
    v_mfma_f32_16x16x32_bf16 v[20:23], a[12:15], a[32:35], v[20:23]
    ds_read_b128 a[28:31], v34 offset:30720
    v_mfma_f32_16x16x32_bf16 v[28:31], a[12:15], a[36:39], v[28:31]
    ds_read_b64_tr_b16 a[4:5], v33 offset:49152
    ds_read_b64_tr_b16 a[6:7], v33 offset:49664
    s_waitcnt lgkmcnt(9)
    v_mfma_f32_16x16x32_bf16 v[16:19], a[16:19], a[40:43], v[16:19]
    ds_read_b128 a[32:35], v35 offset:12288
    s_waitcnt lgkmcnt(9)
    v_mfma_f32_16x16x32_bf16 v[24:27], a[16:19], a[44:47], v[24:27]
    ds_read_b64_tr_b16 a[8:9], v32 offset:53248
    ds_read_b64_tr_b16 a[10:11], v32 offset:53760
    s_waitcnt lgkmcnt(9)
    v_mfma_f32_16x16x32_bf16 v[20:23], a[20:23], a[40:43], v[20:23]
    ds_read_b128 a[36:39], v35 offset:30720
    v_mfma_f32_16x16x32_bf16 v[28:31], a[20:23], a[44:47], v[28:31]
    ds_read_b64_tr_b16 a[12:13], v33 offset:53248
    ds_read_b64_tr_b16 a[14:15], v33 offset:53760
    s_waitcnt vmcnt(1)
    s_barrier
    s_waitcnt lgkmcnt(9)
    v_mfma_f32_16x16x32_bf16 v[16:19], a[0:3], a[24:27], v[16:19]
    ds_read_b128 a[40:43], v34 offset:14336
    s_waitcnt lgkmcnt(9)
    v_mfma_f32_16x16x32_bf16 v[24:27], a[0:3], a[28:31], v[24:27]
    ds_read_b64_tr_b16 a[16:17], v32 offset:57344
    ds_read_b64_tr_b16 a[18:19], v32 offset:57856
    s_waitcnt lgkmcnt(9)
    v_mfma_f32_16x16x32_bf16 v[20:23], a[4:7], a[24:27], v[20:23]
    ds_read_b128 a[44:47], v34 offset:32768
    v_mfma_f32_16x16x32_bf16 v[28:31], a[4:7], a[28:31], v[28:31]
    ds_read_b64_tr_b16 a[20:21], v33 offset:57344
    ds_read_b64_tr_b16 a[22:23], v33 offset:57856
    s_waitcnt lgkmcnt(9)
    v_mfma_f32_16x16x32_bf16 v[16:19], a[8:11], a[32:35], v[16:19]
    ds_read_b128 a[24:27], v35 offset:14336
    s_waitcnt lgkmcnt(9)
    v_mfma_f32_16x16x32_bf16 v[24:27], a[8:11], a[36:39], v[24:27]
    ds_read_b64_tr_b16 a[0:1], v32 offset:61440
    ds_read_b64_tr_b16 a[2:3], v32 offset:61952
    s_waitcnt lgkmcnt(9)
    v_mfma_f32_16x16x32_bf16 v[20:23], a[12:15], a[32:35], v[20:23]
    ds_read_b128 a[28:31], v35 offset:32768
    v_mfma_f32_16x16x32_bf16 v[28:31], a[12:15], a[36:39], v[28:31]
    ds_read_b64_tr_b16 a[4:5], v33 offset:61440
    ds_read_b64_tr_b16 a[6:7], v33 offset:61952
    s_waitcnt vmcnt(0)
    s_barrier
    s_waitcnt lgkmcnt(9)
    v_mfma_f32_16x16x32_bf16 v[16:19], a[16:19], a[40:43], v[16:19]
    ds_read_b128 a[32:35], v34 offset:16384
    s_waitcnt lgkmcnt(9)
    v_mfma_f32_16x16x32_bf16 v[24:27], a[16:19], a[44:47], v[24:27]
    ds_read_b64_tr_b16 a[8:9], v32 offset:0
    ds_read_b64_tr_b16 a[10:11], v32 offset:512
    s_waitcnt lgkmcnt(9)
    v_mfma_f32_16x16x32_bf16 v[20:23], a[20:23], a[40:43], v[20:23]
    ds_read_b128 a[36:39], v34 offset:34816
    v_mfma_f32_16x16x32_bf16 v[28:31], a[20:23], a[44:47], v[28:31]
    ds_read_b64_tr_b16 a[12:13], v33 offset:0
    ds_read_b64_tr_b16 a[14:15], v33 offset:512
    s_waitcnt lgkmcnt(9)
    v_mfma_f32_16x16x32_bf16 v[16:19], a[0:3], a[24:27], v[16:19]
    ds_read_b128 a[40:43], v35 offset:16384
    s_waitcnt lgkmcnt(9)
    v_mfma_f32_16x16x32_bf16 v[24:27], a[0:3], a[28:31], v[24:27]
    ds_read_b64_tr_b16 a[16:17], v32 offset:4096
    ds_read_b64_tr_b16 a[18:19], v32 offset:4608
    s_waitcnt lgkmcnt(9)
    v_mfma_f32_16x16x32_bf16 v[20:23], a[4:7], a[24:27], v[20:23]
    ds_read_b128 a[44:47], v35 offset:34816
    v_mfma_f32_16x16x32_bf16 v[28:31], a[4:7], a[28:31], v[28:31]
    ds_read_b64_tr_b16 a[20:21], v33 offset:4096
    ds_read_b64_tr_b16 a[22:23], v33 offset:4608
    s_waitcnt lgkmcnt(9)
    v_mfma_f32_16x16x32_bf16 v[16:19], a[8:11], a[32:35], v[16:19]
    v_lshrrev_b32 v9, 3, v1
    v_and_b32 v10, 7, v1
    s_lshl_b32 s46, s16, 3
    v_add_u32 v9, s46, v9
    s_waitcnt lgkmcnt(8)
    v_mfma_f32_16x16x32_bf16 v[24:27], a[8:11], a[36:39], v[24:27]
    v_mul_u32_u24 v11, 144, v9
    v_lshl_add_u32 v11, v10, 4, v11
    v_mul_u32_u24 v12, 1152, v9
    v_lshl_add_u32 v12, v10, 4, v12
    s_waitcnt lgkmcnt(6)
    v_mfma_f32_16x16x32_bf16 v[20:23], a[12:15], a[32:35], v[20:23]
    s_mul_i32 s46, s20, 1152
    s_lshl_b32 s47, s18, 7
    s_add_u32 s46, s46, s47
    v_add_u32 v12, s46, v12
    v_mfma_f32_16x16x32_bf16 v[28:31], a[12:15], a[36:39], v[28:31]
    v_add_u32 v13, 73728, v12
    s_mov_b32 s52, s6
    s_mov_b32 s53, s7
    s_mov_b32 s54, 2359296
    s_mov_b32 s55, 0x20000
    s_waitcnt lgkmcnt(3)
    v_mfma_f32_16x16x32_bf16 v[16:19], a[16:19], a[40:43], v[16:19]
    s_waitcnt lgkmcnt(2)
    v_mfma_f32_16x16x32_bf16 v[24:27], a[16:19], a[44:47], v[24:27]
    s_waitcnt lgkmcnt(0)
    v_mfma_f32_16x16x32_bf16 v[20:23], a[20:23], a[40:43], v[20:23]
    v_mfma_f32_16x16x32_bf16 v[28:31], a[20:23], a[44:47], v[28:31]
    s_barrier
    ds_read_b128 v[36:39], v14
    ds_read_b128 v[40:43], v14 offset:64
    ds_read_b64 v[44:45], v15
    ds_read_b64 v[46:47], v15 offset:128
    s_waitcnt lgkmcnt(1)
    v_fma_f32 v16, -v44, v36, v16
    v_fma_f32 v17, -v44, v37, v17
    v_fma_f32 v18, -v44, v38, v18
    v_fma_f32 v19, -v44, v39, v19
    v_fma_f32 v20, -v44, v40, v20
    v_fma_f32 v21, -v44, v41, v21
    v_fma_f32 v22, -v44, v42, v22
    v_fma_f32 v23, -v44, v43, v23
    v_mul_f32 v16, v45, v16
    v_mul_f32 v17, v45, v17
    v_mul_f32 v18, v45, v18
    v_mul_f32 v19, v45, v19
    v_mul_f32 v20, v45, v20
    v_mul_f32 v21, v45, v21
    v_mul_f32 v22, v45, v22
    v_mul_f32 v23, v45, v23
    v_cvt_pk_bf16_f32 v48, v16, v17
    v_cvt_pk_bf16_f32 v49, v18, v19
    v_cvt_pk_bf16_f32 v50, v20, v21
    v_cvt_pk_bf16_f32 v51, v22, v23
    ds_write_b64 v5, v[48:49] offset:0
    ds_write_b64 v5, v[50:51] offset:32
    s_waitcnt lgkmcnt(0)
    v_fma_f32 v24, -v46, v36, v24
    v_fma_f32 v25, -v46, v37, v25
    v_fma_f32 v26, -v46, v38, v26
    v_fma_f32 v27, -v46, v39, v27
    v_fma_f32 v28, -v46, v40, v28
    v_fma_f32 v29, -v46, v41, v29
    v_fma_f32 v30, -v46, v42, v30
    v_fma_f32 v31, -v46, v43, v31
    v_mul_f32 v24, v47, v24
    v_mul_f32 v25, v47, v25
    v_mul_f32 v26, v47, v26
    v_mul_f32 v27, v47, v27
    v_mul_f32 v28, v47, v28
    v_mul_f32 v29, v47, v29
    v_mul_f32 v30, v47, v30
    v_mul_f32 v31, v47, v31
    v_cvt_pk_bf16_f32 v52, v24, v25
    v_cvt_pk_bf16_f32 v53, v26, v27
    v_cvt_pk_bf16_f32 v54, v28, v29
    v_cvt_pk_bf16_f32 v55, v30, v31
    ds_write_b64 v5, v[52:53] offset:2304
    ds_write_b64 v5, v[54:55] offset:2336
    s_branch L_q_out
L_k1_qs:
    s_sub_u32 s59, s16, 4
    s_lshl_b32 s24, s59, 1
    v_lshrrev_b32 v11, 1, v9
    v_add_u32 v11, s24, v11
    v_xor_b32 v11, v11, v10
    v_lshl_add_u32 v8, v11, 4, v5
    s_lshl_b32 s24, s59, 2
    s_add_u32 s24, s24, s20
    s_add_u32 s24, s24, 65
    s_mul_i32 s24, s24, 1152
    s_add_u32 s24, s24, s57
    s_lshl_b32 s25, s59, 9
    s_add_u32 s25, s25, 139264
    s_cmp_eq_u32 s59, 3
    s_cselect_b32 s64, 0x00ffffff, -1
    s_mov_b32 s65, 0
    s_setprio 3
    s_waitcnt lgkmcnt(0)
    s_sub_u32 s28, s28, 1152
    s_subb_u32 s29, s29, 0
    s_add_u32 m0, s56, 0
    s_nop 0
    buffer_load_dwordx4 v7, s[28:31], s23 offen offset:0 lds
    s_add_u32 m0, s25, 0
    s_mov_b64 exec, s[64:65]
    buffer_load_dwordx4 v8, s[28:31], s24 offen offset:0 lds
    s_mov_b64 exec, -1
    s_add_u32 m0, s21, 0
    s_nop 0
    buffer_load_dwordx4 v6, s[60:63], s27 offen lds
    s_add_u32 s27, s27, 73728
    s_cmp_eq_u32 s19, 1
    s_cselect_b32 s22, 663552, 0
    s_sub_u32 s27, s27, s22
    s_setprio 2
    s_add_u32 m0, s21, 8192
    s_nop 0
    buffer_load_dwordx4 v6, s[60:63], s27 offen lds
    s_add_u32 s27, s27, 73728
    s_cmp_eq_u32 s19, 2
    s_cselect_b32 s22, 663552, 0
    s_sub_u32 s27, s27, s22
    s_cmp_eq_u32 s19, 1
    s_cselect_b32 s22, 1152, 0
    s_sub_u32 s23, s23, s22
    s_sub_u32 s24, s24, s22
    s_add_u32 m0, s56, 1920
    s_nop 0
    buffer_load_dwordx4 v7, s[28:31], s23 offen offset:128 lds
    s_add_u32 m0, s25, 1920
    s_mov_b64 exec, s[64:65]
    buffer_load_dwordx4 v8, s[28:31], s24 offen offset:128 lds
    s_mov_b64 exec, -1
    s_cmp_eq_u32 s19, 2
    s_cselect_b32 s22, 1152, 0
    s_sub_u32 s23, s23, s22
    s_sub_u32 s24, s24, s22
    s_add_u32 m0, s56, 3840
    s_nop 0
    buffer_load_dwordx4 v7, s[28:31], s23 offen offset:256 lds
    s_add_u32 m0, s25, 3840
    s_mov_b64 exec, s[64:65]
    buffer_load_dwordx4 v8, s[28:31], s24 offen offset:256 lds
    s_mov_b64 exec, -1
    s_setprio 0
    v_and_b32 v2, 15, v1
    v_lshrrev_b32 v3, 4, v1
    v_mov_b32 v36, 0x3f803f80
    v_mov_b32 v37, 0x3f803f80
    v_mov_b32 v38, 0x3f803f80
    v_mov_b32 v39, 0x3f803f80
    v_mov_b32 v28, 0
    v_mov_b32 v29, 0
    v_mov_b32 v30, 0
    v_mov_b32 v31, 0
    v_mov_b32 v32, 0
    v_mov_b32 v33, 0
    v_mov_b32 v34, 0
    v_mov_b32 v35, 0
    v_mov_b32 v40, 0x4444
    v_mov_b32 v12, 0xeeee
    v_cmp_lt_u32 vcc, 7, v2
    s_mov_b32 s36, 0x00100001
    s_mov_b32 s37, 0x10000100
    v_cndmask_b32 v40, v40, v12, vcc
    s_lshl_b64 s[38:39], s[36:37], 1
    s_lshl_b64 s[40:41], s[36:37], 2
    s_lshl_b64 s[42:43], s[36:37], 3
    s_mov_b32 s58, 0x3ae38e39
    s_mov_b32 s47, 139264
    s_cmp_eq_u32 s59, 3
    s_cbranch_scc0 L_qs_noones
    v_lshlrev_b32 v12, 4, v10
    v_add_u32 v12, s47, v12
    v_lshl_add_u32 v13, v9, 11, v12
    ds_write_b128 v13, v[36:39] offset:1920
    ds_write_b128 v12, v[36:39] offset:18304
    s_waitcnt lgkmcnt(0)
L_qs_noones:
    v_lshrrev_b32 v11, 1, v2
    v_xor_b32 v11, v11, v3
    v_lshlrev_b32 v11, 4, v11
    v_lshl_add_u32 v11, v2, 7, v11
    v_add_u32 v44, s47, v11
    v_xor_b32 v45, 64, v44
    s_mul_i32 s47, s59, 18432
    s_add_u32 s47, s47, 65536
    s_lshl_b32 s45, s59, 5
    v_lshrrev_b32 v11, 1, v2
    v_xor_b32 v11, v11, v3
    v_lshlrev_b32 v11, 4, v11
    v_lshl_add_u32 v11, v2, 7, v11
    v_add_u32 v42, s47, v11
    v_xor_b32 v43, 64, v42
    v_bfe_u32 v12, v1, 2, 2
    v_and_b32 v13, 3, v1
    v_lshl_add_u32 v9, v3, 3, v12
    v_lshlrev_b32 v9, 7, v9
    v_lshl_add_u32 v9, v13, 3, v9
    v_lshrrev_b32 v10, 1, v12
    v_and_b32 v11, 1, v3
    v_lshl_add_u32 v10, v11, 1, v10
    v_lshl_add_u32 v41, v10, 5, v9
    v_xor_b32 v41, s45, v41
    v_add_u32 v4, 64, v2
    v_mul_u32_u24 v5, 144, v4
    v_lshl_add_u32 v5, v3, 3, v5
    v_add_u32 v5, s45, v5
    s_lshl_b32 s45, s59, 6
    s_add_u32 s45, s45, 161920
    v_lshl_add_u32 v14, v3, 4, s45
    s_lshl_b32 s46, s59, 7
    s_add_u32 s46, s46, 162176
    v_lshl_add_u32 v15, v2, 3, s46
    s_mov_b32 s32, s6
    s_mov_b32 s33, s7
    s_mov_b32 s34, 0x600000
    s_mov_b32 s35, 0x20000
    s_mov_b32 s8, s12
    s_mov_b32 s9, s13
    s_mov_b32 s10, 0xa2000
    s_mov_b32 s11, 0x20000
    s_lshl_b32 s66, s26, 2
    s_add_u32 s66, s66, s59
    s_and_b32 s51, s66, 1
    s_lshr_b32 s54, s66, 1
    s_mul_i32 s55, s54, 57
    s_lshr_b32 s55, s55, 11
    s_mul_i32 s45, s55, 36
    s_sub_u32 s54, s54, s45
    s_cmp_ge_u32 s55, 8
    s_cselect_b32 s45, 144, 18
    s_cselect_b32 s46, 36, 4
    s_cselect_b32 s52, 288, 36
    s_cselect_b32 s53, 18, 2
    s_mul_i32 s52, s52, 1152
    s_mul_i32 s53, s53, 1152
    s_mul_i32 s47, s55, 72
    s_cselect_b32 s47, 16, s47
    s_mul_i32 s45, s45, s51
    s_add_u32 s47, s47, s45
    v_mul_u32_u24 v9, s46, v3
    v_add_u32 v9, s47, v9
    v_mul_u32_u24 v9, 1152, v9
    v_lshl_add_u32 v9, v2, 1, v9
    s_lshl_b32 s54, s54, 5
    s_cmp_ge_u32 s66, 648
    s_cselect_b32 s54, 0x7f000000, s54
    v_add_u32 v9, s54, v9
    s_add_u32 s54, s52, s53
    buffer_load_ushort v56, v9, s[8:11], 0 offen offset:0 nt
    buffer_load_ushort v57, v9, s[8:11], s52 offen offset:0 nt
    buffer_load_ushort v58, v9, s[8:11], s53 offen offset:0 nt
    buffer_load_ushort v59, v9, s[8:11], s54 offen offset:0 nt
    buffer_load_ushort v60, v9, s[8:11], 0 offen offset:1152 nt
    buffer_load_ushort v61, v9, s[8:11], s52 offen offset:1152 nt
    buffer_load_ushort v62, v9, s[8:11], s53 offen offset:1152 nt
    buffer_load_ushort v63, v9, s[8:11], s54 offen offset:1152 nt
    s_cmp_eq_u32 s59, 3
    s_cbranch_scc1 L_qs_both
    s_add_u32 m0, s21, 16384
    s_nop 0
    buffer_load_dwordx4 v6, s[60:63], s27 offen lds
    s_add_u32 s27, s27, 73728
    s_cmp_eq_u32 s19, 3
    s_cselect_b32 s22, 663552, 0
    s_sub_u32 s27, s27, s22
    s_cmp_eq_u32 s19, 3
    s_cselect_b32 s22, 1152, 0
    s_sub_u32 s23, s23, s22
    s_sub_u32 s24, s24, s22
    s_add_u32 m0, s56, 5760
    s_nop 0
    buffer_load_dwordx4 v7, s[28:31], s23 offen offset:384 lds
    s_add_u32 m0, s25, 5760
    s_mov_b64 exec, s[64:65]
    buffer_load_dwordx4 v8, s[28:31], s24 offen offset:384 lds
    s_mov_b64 exec, -1
    s_cmp_eq_u32 s19, 4
    s_cselect_b32 s22, 1152, 0
    s_sub_u32 s23, s23, s22
    s_sub_u32 s24, s24, s22
    s_add_u32 m0, s56, 7680
    s_nop 0
    buffer_load_dwordx4 v7, s[28:31], s23 offen offset:512 lds
    s_add_u32 m0, s25, 7680
    s_mov_b64 exec, s[64:65]
    buffer_load_dwordx4 v8, s[28:31], s24 offen offset:512 lds
    s_mov_b64 exec, -1
    s_waitcnt vmcnt(18)
    s_barrier
    ds_read_b128 a[12:15], v42 offset:0
    ds_read_b128 a[16:19], v43 offset:0
    ds_read_b128 a[44:47], v44 offset:0
    ds_read_b64_tr_b16 a[0:1], v41 offset:0
    ds_read_b64_tr_b16 a[2:3], v41 offset:512
    s_add_u32 m0, s21, 24576
    s_nop 0
    buffer_load_dwordx4 v6, s[60:63], s27 offen lds
    s_add_u32 s27, s27, 73728
    s_cmp_eq_u32 s19, 4
    s_cselect_b32 s22, 663552, 0
    s_sub_u32 s27, s27, s22
    s_cmp_eq_u32 s19, 5
    s_cselect_b32 s22, 1152, 0
    s_sub_u32 s23, s23, s22
    s_sub_u32 s24, s24, s22
    s_add_u32 m0, s56, 9600
    s_nop 0
    buffer_load_dwordx4 v7, s[28:31], s23 offen offset:640 lds
    s_add_u32 m0, s25, 9600
    s_mov_b64 exec, s[64:65]
    buffer_load_dwordx4 v8, s[28:31], s24 offen offset:640 lds
    s_mov_b64 exec, -1
    ds_read_b128 a[48:51], v45 offset:0
    ds_read_b64_tr_b16 a[4:5], v41 offset:4096
    ds_read_b64_tr_b16 a[6:7], v41 offset:4608
    s_waitcnt vmcnt(16)
    s_barrier
    s_waitcnt lgkmcnt(7)
    v_mfma_f32_16x16x32_bf16 v[20:23], a[12:15], a[12:15], 0
    ds_read_b128 a[20:23], v42 offset:2048
    ds_read_b128 a[24:27], v43 offset:2048
    s_waitcnt lgkmcnt(8)
    v_smfmac_f32_16x16x64_bf16 v[28:31], v[36:39], a[12:19], v40
    ds_read_b128 a[28:31], v42 offset:4096
    ds_read_b128 a[52:55], v44 offset:2048
    v_mfma_f32_16x16x32_bf16 v[20:23], a[16:19], a[16:19], v[20:23]
    ds_read_b64_tr_b16 a[8:9], v41 offset:8192
    ds_read_b64_tr_b16 a[10:11], v41 offset:8704
    s_waitcnt lgkmcnt(9)
    v_mfma_f32_16x16x32_bf16 v[16:19], a[0:3], a[44:47], 0
    s_add_u32 m0, s21, 32768
    s_nop 0
    buffer_load_dwordx4 v6, s[60:63], s27 offen lds
    s_add_u32 s27, s27, 73728
    s_cmp_eq_u32 s19, 5
    s_cselect_b32 s22, 663552, 0
    s_sub_u32 s27, s27, s22
    s_cmp_eq_u32 s19, 6
    s_cselect_b32 s22, 1152, 0
    s_sub_u32 s23, s23, s22
    s_sub_u32 s24, s24, s22
    s_add_u32 m0, s56, 11520
    s_nop 0
    buffer_load_dwordx4 v7, s[28:31], s23 offen offset:768 lds
    s_add_u32 m0, s25, 11520
    s_mov_b64 exec, s[64:65]
    buffer_load_dwordx4 v8, s[28:31], s24 offen offset:768 lds
    s_mov_b64 exec, -1
    s_waitcnt lgkmcnt(6)
    v_mfma_f32_16x16x32_bf16 v[16:19], a[4:7], a[48:51], v[16:19]
    ds_read_b128 a[32:35], v43 offset:4096
    ds_read_b128 a[56:59], v45 offset:2048
    ds_read_b64_tr_b16 a[0:1], v41 offset:12288
    ds_read_b64_tr_b16 a[2:3], v41 offset:12800
    s_waitcnt vmcnt(6)
    s_barrier
    s_waitcnt lgkmcnt(9)
    v_mfma_f32_16x16x32_bf16 v[20:23], a[20:23], a[20:23], v[20:23]
    ds_read_b128 a[36:39], v42 offset:6144
    s_waitcnt lgkmcnt(9)
    v_smfmac_f32_16x16x64_bf16 v[28:31], v[36:39], a[20:27], v40
    ds_read_b128 a[40:43], v43 offset:6144
    ds_read_b128 a[12:15], v42 offset:8192
    v_mfma_f32_16x16x32_bf16 v[20:23], a[24:27], a[24:27], v[20:23]
    ds_read_b128 a[60:63], v44 offset:4096
    ds_read_b64_tr_b16 a[4:5], v41 offset:16384
    s_waitcnt lgkmcnt(12)
    v_mfma_f32_16x16x32_bf16 v[20:23], a[28:31], a[28:31], v[20:23]
    ds_read_b64_tr_b16 a[6:7], v41 offset:16896
    s_add_u32 m0, s21, 40960
    s_nop 0
    buffer_load_dwordx4 v6, s[60:63], s27 offen lds
    s_waitcnt lgkmcnt(10)
    v_mfma_f32_16x16x32_bf16 v[16:19], a[8:11], a[52:55], v[16:19]
    s_add_u32 s27, s27, 73728
    s_cmp_eq_u32 s19, 6
    s_cselect_b32 s22, 663552, 0
    s_sub_u32 s27, s27, s22
    s_cmp_eq_u32 s19, 7
    s_cselect_b32 s22, 1152, 0
    s_sub_u32 s23, s23, s22
    s_sub_u32 s24, s24, s22
    s_add_u32 m0, s56, 13440
    s_nop 0
    buffer_load_dwordx4 v7, s[28:31], s23 offen offset:896 lds
    s_add_u32 m0, s25, 13440
    s_mov_b64 exec, s[64:65]
    buffer_load_dwordx4 v8, s[28:31], s24 offen offset:896 lds
    s_mov_b64 exec, -1
    s_waitcnt lgkmcnt(9)
    v_smfmac_f32_16x16x64_bf16 v[28:31], v[36:39], a[28:35], v40
    ds_read_b128 a[16:19], v43 offset:8192
    v_mfma_f32_16x16x32_bf16 v[20:23], a[32:35], a[32:35], v[20:23]
    ds_read_b128 a[64:67], v45 offset:4096
    s_waitcnt lgkmcnt(8)
    v_mfma_f32_16x16x32_bf16 v[16:19], a[0:3], a[56:59], v[16:19]
    ds_read_b64_tr_b16 a[8:9], v41 offset:20480
    ds_read_b64_tr_b16 a[10:11], v41 offset:20992
    s_waitcnt vmcnt(6)
    s_barrier
    s_waitcnt lgkmcnt(9)
    v_mfma_f32_16x16x32_bf16 v[20:23], a[36:39], a[36:39], v[20:23]
    ds_read_b128 a[20:23], v42 offset:10240
    s_waitcnt lgkmcnt(9)
    v_smfmac_f32_16x16x64_bf16 v[28:31], v[36:39], a[36:43], v40
    ds_read_b128 a[68:71], v44 offset:6144
    v_mfma_f32_16x16x32_bf16 v[20:23], a[40:43], a[40:43], v[20:23]
    ds_read_b64_tr_b16 a[0:1], v41 offset:24576
    ds_read_b64_tr_b16 a[2:3], v41 offset:25088
    s_waitcnt lgkmcnt(11)
    v_mfma_f32_16x16x32_bf16 v[20:23], a[12:15], a[12:15], v[20:23]
    s_add_u32 m0, s21, 49152
    s_nop 0
    buffer_load_dwordx4 v6, s[60:63], s27 offen lds
    s_waitcnt lgkmcnt(8)
    v_mfma_f32_16x16x32_bf16 v[16:19], a[4:7], a[60:63], v[16:19]
    s_add_u32 s27, s27, 73728
    s_cmp_eq_u32 s19, 7
    s_cselect_b32 s22, 663552, 0
    s_sub_u32 s27, s27, s22
    s_cmp_eq_u32 s19, 8
    s_cselect_b32 s22, 1152, 0
    s_sub_u32 s23, s23, s22
    s_sub_u32 s24, s24, s22
    s_add_u32 m0, s56, 15360
    s_nop 0
    buffer_load_dwordx4 v7, s[28:31], s23 offen offset:1024 lds
    s_add_u32 m0, s25, 15360
    s_mov_b64 exec, s[64:65]
    buffer_load_dwordx4 v8, s[28:31], s24 offen offset:1024 lds
    s_mov_b64 exec, -1
    s_waitcnt lgkmcnt(7)
    v_smfmac_f32_16x16x64_bf16 v[28:31], v[36:39], a[12:19], v40
    ds_read_b128 a[24:27], v43 offset:10240
    v_mfma_f32_16x16x32_bf16 v[20:23], a[16:19], a[16:19], v[20:23]
    ds_read_b128 a[72:75], v45 offset:6144
    s_waitcnt lgkmcnt(6)
    v_mfma_f32_16x16x32_bf16 v[16:19], a[8:11], a[64:67], v[16:19]
    ds_read_b64_tr_b16 a[4:5], v41 offset:28672
    ds_read_b64_tr_b16 a[6:7], v41 offset:29184
    s_waitcnt vmcnt(6)
    s_barrier
    s_waitcnt lgkmcnt(7)
    v_mfma_f32_16x16x32_bf16 v[20:23], a[20:23], a[20:23], v[20:23]
    ds_read_b128 a[28:31], v42 offset:12288
    ds_read_b128 a[76:79], v44 offset:8192
    s_waitcnt lgkmcnt(6)
    v_mfma_f32_16x16x32_bf16 v[16:19], a[0:3], a[68:71], v[16:19]
    ds_read_b64_tr_b16 a[8:9], v41 offset:32768
    ds_read_b64_tr_b16 a[10:11], v41 offset:33280
    s_add_u32 m0, s21, 57344
    s_nop 0
    buffer_load_dwordx4 v6, s[60:63], s27 offen lds
    s_add_u32 s27, s27, 73728
    s_cmp_eq_u32 s19, 8
    s_cselect_b32 s22, 663552, 0
    s_sub_u32 s27, s27, s22
    s_waitcnt lgkmcnt(7)
    v_smfmac_f32_16x16x64_bf16 v[28:31], v[36:39], a[20:27], v40
    ds_read_b128 a[32:35], v43 offset:12288
    v_mfma_f32_16x16x32_bf16 v[20:23], a[24:27], a[24:27], v[20:23]
    ds_read_b128 a[80:83], v45 offset:8192
    s_waitcnt lgkmcnt(6)
    v_mfma_f32_16x16x32_bf16 v[16:19], a[4:7], a[72:75], v[16:19]
    ds_read_b64_tr_b16 a[0:1], v41 offset:36864
    ds_read_b64_tr_b16 a[2:3], v41 offset:37376
    s_waitcnt vmcnt(4)
    s_barrier
    s_waitcnt lgkmcnt(7)
    v_mfma_f32_16x16x32_bf16 v[20:23], a[28:31], a[28:31], v[20:23]
    ds_read_b128 a[36:39], v42 offset:14336
    ds_read_b128 a[44:47], v44 offset:10240
    s_waitcnt lgkmcnt(6)
    v_mfma_f32_16x16x32_bf16 v[16:19], a[8:11], a[76:79], v[16:19]
    ds_read_b64_tr_b16 a[4:5], v41 offset:40960
    ds_read_b64_tr_b16 a[6:7], v41 offset:41472
    s_add_u32 m0, s21, 0
    s_nop 0
    buffer_load_dwordx4 v6, s[60:63], s27 offen lds
    s_waitcnt lgkmcnt(7)
    v_smfmac_f32_16x16x64_bf16 v[28:31], v[36:39], a[28:35], v40
    ds_read_b128 a[40:43], v43 offset:14336
    v_mfma_f32_16x16x32_bf16 v[20:23], a[32:35], a[32:35], v[20:23]
    ds_read_b128 a[48:51], v45 offset:10240
    s_waitcnt lgkmcnt(6)
    v_mfma_f32_16x16x32_bf16 v[16:19], a[0:3], a[80:83], v[16:19]
    ds_read_b64_tr_b16 a[8:9], v41 offset:45056
    ds_read_b64_tr_b16 a[10:11], v41 offset:45568
    s_waitcnt vmcnt(2)
    s_barrier
    s_waitcnt lgkmcnt(7)
    v_mfma_f32_16x16x32_bf16 v[20:23], a[36:39], a[36:39], v[20:23]
    ds_read_b128 a[12:15], v42 offset:16384
    ds_read_b128 a[52:55], v44 offset:12288
    ds_read_b64_tr_b16 a[0:1], v41 offset:49152
    ds_read_b64_tr_b16 a[2:3], v41 offset:49664
    s_waitcnt lgkmcnt(8)
    v_mfma_f32_16x16x32_bf16 v[16:19], a[4:7], a[44:47], v[16:19]
    v_lshl_or_b32 v56, v60, 16, v56
    v_lshl_or_b32 v57, v61, 16, v57
    v_lshl_or_b32 v58, v62, 16, v58
    v_lshl_or_b32 v59, v63, 16, v59
    s_lshl_b32 s45, s66, 10
    s_add_u32 s45, s45, 2527232
    s_cmp_ge_u32 s66, 648
    s_cselect_b32 s45, 0x7f000000, s45
    v_lshl_add_u32 v72, v1, 4, s45
    buffer_store_dwordx4 v[56:59], v72, s[32:35], 0 offen sc1
    v_mov_b32 v64, -1
    v_mov_b32 v65, -1
    v_mov_b32 v66, -1
    v_mov_b32 v67, -1
    s_lshl_b32 s46, s59, 11
    s_cmp_lt_u32 s59, 2
    s_cselect_b32 s46, s46, 0x7f000000
    v_lshl_add_u32 v69, v1, 4, s46
    s_mul_i32 s47, s2, 3600
    s_add_u32 s47, s47, 3538944
    buffer_store_dwordx4 v[64:67], v69, s[32:35], s47 offen sc1
    v_cmp_gt_u32 vcc, 2576, v69
    v_mov_b32 v68, 0x7f000000
    v_lshrrev_b32 v70, 3, v1
    v_cndmask_b32 v69, v68, v69, vcc
    buffer_store_dwordx4 v[64:67], v69, s[32:35], s47 offen offset:1024 sc1
    s_mov_b32 s50, 33024
    v_mul_lo_u32 v70, s50, v70
    v_and_b32 v71, 7, v1
    s_cmp_eq_u32 s59, 2
    s_cselect_b32 s46, 0, 0x7f000000
    v_lshl_add_u32 v71, v71, 4, s46
    v_add_u32 v70, v71, v70
    s_lshl_b32 s47, s26, 7
    s_add_u32 s47, s47, 3211264
    buffer_store_dwordx4 v[64:67], v70, s[32:35], s47 offen sc1
    s_waitcnt lgkmcnt(7)
    v_smfmac_f32_16x16x64_bf16 v[28:31], v[36:39], a[36:43], v40
    ds_read_b128 a[16:19], v43 offset:16384
    v_mfma_f32_16x16x32_bf16 v[20:23], a[40:43], a[40:43], v[20:23]
    ds_read_b128 a[56:59], v45 offset:12288
    s_waitcnt lgkmcnt(6)
    v_mfma_f32_16x16x32_bf16 v[16:19], a[8:11], a[48:51], v[16:19]
    ds_read_b64_tr_b16 a[4:5], v41 offset:53248
    ds_read_b64_tr_b16 a[6:7], v41 offset:53760
    s_waitcnt vmcnt(5)
    s_barrier
    s_waitcnt lgkmcnt(7)
    v_mfma_f32_16x16x32_bf16 v[20:23], a[12:15], a[12:15], v[20:23]
    ds_read_b128 a[60:63], v44 offset:14336
    s_waitcnt lgkmcnt(5)
    v_mfma_f32_16x16x32_bf16 v[16:19], a[0:3], a[52:55], v[16:19]
    ds_read_b64_tr_b16 a[8:9], v41 offset:57344
    ds_read_b64_tr_b16 a[10:11], v41 offset:57856
    s_waitcnt lgkmcnt(6)
    v_smfmac_f32_16x16x64_bf16 v[28:31], v[36:39], a[12:19], v40
    ds_read_b128 a[64:67], v45 offset:14336
    v_mfma_f32_16x16x32_bf16 v[20:23], a[16:19], a[16:19], v[20:23]
    ds_read_b64_tr_b16 a[0:1], v41 offset:61440
    s_waitcnt lgkmcnt(5)
    v_mfma_f32_16x16x32_bf16 v[16:19], a[4:7], a[56:59], v[16:19]
    ds_read_b64_tr_b16 a[2:3], v41 offset:61952
    s_waitcnt vmcnt(4)
    s_barrier
    s_waitcnt lgkmcnt(3)
    v_mfma_f32_16x16x32_bf16 v[16:19], a[8:11], a[60:63], v[16:19]
    ds_read_b128 a[68:71], v44 offset:16384
    ds_read_b64_tr_b16 a[4:5], v41 offset:0
    ds_read_b64_tr_b16 a[6:7], v41 offset:512
    s_nop 6
    v_cndmask_b32 v47, 0, v20, s[36:37]
    v_cndmask_b32 v47, v47, v21, s[38:39]
    v_cndmask_b32 v47, v47, v22, s[40:41]
    v_cndmask_b32 v47, v47, v23, s[42:43]
    v_mov_b32 v46, v28
    v_mov_b32 v48, v47
    s_nop 1
    v_permlane32_swap_b32 v28, v46
    v_permlane32_swap_b32 v47, v48
    v_add_f32 v46, v28, v46
    v_add_f32 v47, v47, v48
    v_mov_b32 v48, v47
    v_mul_f32 v46, 0x3ae38e39, v46
    s_nop 0
    v_permlane16_swap_b32 v47, v48
    v_add_f32 v47, v47, v48
    s_waitcnt lgkmcnt(3)
    v_mfma_f32_16x16x32_bf16 v[16:19], a[0:3], a[64:67], v[16:19]
    ds_read_b128 a[72:75], v45 offset:16384
    ds_read_b64_tr_b16 a[8:9], v41 offset:4096
    ds_read_b64_tr_b16 a[10:11], v41 offset:4608
    v_mul_f32 v48, v46, v46
    v_fma_f32 v47, v47, s58, -v48
    v_max_f32 v47, 0, v47
    v_cvt_pk_bf16_f32 v47, v47, v47
    v_and_b32 v47, 0xffff0000, v47
    v_add_f32 v47, 0x3727c5ac, v47
    v_cvt_pk_bf16_f32 v47, v47, v47
    v_and_b32 v47, 0xffff0000, v47
    s_waitcnt lgkmcnt(3)
    v_mfma_f32_16x16x32_bf16 v[16:19], a[4:7], a[68:71], v[16:19]
    v_sqrt_f32 v47, v47
    v_cvt_pk_bf16_f32 v46, v46, v46
    v_and_b32 v46, 0xffff0000, v46
    v_cvt_pk_bf16_f32 v47, v47, v47
    v_and_b32 v47, 0xffff0000, v47
    v_rcp_f32 v47, v47
    s_nop 0
    v_mul_f32 v47, 0x3eae1a93, v47
    s_waitcnt lgkmcnt(0)
    v_mfma_f32_16x16x32_bf16 v[16:19], a[8:11], a[72:75], v[16:19]
    s_mov_b64 exec, 0xffff
    ds_write_b64 v15, v[46:47]
    s_mov_b64 exec, -1
    s_branch L_qs_join
L_qs_both:
    s_add_u32 m0, s21, 16384
    s_nop 0
    buffer_load_dwordx4 v6, s[60:63], s27 offen lds
    s_add_u32 s27, s27, 73728
    s_cmp_eq_u32 s19, 3
    s_cselect_b32 s22, 663552, 0
    s_sub_u32 s27, s27, s22
    s_cmp_eq_u32 s19, 3
    s_cselect_b32 s22, 1152, 0
    s_sub_u32 s23, s23, s22
    s_sub_u32 s24, s24, s22
    s_add_u32 m0, s56, 5760
    s_nop 0
    buffer_load_dwordx4 v7, s[28:31], s23 offen offset:384 lds
    s_add_u32 m0, s25, 5760
    s_mov_b64 exec, s[64:65]
    buffer_load_dwordx4 v8, s[28:31], s24 offen offset:384 lds
    s_mov_b64 exec, -1
    s_cmp_eq_u32 s19, 4
    s_cselect_b32 s22, 1152, 0
    s_sub_u32 s23, s23, s22
    s_sub_u32 s24, s24, s22
    s_add_u32 m0, s56, 7680
    s_nop 0
    buffer_load_dwordx4 v7, s[28:31], s23 offen offset:512 lds
    s_add_u32 m0, s25, 7680
    s_mov_b64 exec, s[64:65]
    buffer_load_dwordx4 v8, s[28:31], s24 offen offset:512 lds
    s_mov_b64 exec, -1
    s_waitcnt vmcnt(18)
    s_barrier
    ds_read_b128 a[12:15], v42 offset:0
    ds_read_b128 a[44:47], v44 offset:0
    ds_read_b128 a[16:19], v43 offset:0
    ds_read_b128 a[48:51], v45 offset:0
    ds_read_b64_tr_b16 a[0:1], v41 offset:0
    ds_read_b64_tr_b16 a[2:3], v41 offset:512
    s_add_u32 m0, s21, 24576
    s_nop 0
    buffer_load_dwordx4 v6, s[60:63], s27 offen lds
    s_add_u32 s27, s27, 73728
    s_cmp_eq_u32 s19, 4
    s_cselect_b32 s22, 663552, 0
    s_sub_u32 s27, s27, s22
    s_cmp_eq_u32 s19, 5
    s_cselect_b32 s22, 1152, 0
    s_sub_u32 s23, s23, s22
    s_sub_u32 s24, s24, s22
    s_add_u32 m0, s56, 9600
    s_nop 0
    buffer_load_dwordx4 v7, s[28:31], s23 offen offset:640 lds
    s_add_u32 m0, s25, 9600
    s_mov_b64 exec, s[64:65]
    buffer_load_dwordx4 v8, s[28:31], s24 offen offset:640 lds
    s_mov_b64 exec, -1
    ds_read_b64_tr_b16 a[4:5], v41 offset:4096
    ds_read_b64_tr_b16 a[6:7], v41 offset:4608
    s_waitcnt vmcnt(16)
    s_barrier
    s_waitcnt lgkmcnt(7)
    v_mfma_f32_16x16x32_bf16 v[20:23], a[12:15], a[12:15], 0
    ds_read_b128 a[20:23], v42 offset:2048
    s_waitcnt lgkmcnt(7)
    v_mfma_f32_16x16x32_bf16 v[24:27], a[44:47], a[44:47], 0
    ds_read_b128 a[52:55], v44 offset:2048
    ds_read_b128 a[24:27], v43 offset:2048
    s_waitcnt lgkmcnt(8)
    v_smfmac_f32_16x16x64_bf16 v[28:31], v[36:39], a[12:19], v40
    ds_read_b128 a[56:59], v45 offset:2048
    s_waitcnt lgkmcnt(8)
    v_smfmac_f32_16x16x64_bf16 v[32:35], v[36:39], a[44:51], v40
    ds_read_b128 a[28:31], v42 offset:4096
    ds_read_b128 a[60:63], v44 offset:4096
    v_mfma_f32_16x16x32_bf16 v[20:23], a[16:19], a[16:19], v[20:23]
    ds_read_b64_tr_b16 a[8:9], v41 offset:8192
    v_mfma_f32_16x16x32_bf16 v[24:27], a[48:51], a[48:51], v[24:27]
    ds_read_b64_tr_b16 a[10:11], v41 offset:8704
    s_add_u32 m0, s21, 32768
    s_nop 0
    buffer_load_dwordx4 v6, s[60:63], s27 offen lds
    s_waitcnt lgkmcnt(10)
    v_mfma_f32_16x16x32_bf16 v[16:19], a[0:3], a[44:47], 0
    s_add_u32 s27, s27, 73728
    s_cmp_eq_u32 s19, 5
    s_cselect_b32 s22, 663552, 0
    s_sub_u32 s27, s27, s22
    s_cmp_eq_u32 s19, 6
    s_cselect_b32 s22, 1152, 0
    s_sub_u32 s23, s23, s22
    s_sub_u32 s24, s24, s22
    s_add_u32 m0, s56, 11520
    s_nop 0
    buffer_load_dwordx4 v7, s[28:31], s23 offen offset:768 lds
    s_add_u32 m0, s25, 11520
    s_mov_b64 exec, s[64:65]
    buffer_load_dwordx4 v8, s[28:31], s24 offen offset:768 lds
    s_mov_b64 exec, -1
    s_waitcnt lgkmcnt(8)
    v_mfma_f32_16x16x32_bf16 v[16:19], a[4:7], a[48:51], v[16:19]
    ds_read_b128 a[32:35], v43 offset:4096
    ds_read_b128 a[64:67], v45 offset:4096
    ds_read_b64_tr_b16 a[0:1], v41 offset:12288
    ds_read_b64_tr_b16 a[2:3], v41 offset:12800
    s_waitcnt vmcnt(6)
    s_barrier
    s_waitcnt lgkmcnt(11)
    v_mfma_f32_16x16x32_bf16 v[20:23], a[20:23], a[20:23], v[20:23]
    ds_read_b128 a[36:39], v42 offset:6144
    s_waitcnt lgkmcnt(11)
    v_mfma_f32_16x16x32_bf16 v[24:27], a[52:55], a[52:55], v[24:27]
    ds_read_b128 a[68:71], v44 offset:6144
    s_waitcnt lgkmcnt(11)
    v_smfmac_f32_16x16x64_bf16 v[28:31], v[36:39], a[20:27], v40
    ds_read_b128 a[40:43], v43 offset:6144
    s_waitcnt lgkmcnt(11)
    v_smfmac_f32_16x16x64_bf16 v[32:35], v[36:39], a[52:59], v40
    ds_read_b128 a[72:75], v45 offset:6144
    v_mfma_f32_16x16x32_bf16 v[20:23], a[24:27], a[24:27], v[20:23]
    ds_read_b128 a[12:15], v42 offset:8192
    ds_read_b128 a[76:79], v44 offset:8192
    v_mfma_f32_16x16x32_bf16 v[24:27], a[56:59], a[56:59], v[24:27]
    ds_read_b64_tr_b16 a[4:5], v41 offset:16384
    s_waitcnt lgkmcnt(14)
    v_mfma_f32_16x16x32_bf16 v[20:23], a[28:31], a[28:31], v[20:23]
    ds_read_b64_tr_b16 a[6:7], v41 offset:16896
    s_waitcnt lgkmcnt(14)
    v_mfma_f32_16x16x32_bf16 v[24:27], a[60:63], a[60:63], v[24:27]
    s_add_u32 m0, s21, 40960
    s_nop 0
    buffer_load_dwordx4 v6, s[60:63], s27 offen lds
    s_waitcnt lgkmcnt(12)
    v_mfma_f32_16x16x32_bf16 v[16:19], a[8:11], a[52:55], v[16:19]
    s_add_u32 s27, s27, 73728
    s_cmp_eq_u32 s19, 6
    s_cselect_b32 s22, 663552, 0
    s_sub_u32 s27, s27, s22
    s_cmp_eq_u32 s19, 7
    s_cselect_b32 s22, 1152, 0
    s_sub_u32 s23, s23, s22
    s_sub_u32 s24, s24, s22
    s_add_u32 m0, s56, 13440
    s_nop 0
    buffer_load_dwordx4 v7, s[28:31], s23 offen offset:896 lds
    s_add_u32 m0, s25, 13440
    s_mov_b64 exec, s[64:65]
    buffer_load_dwordx4 v8, s[28:31], s24 offen offset:896 lds
    s_mov_b64 exec, -1
    s_waitcnt lgkmcnt(11)
    v_smfmac_f32_16x16x64_bf16 v[28:31], v[36:39], a[28:35], v40
    s_waitcnt lgkmcnt(10)
    v_smfmac_f32_16x16x64_bf16 v[32:35], v[36:39], a[60:67], v40
    ds_read_b128 a[16:19], v43 offset:8192
    v_mfma_f32_16x16x32_bf16 v[20:23], a[32:35], a[32:35], v[20:23]
    ds_read_b128 a[80:83], v45 offset:8192
    v_mfma_f32_16x16x32_bf16 v[24:27], a[64:67], a[64:67], v[24:27]
    ds_read_b64_tr_b16 a[8:9], v41 offset:20480
    s_waitcnt lgkmcnt(11)
    v_mfma_f32_16x16x32_bf16 v[16:19], a[0:3], a[56:59], v[16:19]
    ds_read_b64_tr_b16 a[10:11], v41 offset:20992
    s_waitcnt vmcnt(6)
    s_barrier
    s_waitcnt lgkmcnt(11)
    v_mfma_f32_16x16x32_bf16 v[20:23], a[36:39], a[36:39], v[20:23]
    s_waitcnt lgkmcnt(10)
    v_mfma_f32_16x16x32_bf16 v[24:27], a[68:71], a[68:71], v[24:27]
    ds_read_b128 a[20:23], v42 offset:10240
    s_waitcnt lgkmcnt(10)
    v_smfmac_f32_16x16x64_bf16 v[28:31], v[36:39], a[36:43], v40
    ds_read_b128 a[44:47], v44 offset:10240
    s_waitcnt lgkmcnt(10)
    v_smfmac_f32_16x16x64_bf16 v[32:35], v[36:39], a[68:75], v40
    ds_read_b64_tr_b16 a[0:1], v41 offset:24576
    v_mfma_f32_16x16x32_bf16 v[20:23], a[40:43], a[40:43], v[20:23]
    v_mfma_f32_16x16x32_bf16 v[24:27], a[72:75], a[72:75], v[24:27]
    ds_read_b64_tr_b16 a[2:3], v41 offset:25088
    s_waitcnt lgkmcnt(11)
    v_mfma_f32_16x16x32_bf16 v[20:23], a[12:15], a[12:15], v[20:23]
    s_add_u32 m0, s21, 49152
    s_nop 0
    buffer_load_dwordx4 v6, s[60:63], s27 offen lds
    s_waitcnt lgkmcnt(10)
    v_mfma_f32_16x16x32_bf16 v[24:27], a[76:79], a[76:79], v[24:27]
    s_add_u32 s27, s27, 73728
    s_cmp_eq_u32 s19, 7
    s_cselect_b32 s22, 663552, 0
    s_sub_u32 s27, s27, s22
    s_cmp_eq_u32 s19, 8
    s_cselect_b32 s22, 1152, 0
    s_sub_u32 s23, s23, s22
    s_sub_u32 s24, s24, s22
    s_add_u32 m0, s56, 15360
    s_nop 0
    buffer_load_dwordx4 v7, s[28:31], s23 offen offset:1024 lds
    s_waitcnt lgkmcnt(8)
    v_mfma_f32_16x16x32_bf16 v[16:19], a[4:7], a[60:63], v[16:19]
    s_add_u32 m0, s25, 15360
    s_mov_b64 exec, s[64:65]
    buffer_load_dwordx4 v8, s[28:31], s24 offen offset:1024 lds
    s_mov_b64 exec, -1
    s_waitcnt lgkmcnt(7)
    v_smfmac_f32_16x16x64_bf16 v[28:31], v[36:39], a[12:19], v40
    s_waitcnt lgkmcnt(6)
    v_smfmac_f32_16x16x64_bf16 v[32:35], v[36:39], a[76:83], v40
    ds_read_b128 a[24:27], v43 offset:10240
    v_mfma_f32_16x16x32_bf16 v[20:23], a[16:19], a[16:19], v[20:23]
    ds_read_b128 a[48:51], v45 offset:10240
    v_mfma_f32_16x16x32_bf16 v[24:27], a[80:83], a[80:83], v[24:27]
    ds_read_b64_tr_b16 a[4:5], v41 offset:28672
    s_waitcnt lgkmcnt(7)
    v_mfma_f32_16x16x32_bf16 v[16:19], a[8:11], a[64:67], v[16:19]
    ds_read_b64_tr_b16 a[6:7], v41 offset:29184
    s_waitcnt vmcnt(6)
    s_barrier
    s_waitcnt lgkmcnt(7)
    v_mfma_f32_16x16x32_bf16 v[20:23], a[20:23], a[20:23], v[20:23]
    ds_read_b128 a[28:31], v42 offset:12288
    s_waitcnt lgkmcnt(7)
    v_mfma_f32_16x16x32_bf16 v[24:27], a[44:47], a[44:47], v[24:27]
    ds_read_b128 a[52:55], v44 offset:12288
    ds_read_b64_tr_b16 a[8:9], v41 offset:32768
    s_waitcnt lgkmcnt(7)
    v_mfma_f32_16x16x32_bf16 v[16:19], a[0:3], a[68:71], v[16:19]
    ds_read_b64_tr_b16 a[10:11], v41 offset:33280
    s_add_u32 m0, s21, 57344
    s_nop 0
    buffer_load_dwordx4 v6, s[60:63], s27 offen lds
    s_add_u32 s27, s27, 73728
    s_cmp_eq_u32 s19, 8
    s_cselect_b32 s22, 663552, 0
    s_sub_u32 s27, s27, s22
    s_waitcnt lgkmcnt(7)
    v_smfmac_f32_16x16x64_bf16 v[28:31], v[36:39], a[20:27], v40
    s_waitcnt lgkmcnt(6)
    v_smfmac_f32_16x16x64_bf16 v[32:35], v[36:39], a[44:51], v40
    ds_read_b128 a[32:35], v43 offset:12288
    v_mfma_f32_16x16x32_bf16 v[20:23], a[24:27], a[24:27], v[20:23]
    ds_read_b128 a[56:59], v45 offset:12288
    v_mfma_f32_16x16x32_bf16 v[24:27], a[48:51], a[48:51], v[24:27]
    ds_read_b64_tr_b16 a[0:1], v41 offset:36864
    s_waitcnt lgkmcnt(7)
    v_mfma_f32_16x16x32_bf16 v[16:19], a[4:7], a[72:75], v[16:19]
    ds_read_b64_tr_b16 a[2:3], v41 offset:37376
    s_waitcnt vmcnt(4)
    s_barrier
    s_waitcnt lgkmcnt(7)
    v_mfma_f32_16x16x32_bf16 v[20:23], a[28:31], a[28:31], v[20:23]
    ds_read_b128 a[36:39], v42 offset:14336
    s_waitcnt lgkmcnt(7)
    v_mfma_f32_16x16x32_bf16 v[24:27], a[52:55], a[52:55], v[24:27]
    ds_read_b128 a[60:63], v44 offset:14336
    ds_read_b64_tr_b16 a[4:5], v41 offset:40960
    s_waitcnt lgkmcnt(7)
    v_mfma_f32_16x16x32_bf16 v[16:19], a[8:11], a[76:79], v[16:19]
    ds_read_b64_tr_b16 a[6:7], v41 offset:41472
    s_add_u32 m0, s21, 0
    s_nop 0
    buffer_load_dwordx4 v6, s[60:63], s27 offen lds
    s_waitcnt lgkmcnt(7)
    v_smfmac_f32_16x16x64_bf16 v[28:31], v[36:39], a[28:35], v40
    s_waitcnt lgkmcnt(6)
    v_smfmac_f32_16x16x64_bf16 v[32:35], v[36:39], a[52:59], v40
    ds_read_b128 a[40:43], v43 offset:14336
    v_mfma_f32_16x16x32_bf16 v[20:23], a[32:35], a[32:35], v[20:23]
    ds_read_b128 a[64:67], v45 offset:14336
    v_mfma_f32_16x16x32_bf16 v[24:27], a[56:59], a[56:59], v[24:27]
    ds_read_b64_tr_b16 a[8:9], v41 offset:45056
    s_waitcnt lgkmcnt(7)
    v_mfma_f32_16x16x32_bf16 v[16:19], a[0:3], a[80:83], v[16:19]
    ds_read_b64_tr_b16 a[10:11], v41 offset:45568
    s_waitcnt vmcnt(2)
    s_barrier
    s_waitcnt lgkmcnt(7)
    v_mfma_f32_16x16x32_bf16 v[20:23], a[36:39], a[36:39], v[20:23]
    ds_read_b128 a[12:15], v42 offset:16384
    ds_read_b128 a[68:71], v44 offset:16384
    s_waitcnt lgkmcnt(8)
    v_mfma_f32_16x16x32_bf16 v[24:27], a[60:63], a[60:63], v[24:27]
    ds_read_b64_tr_b16 a[0:1], v41 offset:49152
    ds_read_b64_tr_b16 a[2:3], v41 offset:49664
    v_lshl_or_b32 v56, v60, 16, v56
    v_lshl_or_b32 v57, v61, 16, v57
    v_lshl_or_b32 v58, v62, 16, v58
    v_lshl_or_b32 v59, v63, 16, v59
    s_lshl_b32 s45, s66, 10
    s_add_u32 s45, s45, 2527232
    s_cmp_ge_u32 s66, 648
    s_cselect_b32 s45, 0x7f000000, s45
    v_lshl_add_u32 v72, v1, 4, s45
    buffer_store_dwordx4 v[56:59], v72, s[32:35], 0 offen sc1
    s_waitcnt lgkmcnt(8)
    v_mfma_f32_16x16x32_bf16 v[16:19], a[4:7], a[44:47], v[16:19]
    v_mov_b32 v64, -1
    v_mov_b32 v65, -1
    v_mov_b32 v66, -1
    v_mov_b32 v67, -1
    s_lshl_b32 s46, s59, 11
    s_cmp_lt_u32 s59, 2
    s_cselect_b32 s46, s46, 0x7f000000
    v_lshl_add_u32 v69, v1, 4, s46
    s_mul_i32 s47, s2, 3600
    s_add_u32 s47, s47, 3538944
    buffer_store_dwordx4 v[64:67], v69, s[32:35], s47 offen sc1
    v_cmp_gt_u32 vcc, 2576, v69
    v_mov_b32 v68, 0x7f000000
    v_lshrrev_b32 v70, 3, v1
    v_cndmask_b32 v69, v68, v69, vcc
    buffer_store_dwordx4 v[64:67], v69, s[32:35], s47 offen offset:1024 sc1
    s_mov_b32 s50, 33024
    v_mul_lo_u32 v70, s50, v70
    v_and_b32 v71, 7, v1
    s_cmp_eq_u32 s59, 2
    s_cselect_b32 s46, 0, 0x7f000000
    v_lshl_add_u32 v71, v71, 4, s46
    v_add_u32 v70, v71, v70
    s_lshl_b32 s47, s26, 7
    s_add_u32 s47, s47, 3211264
    buffer_store_dwordx4 v[64:67], v70, s[32:35], s47 offen sc1
    s_waitcnt lgkmcnt(7)
    v_smfmac_f32_16x16x64_bf16 v[28:31], v[36:39], a[36:43], v40
    s_waitcnt lgkmcnt(6)
    v_smfmac_f32_16x16x64_bf16 v[32:35], v[36:39], a[60:67], v40
    ds_read_b128 a[16:19], v43 offset:16384
    v_mfma_f32_16x16x32_bf16 v[20:23], a[40:43], a[40:43], v[20:23]
    ds_read_b128 a[72:75], v45 offset:16384
    v_mfma_f32_16x16x32_bf16 v[24:27], a[64:67], a[64:67], v[24:27]
    ds_read_b64_tr_b16 a[4:5], v41 offset:53248
    s_waitcnt lgkmcnt(7)
    v_mfma_f32_16x16x32_bf16 v[16:19], a[8:11], a[48:51], v[16:19]
    ds_read_b64_tr_b16 a[6:7], v41 offset:53760
    s_waitcnt vmcnt(5)
    s_barrier
    s_waitcnt lgkmcnt(7)
    v_mfma_f32_16x16x32_bf16 v[20:23], a[12:15], a[12:15], v[20:23]
    s_waitcnt lgkmcnt(6)
    v_mfma_f32_16x16x32_bf16 v[24:27], a[68:71], a[68:71], v[24:27]
    ds_read_b64_tr_b16 a[8:9], v41 offset:57344
    s_waitcnt lgkmcnt(5)
    v_mfma_f32_16x16x32_bf16 v[16:19], a[0:3], a[52:55], v[16:19]
    ds_read_b64_tr_b16 a[10:11], v41 offset:57856
    s_waitcnt lgkmcnt(5)
    v_smfmac_f32_16x16x64_bf16 v[28:31], v[36:39], a[12:19], v40
    s_waitcnt lgkmcnt(4)
    v_smfmac_f32_16x16x64_bf16 v[32:35], v[36:39], a[68:75], v40
    v_mfma_f32_16x16x32_bf16 v[20:23], a[16:19], a[16:19], v[20:23]
    ds_read_b64_tr_b16 a[0:1], v41 offset:61440
    v_mfma_f32_16x16x32_bf16 v[24:27], a[72:75], a[72:75], v[24:27]
    s_waitcnt lgkmcnt(3)
    v_mfma_f32_16x16x32_bf16 v[16:19], a[4:7], a[56:59], v[16:19]
    ds_read_b64_tr_b16 a[2:3], v41 offset:61952
    s_waitcnt vmcnt(4)
    s_barrier
    s_waitcnt lgkmcnt(2)
    v_mfma_f32_16x16x32_bf16 v[16:19], a[8:11], a[60:63], v[16:19]
    ds_read_b64_tr_b16 a[4:5], v41 offset:0
    ds_read_b64_tr_b16 a[6:7], v41 offset:512
    s_nop 6
    v_cndmask_b32 v47, 0, v20, s[36:37]
    v_cndmask_b32 v51, 0, v24, s[36:37]
    v_cndmask_b32 v47, v47, v21, s[38:39]
    v_cndmask_b32 v51, v51, v25, s[38:39]
    v_cndmask_b32 v47, v47, v22, s[40:41]
    v_cndmask_b32 v51, v51, v26, s[40:41]
    v_cndmask_b32 v47, v47, v23, s[42:43]
    v_cndmask_b32 v51, v51, v27, s[42:43]
    v_mov_b32 v46, v28
    v_mov_b32 v50, v32
    v_mov_b32 v48, v47
    v_mov_b32 v52, v51
    v_permlane32_swap_b32 v28, v46
    v_permlane32_swap_b32 v32, v50
    v_permlane32_swap_b32 v47, v48
    v_permlane32_swap_b32 v51, v52
    v_add_f32 v46, v28, v46
    v_add_f32 v50, v32, v50
    v_add_f32 v47, v47, v48
    v_add_f32 v51, v51, v52
    v_mov_b32 v48, v47
    v_mov_b32 v52, v51
    v_mul_f32 v46, 0x3ae38e39, v46
    v_mul_f32 v50, 0x3ae38e39, v50
    v_permlane16_swap_b32 v47, v48
    v_permlane16_swap_b32 v51, v52
    v_add_f32 v47, v47, v48
    v_add_f32 v51, v51, v52
    s_waitcnt lgkmcnt(2)
    v_mfma_f32_16x16x32_bf16 v[16:19], a[0:3], a[64:67], v[16:19]
    ds_read_b64_tr_b16 a[8:9], v41 offset:4096
    ds_read_b64_tr_b16 a[10:11], v41 offset:4608
    v_mul_f32 v48, v46, v46
    v_mul_f32 v52, v50, v50
    v_fma_f32 v47, v47, s58, -v48
    v_fma_f32 v51, v51, s58, -v52
    v_max_f32 v47, 0, v47
    v_max_f32 v51, 0, v51
    v_cvt_pk_bf16_f32 v47, v47, v47
    v_cvt_pk_bf16_f32 v51, v51, v51
    v_and_b32 v47, 0xffff0000, v47
    v_and_b32 v51, 0xffff0000, v51
    v_add_f32 v47, 0x3727c5ac, v47
    v_add_f32 v51, 0x3727c5ac, v51
    v_cvt_pk_bf16_f32 v47, v47, v47
    v_cvt_pk_bf16_f32 v51, v51, v51
    v_and_b32 v47, 0xffff0000, v47
    s_waitcnt lgkmcnt(2)
    v_mfma_f32_16x16x32_bf16 v[16:19], a[4:7], a[68:71], v[16:19]
    v_and_b32 v51, 0xffff0000, v51
    v_sqrt_f32 v47, v47
    v_sqrt_f32 v51, v51
    v_cvt_pk_bf16_f32 v46, v46, v46
    v_cvt_pk_bf16_f32 v50, v50, v50
    v_and_b32 v46, 0xffff0000, v46
    v_and_b32 v50, 0xffff0000, v50
    v_cvt_pk_bf16_f32 v47, v47, v47
    v_cvt_pk_bf16_f32 v51, v51, v51
    v_and_b32 v47, 0xffff0000, v47
    v_and_b32 v51, 0xffff0000, v51
    v_rcp_f32 v47, v47
    v_rcp_f32 v51, v51
    v_mul_f32 v47, 0x3eae1a93, v47
    v_mul_f32 v51, 0x3eae1a93, v51
    s_waitcnt lgkmcnt(0)
    v_mfma_f32_16x16x32_bf16 v[16:19], a[8:11], a[72:75], v[16:19]
    s_mov_b64 exec, 0xffff
    ds_write_b64 v15, v[46:47]
    ds_write_b64 v15, v[50:51] offset:128
    s_mov_b64 exec, -1
L_qs_join:
    s_mov_b32 s48, 0x80008000
    s_mov_b32 s49, 0x80008000
    s_mov_b64 exec, s[48:49]
    s_nop 1
    ds_write_b128 v14, v[16:19]
    s_mov_b64 exec, -1
    s_mov_b32 s46, 162688
    v_lshl_add_u32 v15, v2, 3, s46
    s_waitcnt lgkmcnt(0)
    s_barrier
    ds_read_b64 v[50:51], v15
    v_lshrrev_b32 v9, 3, v1
    v_and_b32 v10, 7, v1
    s_lshl_b32 s46, s16, 3
    v_add_u32 v9, s46, v9
    v_mul_u32_u24 v11, 144, v9
    v_lshl_add_u32 v11, v10, 4, v11
    v_mul_u32_u24 v12, 1152, v9
    v_lshl_add_u32 v12, v10, 4, v12
    s_mul_i32 s46, s20, 1152
    s_lshl_b32 s47, s18, 7
    s_add_u32 s46, s46, s47
    v_add_u32 v12, s46, v12
    v_add_u32 v13, 73728, v12
    s_mov_b32 s52, s6
    s_mov_b32 s53, s7
    s_mov_b32 s54, 2359296
    s_mov_b32 s55, 0x20000
    v_mov_b32_dpp v52, v16 row_newbcast:15 row_mask:0xf bank_mask:0xf
    v_mov_b32_dpp v53, v17 row_newbcast:15 row_mask:0xf bank_mask:0xf
    v_mov_b32_dpp v54, v18 row_newbcast:15 row_mask:0xf bank_mask:0xf
    v_mov_b32_dpp v55, v19 row_newbcast:15 row_mask:0xf bank_mask:0xf
    s_waitcnt lgkmcnt(0)
    v_fma_f32 v16, -v50, v52, v16
    v_fma_f32 v17, -v50, v53, v17
    v_fma_f32 v18, -v50, v54, v18
    v_fma_f32 v19, -v50, v55, v19
    v_mul_f32 v16, v51, v16
    v_mul_f32 v17, v51, v17
    v_mul_f32 v18, v51, v18
    v_mul_f32 v19, v51, v19
    v_cvt_pk_bf16_f32 v52, v16, v17
    v_cvt_pk_bf16_f32 v53, v18, v19
    ds_write_b64 v5, v[52:53]
L_q_out:
    s_waitcnt lgkmcnt(0)
    s_barrier
    ds_read_b128 v[4:7], v11
    ds_read_b128 v[16:19], v11 offset:9216
    v_cmp_gt_u32 vcc, 15, v9
    s_waitcnt lgkmcnt(1)
    buffer_store_dwordx4 v[4:7], v12, s[52:55], 0 offen sc1
    s_and_b64 exec, exec, vcc
    s_cbranch_execz L_q_out2
    s_waitcnt lgkmcnt(0)
    buffer_store_dwordx4 v[16:19], v13, s[52:55], 0 offen sc1
L_q_out2:
    s_mov_b64 exec, -1
    v_mov_b32 v29, 0
    s_branch L_p1done
L_k1_kv:
    s_sub_u32 s17, s21, s24
    s_add_u32 s17, s17, s23
    s_add_u32 s26, s17, 234
    s_sub_u32 s19, s21, s24
    s_mul_i32 s18, s19, 3
    s_sub_u32 s19, 9, s18
    s_cmp_ge_u32 s16, 6
    s_cbranch_scc1 L_k1_hkv
    v_lshrrev_b32 v9, 3, v1
    v_and_b32 v10, 7, v1
    v_lshrrev_b32 v11, 1, v9
    v_xor_b32 v11, v11, v10
    v_mul_u32_u24 v6, 1152, v9
    v_lshl_add_u32 v6, v11, 4, v6
    v_xor_b32 v7, 64, v6
    v_add_u32 v7, 9216, v7
    s_mul_i32 s20, s17, 96
    s_lshl_b32 s21, s16, 4
    s_add_u32 s20, s20, s21
    s_add_u32 s23, s20, 1
    s_mul_i32 s23, s23, 1152
    s_lshl_b32 s22, s18, 7
    s_add_u32 s23, s23, s22
    s_mul_i32 s21, s16, 18432
    s_add_u32 s21, s21, 51328
    s_setprio 3
    s_waitcnt lgkmcnt(0)
    s_sub_u32 s28, s28, 1152
    s_subb_u32 s29, s29, 0
    s_add_u32 m0, s21, 0
    s_nop 0
    buffer_load_dwordx4 v6, s[28:31], s23 offen offset:0 lds
    s_add_u32 m0, s21, 1024
    s_nop 0
    buffer_load_dwordx4 v7, s[28:31], s23 offen offset:0 lds
    s_cmp_lg_u32 s16, 0
    s_cbranch_scc1 L_nopf2
    s_getpc_b64 s[36:37]
L_pf2:
    s_sub_u32 s36, s36, L_pf2 - L_entry
    s_subb_u32 s37, s37, 0
    s_lshr_b32 s38, s2, 3
    s_mul_i32 s38, s38, ((L_slow - L_entry + 4095) / 4096) * 128
    v_lshl_add_u32 v2, v1, 7, s38
    s_bfm_b64 exec, (L_slow - L_entry + 4095) / 4096, 0
    global_load_dword v83, v2, s[36:37]
    s_mov_b64 exec, -1
L_nopf2:
    s_setprio 2
    s_cmp_eq_u32 s19, 1
    s_cselect_b32 s22, 1152, 0
    s_sub_u32 s23, s23, s22
    s_add_u32 m0, s21, 1920
    s_nop 0
    buffer_load_dwordx4 v6, s[28:31], s23 offen offset:128 lds
    s_add_u32 m0, s21, 2944
    s_nop 0
    buffer_load_dwordx4 v7, s[28:31], s23 offen offset:128 lds
    s_setprio 0
    v_and_b32 v2, 15, v1
    v_lshrrev_b32 v3, 4, v1
    v_mov_b32 v40, 0x3f803f80
    v_mov_b32 v41, 0x3f803f80
    v_mov_b32 v42, 0x3f803f80
    v_mov_b32 v43, 0x3f803f80
    v_mov_b32 v36, 0
    v_mov_b32 v37, 0
    v_mov_b32 v38, 0
    v_mov_b32 v39, 0
    v_mov_b32 v44, 0x4444
    v_mov_b32 v12, 0xeeee
    v_cmp_lt_u32 vcc, 7, v2
    s_mov_b32 s36, 0x00100001
    s_mov_b32 s37, 0x10000100
    v_cndmask_b32 v44, v44, v12, vcc
    s_lshl_b64 s[38:39], s[36:37], 1
    s_lshl_b64 s[40:41], s[36:37], 2
    s_lshl_b64 s[42:43], s[36:37], 3
    s_mov_b32 s58, 0x3ae38e39
    v_lshrrev_b32 v11, 1, v2
    v_xor_b32 v11, v11, v3
    v_lshlrev_b32 v11, 4, v11
    v_lshl_add_u32 v11, v2, 7, v11
    v_add_u32 v48, s21, v11
    v_xor_b32 v49, 64, v48
    v_bfe_u32 v12, v1, 2, 2
    v_and_b32 v13, 3, v1
    v_lshrrev_b32 v9, 1, v3
    v_lshlrev_b32 v9, 4, v9
    v_and_b32 v10, 1, v3
    v_lshl_add_u32 v9, v10, 2, v9
    v_add_u32 v9, v9, v12
    v_lshlrev_b32 v9, 5, v9
    v_lshl_add_u32 v46, v13, 3, v9
    v_lshl_add_u32 v9, v3, 3, v12
    v_lshlrev_b32 v9, 4, v9
    v_and_b32 v10, 1, v13
    v_lshl_add_u32 v9, v10, 3, v9
    v_lshrrev_b32 v10, 1, v13
    v_mul_u32_u24 v10, 9280, v10
    v_add_u32 v47, v9, v10
    s_add_u32 s32, s6, 0x240000
    s_addc_u32 s33, s7, 0
    s_mov_b32 s34, 0x29000
    s_mov_b32 s35, 0x20000
    s_mov_b32 s47, 161920
    v_lshl_add_u32 v51, v3, 4, s47
    s_lshr_b32 s46, s16, 1
    s_mul_i32 s46, s46, 2304
    s_and_b32 s47, s16, 1
    s_lshl_b32 s47, s47, 4
    v_add_u32 v4, s47, v2
    v_lshl_add_u32 v54, v4, 4, s46
    v_lshrrev_b32 v55, 1, v3
    v_lshl_add_u32 v54, v55, 9, v54
    v_and_b32 v55, 1, v3
    v_lshl_add_u32 v54, v55, 3, v54
    v_lshrrev_b32 v55, 3, v4
    v_mul_u32_u24 v55, 288, v55
    v_add_u32 v55, s46, v55
    v_and_b32 v56, 7, v4
    v_lshl_add_u32 v55, v56, 1, v55
    v_lshl_add_u32 v57, v3, 6, v55
    v_lshl_add_u32 v58, v4, 2, s46
    s_cmp_eq_u32 s19, 2
    s_cselect_b32 s22, 1152, 0
    s_sub_u32 s23, s23, s22
    s_add_u32 m0, s21, 3840
    s_nop 0
    buffer_load_dwordx4 v6, s[28:31], s23 offen offset:256 lds
    s_add_u32 m0, s21, 4864
    s_nop 0
    buffer_load_dwordx4 v7, s[28:31], s23 offen offset:256 lds
    s_waitcnt vmcnt(4)
    s_barrier
    ds_read_b128 a[36:39], v48 offset:0
    ds_read_b64_tr_b16 a[0:1], v46 offset:0
    ds_read_b64_tr_b16 a[2:3], v46 offset:256
    ds_read_b64_tr_b16 a[4:5], v46 offset:16384
    ds_read_b64_tr_b16 a[6:7], v46 offset:16640
    ds_read_b64_tr_b16 a[8:9], v47 offset:32768
    ds_read_b64_tr_b16 a[10:11], v47 offset:32832
    s_cmp_eq_u32 s19, 3
    s_cselect_b32 s22, 1152, 0
    s_sub_u32 s23, s23, s22
    s_add_u32 m0, s21, 5760
    s_nop 0
    buffer_load_dwordx4 v6, s[28:31], s23 offen offset:384 lds
    s_add_u32 m0, s21, 6784
    s_nop 0
    buffer_load_dwordx4 v7, s[28:31], s23 offen offset:384 lds
    ds_read_b128 a[40:43], v49 offset:0
    ds_read_b64_tr_b16 a[12:13], v46 offset:1024
    ds_read_b64_tr_b16 a[14:15], v46 offset:1280
    ds_read_b64_tr_b16 a[16:17], v46 offset:17408
    ds_read_b64_tr_b16 a[18:19], v46 offset:17664
    ds_read_b64_tr_b16 a[20:21], v47 offset:33280
    ds_read_b64_tr_b16 a[22:23], v47 offset:33344
    s_waitcnt vmcnt(4)
    s_barrier
    s_waitcnt lgkmcnt(13)
    v_mfma_f32_16x16x32_bf16 v[32:35], a[36:39], a[36:39], 0
    ds_read_b128 a[44:47], v48 offset:2048
    ds_read_b64_tr_b16 a[24:25], v46 offset:2048
    s_waitcnt lgkmcnt(13)
    v_mfma_f32_16x16x32_bf16 v[16:19], a[0:3], a[36:39], 0
    ds_read_b64_tr_b16 a[26:27], v46 offset:2304
    ds_read_b64_tr_b16 a[28:29], v46 offset:18432
    s_waitcnt lgkmcnt(13)
    v_mfma_f32_16x16x32_bf16 v[20:23], a[4:7], a[36:39], 0
    ds_read_b64_tr_b16 a[30:31], v46 offset:18688
    ds_read_b64_tr_b16 a[32:33], v47 offset:33792
    s_waitcnt lgkmcnt(13)
    v_mfma_f32_16x16x32_bf16 v[24:27], a[8:11], a[36:39], 0
    ds_read_b64_tr_b16 a[34:35], v47 offset:33856
    s_cmp_eq_u32 s19, 4
    s_cselect_b32 s22, 1152, 0
    s_sub_u32 s23, s23, s22
    s_add_u32 m0, s21, 7680
    s_nop 0
    buffer_load_dwordx4 v6, s[28:31], s23 offen offset:512 lds
    s_add_u32 m0, s21, 8704
    s_nop 0
    buffer_load_dwordx4 v7, s[28:31], s23 offen offset:512 lds
    s_waitcnt lgkmcnt(13)
    v_smfmac_f32_16x16x64_bf16 v[36:39], v[40:43], a[36:43], v44
    ds_read_b128 a[48:51], v49 offset:2048
    v_mfma_f32_16x16x32_bf16 v[32:35], a[40:43], a[40:43], v[32:35]
    ds_read_b64_tr_b16 a[0:1], v46 offset:3072
    s_waitcnt lgkmcnt(13)
    v_mfma_f32_16x16x32_bf16 v[16:19], a[12:15], a[40:43], v[16:19]
    ds_read_b64_tr_b16 a[2:3], v46 offset:3328
    ds_read_b64_tr_b16 a[4:5], v46 offset:19456
    s_waitcnt lgkmcnt(13)
    v_mfma_f32_16x16x32_bf16 v[20:23], a[16:19], a[40:43], v[20:23]
    ds_read_b64_tr_b16 a[6:7], v46 offset:19712
    s_waitcnt lgkmcnt(12)
    v_mfma_f32_16x16x32_bf16 v[24:27], a[20:23], a[40:43], v[24:27]
    ds_read_b64_tr_b16 a[8:9], v47 offset:34304
    ds_read_b64_tr_b16 a[10:11], v47 offset:34368
    s_waitcnt vmcnt(4)
    s_barrier
    s_waitcnt lgkmcnt(13)
    v_mfma_f32_16x16x32_bf16 v[32:35], a[44:47], a[44:47], v[32:35]
    ds_read_b128 a[36:39], v48 offset:4096
    ds_read_b64_tr_b16 a[12:13], v46 offset:4096
    s_waitcnt lgkmcnt(13)
    v_mfma_f32_16x16x32_bf16 v[16:19], a[24:27], a[44:47], v[16:19]
    ds_read_b64_tr_b16 a[14:15], v46 offset:4352
    ds_read_b64_tr_b16 a[16:17], v46 offset:20480
    s_waitcnt lgkmcnt(13)
    v_mfma_f32_16x16x32_bf16 v[20:23], a[28:31], a[44:47], v[20:23]
    ds_read_b64_tr_b16 a[18:19], v46 offset:20736
    ds_read_b64_tr_b16 a[20:21], v47 offset:34816
    s_waitcnt lgkmcnt(13)
    v_mfma_f32_16x16x32_bf16 v[24:27], a[32:35], a[44:47], v[24:27]
    ds_read_b64_tr_b16 a[22:23], v47 offset:34880
    s_cmp_eq_u32 s19, 5
    s_cselect_b32 s22, 1152, 0
    s_sub_u32 s23, s23, s22
    s_add_u32 m0, s21, 9600
    s_nop 0
    buffer_load_dwordx4 v6, s[28:31], s23 offen offset:640 lds
    s_add_u32 m0, s21, 10624
    s_nop 0
    buffer_load_dwordx4 v7, s[28:31], s23 offen offset:640 lds
    s_waitcnt lgkmcnt(13)
    v_smfmac_f32_16x16x64_bf16 v[36:39], v[40:43], a[44:51], v44
    ds_read_b128 a[40:43], v49 offset:4096
    v_mfma_f32_16x16x32_bf16 v[32:35], a[48:51], a[48:51], v[32:35]
    ds_read_b64_tr_b16 a[24:25], v46 offset:5120
    s_waitcnt lgkmcnt(13)
    v_mfma_f32_16x16x32_bf16 v[16:19], a[0:3], a[48:51], v[16:19]
    ds_read_b64_tr_b16 a[26:27], v46 offset:5376
    ds_read_b64_tr_b16 a[28:29], v46 offset:21504
    s_waitcnt lgkmcnt(13)
    v_mfma_f32_16x16x32_bf16 v[20:23], a[4:7], a[48:51], v[20:23]
    ds_read_b64_tr_b16 a[30:31], v46 offset:21760
    s_waitcnt lgkmcnt(12)
    v_mfma_f32_16x16x32_bf16 v[24:27], a[8:11], a[48:51], v[24:27]
    ds_read_b64_tr_b16 a[32:33], v47 offset:35328
    ds_read_b64_tr_b16 a[34:35], v47 offset:35392
    s_waitcnt vmcnt(4)
    s_barrier
    s_waitcnt lgkmcnt(13)
    v_mfma_f32_16x16x32_bf16 v[32:35], a[36:39], a[36:39], v[32:35]
    ds_read_b128 a[44:47], v48 offset:6144
    ds_read_b64_tr_b16 a[0:1], v46 offset:6144
    s_waitcnt lgkmcnt(13)
    v_mfma_f32_16x16x32_bf16 v[16:19], a[12:15], a[36:39], v[16:19]
    ds_read_b64_tr_b16 a[2:3], v46 offset:6400
    ds_read_b64_tr_b16 a[4:5], v46 offset:22528
    s_waitcnt lgkmcnt(13)
    v_mfma_f32_16x16x32_bf16 v[20:23], a[16:19], a[36:39], v[20:23]
    ds_read_b64_tr_b16 a[6:7], v46 offset:22784
    ds_read_b64_tr_b16 a[8:9], v47 offset:35840
    s_waitcnt lgkmcnt(13)
    v_mfma_f32_16x16x32_bf16 v[24:27], a[20:23], a[36:39], v[24:27]
    ds_read_b64_tr_b16 a[10:11], v47 offset:35904
    s_cmp_eq_u32 s19, 6
    s_cselect_b32 s22, 1152, 0
    s_sub_u32 s23, s23, s22
    s_add_u32 m0, s21, 11520
    s_nop 0
    buffer_load_dwordx4 v6, s[28:31], s23 offen offset:768 lds
    s_add_u32 m0, s21, 12544
    s_nop 0
    buffer_load_dwordx4 v7, s[28:31], s23 offen offset:768 lds
    s_waitcnt lgkmcnt(13)
    v_smfmac_f32_16x16x64_bf16 v[36:39], v[40:43], a[36:43], v44
    ds_read_b128 a[48:51], v49 offset:6144
    v_mfma_f32_16x16x32_bf16 v[32:35], a[40:43], a[40:43], v[32:35]
    ds_read_b64_tr_b16 a[12:13], v46 offset:7168
    s_waitcnt lgkmcnt(13)
    v_mfma_f32_16x16x32_bf16 v[16:19], a[24:27], a[40:43], v[16:19]
    ds_read_b64_tr_b16 a[14:15], v46 offset:7424
    ds_read_b64_tr_b16 a[16:17], v46 offset:23552
    s_waitcnt lgkmcnt(13)
    v_mfma_f32_16x16x32_bf16 v[20:23], a[28:31], a[40:43], v[20:23]
    ds_read_b64_tr_b16 a[18:19], v46 offset:23808
    s_waitcnt lgkmcnt(12)
    v_mfma_f32_16x16x32_bf16 v[24:27], a[32:35], a[40:43], v[24:27]
    ds_read_b64_tr_b16 a[20:21], v47 offset:36352
    ds_read_b64_tr_b16 a[22:23], v47 offset:36416
    s_waitcnt vmcnt(4)
    s_barrier
    s_waitcnt lgkmcnt(13)
    v_mfma_f32_16x16x32_bf16 v[32:35], a[44:47], a[44:47], v[32:35]
    ds_read_b128 a[36:39], v48 offset:8192
    ds_read_b64_tr_b16 a[24:25], v46 offset:8192
    s_waitcnt lgkmcnt(13)
    v_mfma_f32_16x16x32_bf16 v[16:19], a[0:3], a[44:47], v[16:19]
    ds_read_b64_tr_b16 a[26:27], v46 offset:8448
    ds_read_b64_tr_b16 a[28:29], v46 offset:24576
    s_waitcnt lgkmcnt(13)
    v_mfma_f32_16x16x32_bf16 v[20:23], a[4:7], a[44:47], v[20:23]
    ds_read_b64_tr_b16 a[30:31], v46 offset:24832
    ds_read_b64_tr_b16 a[32:33], v47 offset:36864
    s_waitcnt lgkmcnt(13)
    v_mfma_f32_16x16x32_bf16 v[24:27], a[8:11], a[44:47], v[24:27]
    ds_read_b64_tr_b16 a[34:35], v47 offset:36928
    s_cmp_eq_u32 s19, 7
    s_cselect_b32 s22, 1152, 0
    s_sub_u32 s23, s23, s22
    s_add_u32 m0, s21, 13440
    s_nop 0
    buffer_load_dwordx4 v6, s[28:31], s23 offen offset:896 lds
    s_add_u32 m0, s21, 14464
    s_nop 0
    buffer_load_dwordx4 v7, s[28:31], s23 offen offset:896 lds
    s_waitcnt lgkmcnt(13)
    v_smfmac_f32_16x16x64_bf16 v[36:39], v[40:43], a[44:51], v44
    ds_read_b128 a[40:43], v49 offset:8192
    v_mfma_f32_16x16x32_bf16 v[32:35], a[48:51], a[48:51], v[32:35]
    ds_read_b64_tr_b16 a[0:1], v46 offset:9216
    s_waitcnt lgkmcnt(13)
    v_mfma_f32_16x16x32_bf16 v[16:19], a[12:15], a[48:51], v[16:19]
    ds_read_b64_tr_b16 a[2:3], v46 offset:9472
    ds_read_b64_tr_b16 a[4:5], v46 offset:25600
    s_waitcnt lgkmcnt(13)
    v_mfma_f32_16x16x32_bf16 v[20:23], a[16:19], a[48:51], v[20:23]
    ds_read_b64_tr_b16 a[6:7], v46 offset:25856
    s_waitcnt lgkmcnt(12)
    v_mfma_f32_16x16x32_bf16 v[24:27], a[20:23], a[48:51], v[24:27]
    ds_read_b64_tr_b16 a[8:9], v47 offset:37376
    ds_read_b64_tr_b16 a[10:11], v47 offset:37440
    s_waitcnt vmcnt(4)
    s_barrier
    s_waitcnt lgkmcnt(13)
    v_mfma_f32_16x16x32_bf16 v[32:35], a[36:39], a[36:39], v[32:35]
    ds_read_b128 a[44:47], v48 offset:10240
    ds_read_b64_tr_b16 a[12:13], v46 offset:10240
    s_waitcnt lgkmcnt(13)
    v_mfma_f32_16x16x32_bf16 v[16:19], a[24:27], a[36:39], v[16:19]
    ds_read_b64_tr_b16 a[14:15], v46 offset:10496
    ds_read_b64_tr_b16 a[16:17], v46 offset:26624
    s_waitcnt lgkmcnt(13)
    v_mfma_f32_16x16x32_bf16 v[20:23], a[28:31], a[36:39], v[20:23]
    ds_read_b64_tr_b16 a[18:19], v46 offset:26880
    ds_read_b64_tr_b16 a[20:21], v47 offset:37888
    s_waitcnt lgkmcnt(13)
    v_mfma_f32_16x16x32_bf16 v[24:27], a[32:35], a[36:39], v[24:27]
    ds_read_b64_tr_b16 a[22:23], v47 offset:37952
    s_cmp_eq_u32 s19, 8
    s_cselect_b32 s22, 1152, 0
    s_sub_u32 s23, s23, s22
    s_add_u32 m0, s21, 15360
    s_nop 0
    buffer_load_dwordx4 v6, s[28:31], s23 offen offset:1024 lds
    s_add_u32 m0, s21, 16384
    s_nop 0
    buffer_load_dwordx4 v7, s[28:31], s23 offen offset:1024 lds
    s_waitcnt lgkmcnt(13)
    v_smfmac_f32_16x16x64_bf16 v[36:39], v[40:43], a[36:43], v44
    ds_read_b128 a[48:51], v49 offset:10240
    v_mfma_f32_16x16x32_bf16 v[32:35], a[40:43], a[40:43], v[32:35]
    ds_read_b64_tr_b16 a[24:25], v46 offset:11264
    s_waitcnt lgkmcnt(13)
    v_mfma_f32_16x16x32_bf16 v[16:19], a[0:3], a[40:43], v[16:19]
    ds_read_b64_tr_b16 a[26:27], v46 offset:11520
    ds_read_b64_tr_b16 a[28:29], v46 offset:27648
    s_waitcnt lgkmcnt(13)
    v_mfma_f32_16x16x32_bf16 v[20:23], a[4:7], a[40:43], v[20:23]
    ds_read_b64_tr_b16 a[30:31], v46 offset:27904
    s_waitcnt lgkmcnt(12)
    v_mfma_f32_16x16x32_bf16 v[24:27], a[8:11], a[40:43], v[24:27]
    ds_read_b64_tr_b16 a[32:33], v47 offset:38400
    ds_read_b64_tr_b16 a[34:35], v47 offset:38464
    s_waitcnt vmcnt(4)
    s_barrier
    s_waitcnt lgkmcnt(13)
    v_mfma_f32_16x16x32_bf16 v[32:35], a[44:47], a[44:47], v[32:35]
    ds_read_b128 a[36:39], v48 offset:12288
    s_waitcnt lgkmcnt(12)
    v_mfma_f32_16x16x32_bf16 v[16:19], a[12:15], a[44:47], v[16:19]
    ds_read_b64_tr_b16 a[0:1], v46 offset:12288
    ds_read_b64_tr_b16 a[2:3], v46 offset:12544
    s_waitcnt lgkmcnt(12)
    v_mfma_f32_16x16x32_bf16 v[20:23], a[16:19], a[44:47], v[20:23]
    ds_read_b64_tr_b16 a[4:5], v46 offset:28672
    ds_read_b64_tr_b16 a[6:7], v46 offset:28928
    s_waitcnt lgkmcnt(12)
    v_mfma_f32_16x16x32_bf16 v[24:27], a[20:23], a[44:47], v[24:27]
    ds_read_b64_tr_b16 a[8:9], v47 offset:38912
    ds_read_b64_tr_b16 a[10:11], v47 offset:38976
    s_waitcnt lgkmcnt(13)
    v_smfmac_f32_16x16x64_bf16 v[36:39], v[40:43], a[44:51], v44
    ds_read_b128 a[40:43], v49 offset:12288
    v_mfma_f32_16x16x32_bf16 v[32:35], a[48:51], a[48:51], v[32:35]
    ds_read_b64_tr_b16 a[12:13], v46 offset:13312
    s_waitcnt lgkmcnt(13)
    v_mfma_f32_16x16x32_bf16 v[16:19], a[24:27], a[48:51], v[16:19]
    ds_read_b64_tr_b16 a[14:15], v46 offset:13568
    ds_read_b64_tr_b16 a[16:17], v46 offset:29696
    s_waitcnt lgkmcnt(13)
    v_mfma_f32_16x16x32_bf16 v[20:23], a[28:31], a[48:51], v[20:23]
    ds_read_b64_tr_b16 a[18:19], v46 offset:29952
    s_waitcnt lgkmcnt(12)
    v_mfma_f32_16x16x32_bf16 v[24:27], a[32:35], a[48:51], v[24:27]
    ds_read_b64_tr_b16 a[20:21], v47 offset:39424
    ds_read_b64_tr_b16 a[22:23], v47 offset:39488
    s_waitcnt vmcnt(2)
    s_barrier
    s_waitcnt lgkmcnt(13)
    v_mfma_f32_16x16x32_bf16 v[32:35], a[36:39], a[36:39], v[32:35]
    ds_read_b128 a[44:47], v48 offset:14336
    s_waitcnt lgkmcnt(12)
    v_mfma_f32_16x16x32_bf16 v[16:19], a[0:3], a[36:39], v[16:19]
    ds_read_b64_tr_b16 a[24:25], v46 offset:14336
    ds_read_b64_tr_b16 a[26:27], v46 offset:14592
    s_waitcnt lgkmcnt(12)
    v_mfma_f32_16x16x32_bf16 v[20:23], a[4:7], a[36:39], v[20:23]
    ds_read_b64_tr_b16 a[28:29], v46 offset:30720
    ds_read_b64_tr_b16 a[30:31], v46 offset:30976
    s_waitcnt lgkmcnt(12)
    v_mfma_f32_16x16x32_bf16 v[24:27], a[8:11], a[36:39], v[24:27]
    ds_read_b64_tr_b16 a[32:33], v47 offset:39936
    ds_read_b64_tr_b16 a[34:35], v47 offset:40000
    s_waitcnt lgkmcnt(13)
    v_smfmac_f32_16x16x64_bf16 v[36:39], v[40:43], a[36:43], v44
    ds_read_b128 a[48:51], v49 offset:14336
    v_mfma_f32_16x16x32_bf16 v[32:35], a[40:43], a[40:43], v[32:35]
    ds_read_b64_tr_b16 a[0:1], v46 offset:15360
    s_waitcnt lgkmcnt(13)
    v_mfma_f32_16x16x32_bf16 v[16:19], a[12:15], a[40:43], v[16:19]
    ds_read_b64_tr_b16 a[2:3], v46 offset:15616
    ds_read_b64_tr_b16 a[4:5], v46 offset:31744
    s_waitcnt lgkmcnt(13)
    v_mfma_f32_16x16x32_bf16 v[20:23], a[16:19], a[40:43], v[20:23]
    ds_read_b64_tr_b16 a[6:7], v46 offset:32000
    s_waitcnt lgkmcnt(12)
    v_mfma_f32_16x16x32_bf16 v[24:27], a[20:23], a[40:43], v[24:27]
    ds_read_b64_tr_b16 a[8:9], v47 offset:40448
    ds_read_b64_tr_b16 a[10:11], v47 offset:40512
    s_waitcnt vmcnt(0)
    s_barrier
    s_waitcnt lgkmcnt(13)
    v_mfma_f32_16x16x32_bf16 v[32:35], a[44:47], a[44:47], v[32:35]
    ds_read_b128 a[36:39], v48 offset:16384
    s_waitcnt lgkmcnt(12)
    v_mfma_f32_16x16x32_bf16 v[16:19], a[24:27], a[44:47], v[16:19]
    ds_read_b64_tr_b16 a[12:13], v46 offset:0
    ds_read_b64_tr_b16 a[14:15], v46 offset:256
    s_waitcnt lgkmcnt(12)
    v_mfma_f32_16x16x32_bf16 v[20:23], a[28:31], a[44:47], v[20:23]
    ds_read_b64_tr_b16 a[16:17], v46 offset:16384
    ds_read_b64_tr_b16 a[18:19], v46 offset:16640
    s_waitcnt lgkmcnt(12)
    v_mfma_f32_16x16x32_bf16 v[24:27], a[32:35], a[44:47], v[24:27]
    ds_read_b64_tr_b16 a[20:21], v47 offset:40960
    ds_read_b64_tr_b16 a[22:23], v47 offset:41024
    s_waitcnt lgkmcnt(13)
    v_smfmac_f32_16x16x64_bf16 v[36:39], v[40:43], a[44:51], v44
    ds_read_b128 a[40:43], v49 offset:16384
    v_mfma_f32_16x16x32_bf16 v[32:35], a[48:51], a[48:51], v[32:35]
    ds_read_b64_tr_b16 a[24:25], v46 offset:1024
    s_waitcnt lgkmcnt(13)
    v_mfma_f32_16x16x32_bf16 v[16:19], a[0:3], a[48:51], v[16:19]
    ds_read_b64_tr_b16 a[26:27], v46 offset:1280
    ds_read_b64_tr_b16 a[28:29], v46 offset:17408
    s_waitcnt lgkmcnt(13)
    v_mfma_f32_16x16x32_bf16 v[20:23], a[4:7], a[48:51], v[20:23]
    ds_read_b64_tr_b16 a[30:31], v46 offset:17664
    s_waitcnt lgkmcnt(12)
    v_mfma_f32_16x16x32_bf16 v[24:27], a[8:11], a[48:51], v[24:27]
    ds_read_b64_tr_b16 a[32:33], v47 offset:41472
    ds_read_b64_tr_b16 a[34:35], v47 offset:41536
    s_waitcnt lgkmcnt(13)
    v_mfma_f32_16x16x32_bf16 v[32:35], a[36:39], a[36:39], v[32:35]
    s_waitcnt lgkmcnt(11)
    v_mfma_f32_16x16x32_bf16 v[16:19], a[12:15], a[36:39], v[16:19]
    s_waitcnt lgkmcnt(9)
    v_mfma_f32_16x16x32_bf16 v[20:23], a[16:19], a[36:39], v[20:23]
    s_waitcnt lgkmcnt(7)
    v_mfma_f32_16x16x32_bf16 v[24:27], a[20:23], a[36:39], v[24:27]
    s_waitcnt lgkmcnt(6)
    v_smfmac_f32_16x16x64_bf16 v[36:39], v[40:43], a[36:43], v44
    v_mfma_f32_16x16x32_bf16 v[32:35], a[40:43], a[40:43], v[32:35]
    s_waitcnt lgkmcnt(4)
    v_mfma_f32_16x16x32_bf16 v[16:19], a[24:27], a[40:43], v[16:19]
    s_waitcnt lgkmcnt(2)
    v_mfma_f32_16x16x32_bf16 v[20:23], a[28:31], a[40:43], v[20:23]
    s_waitcnt lgkmcnt(0)
    v_mfma_f32_16x16x32_bf16 v[24:27], a[32:35], a[40:43], v[24:27]
    s_nop 4
    v_cndmask_b32 v48, 0, v32, s[36:37]
    v_cndmask_b32 v48, v48, v33, s[38:39]
    v_cndmask_b32 v48, v48, v34, s[40:41]
    v_cndmask_b32 v48, v48, v35, s[42:43]
    v_mov_b32 v50, v36
    v_mov_b32 v49, v48
    s_nop 1
    v_permlane32_swap_b32 v36, v50
    v_permlane32_swap_b32 v48, v49
    v_add_f32 v50, v36, v50
    v_add_f32 v48, v48, v49
    v_mov_b32 v49, v48
    v_mul_f32 v50, 0x3ae38e39, v50
    s_nop 0
    v_permlane16_swap_b32 v48, v49
    v_add_f32 v48, v48, v49
    v_mul_f32 v49, v50, v50
    v_fma_f32 v48, v48, s58, -v49
    v_max_f32 v48, 0, v48
    v_cvt_pk_bf16_f32 v48, v48, v48
    v_and_b32 v48, 0xffff0000, v48
    v_add_f32 v48, 0x3727c5ac, v48
    v_cvt_pk_bf16_f32 v48, v48, v48
    v_and_b32 v48, 0xffff0000, v48
    v_sqrt_f32 v48, v48
    v_cvt_pk_bf16_f32 v50, v50, v50
    v_and_b32 v50, 0xffff0000, v50
    v_cvt_pk_bf16_f32 v48, v48, v48
    v_and_b32 v48, 0xffff0000, v48
    v_rcp_f32 v48, v48
    s_nop 0
    s_barrier
    ds_read_b128 v[60:63], v51 offset:0
    ds_read_b128 v[64:67], v51 offset:64
    ds_read_b128 v[68:71], v51 offset:128
    s_mov_b32 s48, 0xffff0000
    s_mov_b32 s49, 0
    s_mov_b32 s50, 0
    s_mov_b32 s51, 0xffff0000
    s_waitcnt lgkmcnt(2)
    v_fma_f32 v16, -v50, v60, v16
    v_fma_f32 v17, -v50, v61, v17
    v_fma_f32 v18, -v50, v62, v18
    v_fma_f32 v19, -v50, v63, v19
    s_waitcnt lgkmcnt(1)
    v_fma_f32 v20, -v50, v64, v20
    v_fma_f32 v21, -v50, v65, v21
    v_fma_f32 v22, -v50, v66, v22
    v_fma_f32 v23, -v50, v67, v23
    s_waitcnt lgkmcnt(0)
    v_fma_f32 v24, -v50, v68, v24
    v_fma_f32 v25, -v50, v69, v25
    v_fma_f32 v26, -v50, v70, v26
    v_fma_f32 v27, -v50, v71, v27
    v_mul_f32 v16, v48, v16
    v_mul_f32 v17, v48, v17
    v_mul_f32 v18, v48, v18
    v_mul_f32 v19, v48, v19
    v_mul_f32 v20, v48, v20
    v_mul_f32 v21, v48, v21
    v_mul_f32 v22, v48, v22
    v_mul_f32 v23, v48, v23
    v_mul_f32 v24, v48, v24
    v_mul_f32 v25, v48, v25
    v_mul_f32 v26, v48, v26
    v_mul_f32 v27, v48, v27
    v_cvt_pk_bf16_f32 v72, v16, v17
    v_cvt_pk_bf16_f32 v73, v18, v19
    v_cvt_pk_bf16_f32 v74, v20, v21
    v_cvt_pk_bf16_f32 v75, v22, v23
    v_cvt_pk_bf16_f32 v76, v24, v25
    v_cvt_pk_bf16_f32 v77, v26, v27
    ds_write_b64 v54, v[72:73]
    ds_write_b16 v57, v74 offset:1024
    ds_write_b16_d16_hi v57, v74 offset:1040
    ds_write_b16 v57, v75 offset:1056
    ds_write_b16_d16_hi v57, v75 offset:1072
    s_mov_b64 exec, s[48:49]
    ds_write_b32 v58, v77 offset:2176
    s_mov_b64 exec, s[50:51]
    ds_write_b16 v55, v77 offset:1280
    ds_write_b16_d16_hi v55, v77 offset:1296
    s_mov_b64 exec, -1
    v_cndmask_b32 v60, 0, v77, s[48:49]
    v_mov_b32 v61, 0
    v_dot2c_f32_bf16 v61, v72, v72
    v_dot2c_f32_bf16 v61, v73, v73
    v_dot2c_f32_bf16 v61, v60, v60
    s_nop 2
    v_mov_b32 v62, v61
    s_nop 1
    v_permlane32_swap_b32 v61, v62
    v_add_f32 v61, v61, v62
    v_mov_b32 v62, v61
    s_nop 1
    v_permlane16_swap_b32 v61, v62
    v_add_f32 v61, v61, v62
    s_nop 1
    v_max_f32_dpp v61, v61, v61 row_ror:8 row_mask:0xf bank_mask:0xf
    s_nop 1
    v_max_f32_dpp v61, v61, v61 row_ror:4 row_mask:0xf bank_mask:0xf
    s_nop 1
    v_max_f32_dpp v61, v61, v61 row_ror:2 row_mask:0xf bank_mask:0xf
    s_nop 1
    v_max_f32_dpp v61, v61, v61 row_ror:1 row_mask:0xf bank_mask:0xf
    s_lshl_b32 s46, s16, 2
    s_add_u32 s46, s46, 162176
    v_mov_b32 v62, s46
    ds_write_b32 v62, v61
    s_branch L_kv_out
L_k1_hkv:
    s_sub_u32 s23, s16, 6
    v_lshrrev_b32 v2, 1, v1
    v_and_b32 v3, 0x13, v2
    v_bfe_u32 v4, v2, 2, 1
    v_bfe_u32 v5, v2, 3, 1
    v_lshl_add_u32 v3, v4, 3, v3
    v_lshl_add_u32 v3, v5, 2, v3
    v_mul_u32_u24 v3, 36, v3
    v_and_b32 v4, 1, v1
    v_lshl_add_u32 v6, v4, 4, v3
    v_mul_u32_u24 v7, 36, v1
    v_add_u32 v7, 20, v7
    s_mul_i32 s22, s18, 2304
    s_mul_i32 s20, s23, 16384
    s_mul_i32 s21, s23, 9280
    s_add_u32 s21, s21, 32768
    s_setprio 3
    s_waitcnt lgkmcnt(0)
    s_cmp_eq_u32 s23, 0
    s_cselect_b32 s28, s8, s10
    s_cselect_b32 s29, s9, s11
    s_mov_b32 s30, 20736
    s_mov_b32 s31, 0x20000
    s_add_u32 m0, s21, 0
    s_nop 0
    buffer_load_dwordx4 v7, s[28:31], s22 offen lds
    s_add_u32 m0, s20, 0
    s_nop 0
    buffer_load_dwordx4 v6, s[28:31], s22 offen lds
    s_add_u32 m0, s20, 1024
    s_add_u32 s22, s22, 1152
    buffer_load_dwordx4 v6, s[28:31], s22 offen lds
    s_add_u32 s22, s22, 1152
    s_cmp_eq_u32 s19, 1
    s_cselect_b32 s22, 0, s22
    s_setprio 2
    s_add_u32 m0, s21, 1024
    s_nop 0
    buffer_load_dwordx4 v7, s[28:31], s22 offen lds
    s_add_u32 m0, s20, 2048
    s_nop 0
    buffer_load_dwordx4 v6, s[28:31], s22 offen lds
    s_add_u32 m0, s20, 3072
    s_add_u32 s22, s22, 1152
    buffer_load_dwordx4 v6, s[28:31], s22 offen lds
    s_add_u32 s22, s22, 1152
    s_cmp_eq_u32 s19, 2
    s_cselect_b32 s22, 0, s22
    s_setprio 0
    s_cmp_eq_u32 s26, 255
    s_cselect_b32 s46, s23, 0
    s_cmp_eq_u32 s46, 1
    s_cbranch_scc0 L_notag
    s_add_u32 s32, s6, 3207168
    s_addc_u32 s33, s7, 0
    s_load_dword s46, s[32:33], 0
    s_mov_b32 s34, 4
    s_mov_b32 s35, 0x20000
    s_mov_b32 s8, s4
    s_mov_b32 s9, s5
    s_mov_b32 s10, 4
    s_mov_b32 s11, 0x20000
    v_mov_b32 v13, 0
    s_waitcnt lgkmcnt(0)
    s_add_u32 s46, s46, 1
    s_add_u32 s47, s46, 1
    s_cmp_lt_u32 s47, 2
    s_cselect_b32 s46, 1, s46
    v_mov_b32 v12, s46
    s_mov_b64 exec, 1
    buffer_store_dword v12, v13, s[8:11], 0 offen sc1
    buffer_store_dword v12, v13, s[32:35], 0 offen sc1
    s_mov_b64 exec, -1
L_notag:
    s_mov_b32 s32, s6
    s_mov_b32 s33, s7
    s_mov_b32 s34, 0x600000
    s_mov_b32 s35, 0x20000
    v_lshrrev_b32 v3, 4, v1
    v_bfe_u32 v12, v1, 2, 2
    v_and_b32 v13, 3, v1
    v_lshrrev_b32 v9, 1, v3
    v_lshlrev_b32 v9, 4, v9
    v_and_b32 v10, 1, v3
    v_lshl_add_u32 v9, v10, 2, v9
    v_add_u32 v9, v9, v12
    v_lshlrev_b32 v9, 5, v9
    v_lshl_add_u32 v28, v13, 3, v9
    v_lshl_add_u32 v9, v3, 3, v12
    v_lshlrev_b32 v9, 4, v9
    v_and_b32 v10, 1, v13
    v_lshl_add_u32 v9, v10, 3, v9
    v_lshrrev_b32 v10, 1, v13
    v_mul_u32_u24 v10, 9280, v10
    v_add_u32 v29, v9, v10
    v_add_u32 v28, s20, v28
    v_mov_b32 v24, 0x3f803f80
    v_mov_b32 v25, 0x3f803f80
    v_mov_b32 v26, 0x3f803f80
    v_mov_b32 v27, 0x3f803f80
    s_add_u32 m0, s21, 2048
    s_nop 0
    buffer_load_dwordx4 v7, s[28:31], s22 offen lds
    s_add_u32 m0, s20, 4096
    s_nop 0
    buffer_load_dwordx4 v6, s[28:31], s22 offen lds
    s_add_u32 m0, s20, 5120
    s_add_u32 s22, s22, 1152
    buffer_load_dwordx4 v6, s[28:31], s22 offen lds
    s_add_u32 s22, s22, 1152
    s_cmp_eq_u32 s19, 3
    s_cselect_b32 s22, 0, s22
    s_waitcnt vmcnt(6)
    s_barrier
    ds_read_b64_tr_b16 a[0:1], v28 offset:0
    ds_read_b64_tr_b16 a[2:3], v28 offset:256
    ds_read_b64_tr_b16 a[4:5], v29 offset:32768
    ds_read_b64_tr_b16 a[6:7], v29 offset:32832
    s_add_u32 m0, s21, 3072
    s_nop 0
    buffer_load_dwordx4 v7, s[28:31], s22 offen lds
    s_add_u32 m0, s20, 6144
    s_nop 0
    buffer_load_dwordx4 v6, s[28:31], s22 offen lds
    s_add_u32 m0, s20, 7168
    s_add_u32 s22, s22, 1152
    buffer_load_dwordx4 v6, s[28:31], s22 offen lds
    s_add_u32 s22, s22, 1152
    s_cmp_eq_u32 s19, 4
    s_cselect_b32 s22, 0, s22
    ds_read_b64_tr_b16 a[8:9], v28 offset:1024
    ds_read_b64_tr_b16 a[10:11], v28 offset:1280
    ds_read_b64_tr_b16 a[12:13], v29 offset:33280
    ds_read_b64_tr_b16 a[14:15], v29 offset:33344
    s_waitcnt vmcnt(6)
    s_barrier
    s_waitcnt lgkmcnt(6)
    v_mfma_f32_16x16x32_bf16 v[16:19], a[0:3], v[24:27], 0
    ds_read_b64_tr_b16 a[16:17], v28 offset:2048
    ds_read_b64_tr_b16 a[18:19], v28 offset:2304
    ds_read_b64_tr_b16 a[20:21], v29 offset:33792
    s_waitcnt lgkmcnt(7)
    v_mfma_f32_16x16x32_bf16 v[20:23], a[4:7], v[24:27], 0
    ds_read_b64_tr_b16 a[22:23], v29 offset:33856
    s_add_u32 m0, s21, 4096
    s_nop 0
    buffer_load_dwordx4 v7, s[28:31], s22 offen lds
    s_add_u32 m0, s20, 8192
    s_nop 0
    buffer_load_dwordx4 v6, s[28:31], s22 offen lds
    s_add_u32 m0, s20, 9216
    s_add_u32 s22, s22, 1152
    buffer_load_dwordx4 v6, s[28:31], s22 offen lds
    s_add_u32 s22, s22, 1152
    s_cmp_eq_u32 s19, 5
    s_cselect_b32 s22, 0, s22
    s_waitcnt lgkmcnt(6)
    v_mfma_f32_16x16x32_bf16 v[16:19], a[8:11], v[24:27], v[16:19]
    ds_read_b64_tr_b16 a[0:1], v28 offset:3072
    ds_read_b64_tr_b16 a[2:3], v28 offset:3328
    s_waitcnt lgkmcnt(6)
    v_mfma_f32_16x16x32_bf16 v[20:23], a[12:15], v[24:27], v[20:23]
    ds_read_b64_tr_b16 a[4:5], v29 offset:34304
    ds_read_b64_tr_b16 a[6:7], v29 offset:34368
    s_waitcnt vmcnt(6)
    s_barrier
    s_waitcnt lgkmcnt(6)
    v_mfma_f32_16x16x32_bf16 v[16:19], a[16:19], v[24:27], v[16:19]
    ds_read_b64_tr_b16 a[8:9], v28 offset:4096
    ds_read_b64_tr_b16 a[10:11], v28 offset:4352
    ds_read_b64_tr_b16 a[12:13], v29 offset:34816
    s_waitcnt lgkmcnt(7)
    v_mfma_f32_16x16x32_bf16 v[20:23], a[20:23], v[24:27], v[20:23]
    ds_read_b64_tr_b16 a[14:15], v29 offset:34880
    s_add_u32 m0, s21, 5120
    s_nop 0
    buffer_load_dwordx4 v7, s[28:31], s22 offen lds
    s_add_u32 m0, s20, 10240
    s_nop 0
    buffer_load_dwordx4 v6, s[28:31], s22 offen lds
    s_add_u32 m0, s20, 11264
    s_add_u32 s22, s22, 1152
    buffer_load_dwordx4 v6, s[28:31], s22 offen lds
    s_add_u32 s22, s22, 1152
    s_cmp_eq_u32 s19, 6
    s_cselect_b32 s22, 0, s22
    s_waitcnt lgkmcnt(6)
    v_mfma_f32_16x16x32_bf16 v[16:19], a[0:3], v[24:27], v[16:19]
    ds_read_b64_tr_b16 a[16:17], v28 offset:5120
    ds_read_b64_tr_b16 a[18:19], v28 offset:5376
    s_waitcnt lgkmcnt(6)
    v_mfma_f32_16x16x32_bf16 v[20:23], a[4:7], v[24:27], v[20:23]
    ds_read_b64_tr_b16 a[20:21], v29 offset:35328
    ds_read_b64_tr_b16 a[22:23], v29 offset:35392
    s_waitcnt vmcnt(6)
    s_barrier
    s_waitcnt lgkmcnt(6)
    v_mfma_f32_16x16x32_bf16 v[16:19], a[8:11], v[24:27], v[16:19]
    ds_read_b64_tr_b16 a[0:1], v28 offset:6144
    ds_read_b64_tr_b16 a[2:3], v28 offset:6400
    ds_read_b64_tr_b16 a[4:5], v29 offset:35840
    s_waitcnt lgkmcnt(7)
    v_mfma_f32_16x16x32_bf16 v[20:23], a[12:15], v[24:27], v[20:23]
    ds_read_b64_tr_b16 a[6:7], v29 offset:35904
    s_add_u32 m0, s21, 6144
    s_nop 0
    buffer_load_dwordx4 v7, s[28:31], s22 offen lds
    s_add_u32 m0, s20, 12288
    s_nop 0
    buffer_load_dwordx4 v6, s[28:31], s22 offen lds
    s_add_u32 m0, s20, 13312
    s_add_u32 s22, s22, 1152
    buffer_load_dwordx4 v6, s[28:31], s22 offen lds
    s_add_u32 s22, s22, 1152
    s_cmp_eq_u32 s19, 7
    s_cselect_b32 s22, 0, s22
    s_waitcnt lgkmcnt(6)
    v_mfma_f32_16x16x32_bf16 v[16:19], a[16:19], v[24:27], v[16:19]
    ds_read_b64_tr_b16 a[8:9], v28 offset:7168
    ds_read_b64_tr_b16 a[10:11], v28 offset:7424
    s_waitcnt lgkmcnt(6)
    v_mfma_f32_16x16x32_bf16 v[20:23], a[20:23], v[24:27], v[20:23]
    ds_read_b64_tr_b16 a[12:13], v29 offset:36352
    ds_read_b64_tr_b16 a[14:15], v29 offset:36416
    s_waitcnt vmcnt(6)
    s_barrier
    s_waitcnt lgkmcnt(6)
    v_mfma_f32_16x16x32_bf16 v[16:19], a[0:3], v[24:27], v[16:19]
    ds_read_b64_tr_b16 a[16:17], v28 offset:8192
    ds_read_b64_tr_b16 a[18:19], v28 offset:8448
    ds_read_b64_tr_b16 a[20:21], v29 offset:36864
    s_waitcnt lgkmcnt(7)
    v_mfma_f32_16x16x32_bf16 v[20:23], a[4:7], v[24:27], v[20:23]
    ds_read_b64_tr_b16 a[22:23], v29 offset:36928
    s_add_u32 m0, s21, 7168
    s_nop 0
    buffer_load_dwordx4 v7, s[28:31], s22 offen lds
    s_add_u32 m0, s20, 14336
    s_nop 0
    buffer_load_dwordx4 v6, s[28:31], s22 offen lds
    s_add_u32 m0, s20, 15360
    s_add_u32 s22, s22, 1152
    buffer_load_dwordx4 v6, s[28:31], s22 offen lds
    s_add_u32 s22, s22, 1152
    s_cmp_eq_u32 s19, 8
    s_cselect_b32 s22, 0, s22
    s_waitcnt lgkmcnt(6)
    v_mfma_f32_16x16x32_bf16 v[16:19], a[8:11], v[24:27], v[16:19]
    ds_read_b64_tr_b16 a[0:1], v28 offset:9216
    ds_read_b64_tr_b16 a[2:3], v28 offset:9472
    s_waitcnt lgkmcnt(6)
    v_mfma_f32_16x16x32_bf16 v[20:23], a[12:15], v[24:27], v[20:23]
    ds_read_b64_tr_b16 a[4:5], v29 offset:37376
    ds_read_b64_tr_b16 a[6:7], v29 offset:37440
    s_waitcnt vmcnt(6)
    s_barrier
    s_waitcnt lgkmcnt(6)
    v_mfma_f32_16x16x32_bf16 v[16:19], a[16:19], v[24:27], v[16:19]
    ds_read_b64_tr_b16 a[8:9], v28 offset:10240
    ds_read_b64_tr_b16 a[10:11], v28 offset:10496
    ds_read_b64_tr_b16 a[12:13], v29 offset:37888
    s_waitcnt lgkmcnt(7)
    v_mfma_f32_16x16x32_bf16 v[20:23], a[20:23], v[24:27], v[20:23]
    ds_read_b64_tr_b16 a[14:15], v29 offset:37952
    s_add_u32 m0, s21, 8192
    s_nop 0
    buffer_load_dwordx4 v7, s[28:31], s22 offen lds
    s_add_u32 m0, s20, 0
    s_nop 0
    buffer_load_dwordx4 v6, s[28:31], s22 offen lds
    s_add_u32 m0, s20, 1024
    s_add_u32 s22, s22, 1152
    buffer_load_dwordx4 v6, s[28:31], s22 offen lds
    s_waitcnt lgkmcnt(6)
    v_mfma_f32_16x16x32_bf16 v[16:19], a[0:3], v[24:27], v[16:19]
    ds_read_b64_tr_b16 a[16:17], v28 offset:11264
    ds_read_b64_tr_b16 a[18:19], v28 offset:11520
    s_waitcnt lgkmcnt(6)
    v_mfma_f32_16x16x32_bf16 v[20:23], a[4:7], v[24:27], v[20:23]
    ds_read_b64_tr_b16 a[20:21], v29 offset:38400
    ds_read_b64_tr_b16 a[22:23], v29 offset:38464
    s_waitcnt vmcnt(6)
    s_barrier
    s_waitcnt lgkmcnt(6)
    v_mfma_f32_16x16x32_bf16 v[16:19], a[8:11], v[24:27], v[16:19]
    ds_read_b64_tr_b16 a[0:1], v28 offset:12288
    ds_read_b64_tr_b16 a[2:3], v28 offset:12544
    ds_read_b64_tr_b16 a[4:5], v29 offset:38912
    s_waitcnt lgkmcnt(7)
    v_mfma_f32_16x16x32_bf16 v[20:23], a[12:15], v[24:27], v[20:23]
    ds_read_b64_tr_b16 a[6:7], v29 offset:38976
    v_mov_b32 v32, -1
    v_mov_b32 v33, -1
    v_mov_b32 v34, -1
    v_mov_b32 v35, -1
    s_lshl_b32 s46, s23, 11
    s_cmp_lt_u32 s23, 2
    s_cselect_b32 s46, s46, 0x7f000000
    v_lshl_add_u32 v37, v1, 4, s46
    s_mul_i32 s47, s2, 3600
    s_add_u32 s47, s47, 3538944
    buffer_store_dwordx4 v[32:35], v37, s[32:35], s47 offen sc1
    v_cmp_gt_u32 vcc, 2576, v37
    v_mov_b32 v36, 0x7f000000
    v_lshrrev_b32 v38, 3, v1
    v_cndmask_b32 v37, v36, v37, vcc
    buffer_store_dwordx4 v[32:35], v37, s[32:35], s47 offen offset:1024 sc1
    s_mov_b32 s50, 33024
    v_mul_lo_u32 v38, s50, v38
    v_and_b32 v39, 7, v1
    s_cmp_eq_u32 s23, 0
    s_cselect_b32 s46, 0, 0x7f000000
    v_lshl_add_u32 v39, v39, 4, s46
    v_add_u32 v38, v39, v38
    s_lshl_b32 s47, s26, 7
    s_add_u32 s47, s47, 3211264
    buffer_store_dwordx4 v[32:35], v38, s[32:35], s47 offen sc1
    s_waitcnt lgkmcnt(6)
    v_mfma_f32_16x16x32_bf16 v[16:19], a[16:19], v[24:27], v[16:19]
    ds_read_b64_tr_b16 a[8:9], v28 offset:13312
    ds_read_b64_tr_b16 a[10:11], v28 offset:13568
    s_waitcnt lgkmcnt(6)
    v_mfma_f32_16x16x32_bf16 v[20:23], a[20:23], v[24:27], v[20:23]
    ds_read_b64_tr_b16 a[12:13], v29 offset:39424
    ds_read_b64_tr_b16 a[14:15], v29 offset:39488
    s_waitcnt vmcnt(6)
    s_barrier
    s_waitcnt lgkmcnt(6)
    v_mfma_f32_16x16x32_bf16 v[16:19], a[0:3], v[24:27], v[16:19]
    ds_read_b64_tr_b16 a[16:17], v28 offset:14336
    ds_read_b64_tr_b16 a[18:19], v28 offset:14592
    s_waitcnt lgkmcnt(6)
    v_mfma_f32_16x16x32_bf16 v[20:23], a[4:7], v[24:27], v[20:23]
    ds_read_b64_tr_b16 a[20:21], v29 offset:39936
    ds_read_b64_tr_b16 a[22:23], v29 offset:40000
    s_waitcnt lgkmcnt(6)
    v_mfma_f32_16x16x32_bf16 v[16:19], a[8:11], v[24:27], v[16:19]
    ds_read_b64_tr_b16 a[0:1], v28 offset:15360
    ds_read_b64_tr_b16 a[2:3], v28 offset:15616
    s_waitcnt lgkmcnt(6)
    v_mfma_f32_16x16x32_bf16 v[20:23], a[12:15], v[24:27], v[20:23]
    ds_read_b64_tr_b16 a[4:5], v29 offset:40448
    ds_read_b64_tr_b16 a[6:7], v29 offset:40512
    s_waitcnt vmcnt(3)
    s_barrier
    s_waitcnt lgkmcnt(6)
    v_mfma_f32_16x16x32_bf16 v[16:19], a[16:19], v[24:27], v[16:19]
    ds_read_b64_tr_b16 a[8:9], v28 offset:0
    ds_read_b64_tr_b16 a[10:11], v28 offset:256
    s_waitcnt lgkmcnt(6)
    v_mfma_f32_16x16x32_bf16 v[20:23], a[20:23], v[24:27], v[20:23]
    ds_read_b64_tr_b16 a[12:13], v29 offset:40960
    ds_read_b64_tr_b16 a[14:15], v29 offset:41024
    s_waitcnt lgkmcnt(6)
    v_mfma_f32_16x16x32_bf16 v[16:19], a[0:3], v[24:27], v[16:19]
    ds_read_b64_tr_b16 a[16:17], v28 offset:1024
    ds_read_b64_tr_b16 a[18:19], v28 offset:1280
    s_waitcnt lgkmcnt(6)
    v_mfma_f32_16x16x32_bf16 v[20:23], a[4:7], v[24:27], v[20:23]
    ds_read_b64_tr_b16 a[20:21], v29 offset:41472
    ds_read_b64_tr_b16 a[22:23], v29 offset:41536
    s_waitcnt lgkmcnt(6)
    v_mfma_f32_16x16x32_bf16 v[16:19], a[8:11], v[24:27], v[16:19]
    s_waitcnt lgkmcnt(4)
    v_mfma_f32_16x16x32_bf16 v[20:23], a[12:15], v[24:27], v[20:23]
    s_waitcnt lgkmcnt(2)
    v_mfma_f32_16x16x32_bf16 v[16:19], a[16:19], v[24:27], v[16:19]
    s_waitcnt lgkmcnt(0)
    v_mfma_f32_16x16x32_bf16 v[20:23], a[20:23], v[24:27], v[20:23]
    s_lshl_b32 s46, s23, 6
    s_add_u32 s46, s46, 161920
    v_lshl_add_u32 v8, v3, 4, s46
    s_mov_b32 s46, 162048
    v_lshl_add_u32 v9, v3, 4, s46
    s_mov_b32 s48, 0x00010001
    s_mov_b32 s49, 0x00010001
    s_mov_b64 exec, s[48:49]
    s_nop 1
    ds_write_b128 v8, v[16:19]
    ds_write_b128 v9, v[20:23]
    s_mov_b64 exec, -1
    s_waitcnt lgkmcnt(0)
    s_barrier
    s_add_u32 s32, s6, 0x240000
    s_addc_u32 s33, s7, 0
    s_mov_b32 s34, 0x29000
    s_mov_b32 s35, 0x20000
L_kv_out:
    s_lshl_b32 s46, s16, 10
    v_lshl_add_u32 v8, v1, 4, s46
    s_mul_i32 s47, s17, 6912
    v_add_u32 v9, s47, v8
    s_waitcnt lgkmcnt(0)
    s_barrier
    ds_read_b128 v[4:7], v8
    v_mov_b32 v10, 162176
    ds_read_b128 v[12:15], v10
    ds_read_b64 v[16:17], v10 offset:16
    s_mov_b32 s34, 147456
    v_cmp_gt_u32 vcc, 6912, v8
    s_and_b64 exec, exec, vcc
    s_cbranch_execz L_kv_out2
    s_waitcnt lgkmcnt(2)
    buffer_store_dwordx4 v[4:7], v9, s[32:35], 0 offen sc1
L_kv_out2:
    s_mov_b64 exec, -1
    s_waitcnt lgkmcnt(0)
    v_max3_f32 v29, v12, v13, v14
    v_max3_f32 v29, v29, v15, v16
    v_max_f32 v29, v29, v17
    s_branch L_p1done
L_p1done:
    s_lshl_b32 s57, s26, 7
    s_add_u32 s57, s57, 3211264
    s_mov_b32 s96, s4
    s_mov_b32 s97, s5
    s_mov_b32 s98, 4
    s_mov_b32 s99, 0x20000
    v_mov_b32 v64, 0
    buffer_load_dword v61, v64, s[96:99], 0 offen sc1
    s_mov_b32 s20, s6
    s_mov_b32 s21, s7
    s_mov_b32 s22, 6291456
    s_mov_b32 s23, 0x20000
    s_mov_b32 s59, 33024
    v_mul_lo_u32 v63, s59, v1
    v_mov_b32 v60, -1
    v_mov_b32 v62, v29
    s_load_dwordx2 s[16:17], s[0:1], 96
    s_load_dwordx2 s[4:5], s[0:1], 0
    s_load_dwordx8 s[8:15], s[0:1], 48
    s_load_dwordx2 s[6:7], s[0:1], 80
    s_setprio 3
    v_lshrrev_b32 v1, 6, v0
    v_and_b32 v79, 63, v0
    v_and_b32 v5, 7, v0
    v_readfirstlane_b32 s18, v1
    v_bfe_u32 v6, v0, 3, 2
    s_lshl_b32 s58, s2, 3
    s_add_u32 s61, s58, s18
    s_mul_i32 s61, s61, 1152
    v_mul_u32_u24 v7, 1168, v5
    v_mad_u32_u24 v7, v6, 36, v7
    s_mul_i32 s58, s18, 144
    s_add_u32 s58, s58, 110592
    v_add_u32 v7, s58, v7
    v_lshrrev_b32 v4, 5, v79
    v_lshl_add_u32 v8, v4, 4, v7
    s_mul_i32 s68, s18, 1168
    s_add_u32 s68, s68, 110592
    v_lshlrev_b32 v75, 4, v79
    v_lshlrev_b32 v66, 2, v79
    v_and_b32 v3, 31, v79
    v_lshlrev_b32 v10, 4, v3
    s_movk_i32 s62, 288
    v_mad_u32_u24 v83, v4, s62, v10
    s_mov_b32 s64, 0x0003ffff
    s_mov_b32 s65, 0x0003ffff
    v_mul_u32_u24 v2, 0x3f80, v4
    v_mov_b32 v10, 0x3f803f80
    v_cmp_eq_u32 vcc, 20, v3
    s_bfe_u32 s60, s2, 196611
    s_mul_i32 s62, s18, 18432
    s_add_u32 s62, s62, 2359296
    s_mul_i32 s67, s60, 2304
    s_add_u32 s67, s67, s62
    s_add_u32 s63, s62, 18432
    v_cndmask_b32 v10, 0, v10, vcc
    v_accvgpr_write_b32 a32, v2
    v_accvgpr_write_b32 a33, v2
    v_accvgpr_write_b32 a34, v2
    v_accvgpr_write_b32 a35, v2
    v_accvgpr_write_b32 a36, v2
    v_accvgpr_write_b32 a37, v2
    v_accvgpr_write_b32 a38, v2
    v_accvgpr_write_b32 a39, v2
    v_accvgpr_write_b32 a40, v10
    v_accvgpr_write_b32 a41, v10
    v_accvgpr_write_b32 a42, v10
    v_accvgpr_write_b32 a43, v10
    v_accvgpr_write_b32 a44, v10
    v_accvgpr_write_b32 a45, v10
    v_accvgpr_write_b32 a46, v10
    v_accvgpr_write_b32 a47, v10
    v_accvgpr_write_b32 a48, v10
    v_accvgpr_write_b32 a49, v10
    v_accvgpr_write_b32 a50, v10
    v_accvgpr_write_b32 a51, v10
    v_accvgpr_write_b32 a52, v10
    v_accvgpr_write_b32 a53, v10
    v_accvgpr_write_b32 a54, v10
    v_accvgpr_write_b32 a55, v10
    v_accvgpr_write_b32 a56, v10
    v_accvgpr_write_b32 a57, v10
    v_accvgpr_write_b32 a58, v10
    v_accvgpr_write_b32 a59, v10
    v_accvgpr_write_b32 a60, v10
    v_accvgpr_write_b32 a61, v10
    v_accvgpr_write_b32 a62, v10
    v_accvgpr_write_b32 a63, v10
    s_getreg_b32 s58, hwreg(HW_REG_XCC_ID)
    s_and_b32 s58, s58, 7
    s_mul_i32 s58, s58, 33024
    s_add_u32 s58, s58, 3211268
    s_mul_i32 s59, s18, 344
    s_lshr_b32 s59, s59, 7
    v_add_u32 v24, s59, v79
    v_min_u32 v24, 21, v24
    v_add_u32 v24, 234, v24
    v_lshlrev_b32 v24, 7, v24
    s_mov_b32 s59, 0
    s_waitcnt vmcnt(0)
L_tag:
    v_cmp_ne_u32 vcc, 0, v61
    s_cbranch_vccnz L_tagok
    buffer_load_dword v61, v64, s[96:99], 0 offen sc1
    s_add_u32 s59, s59, 1
    s_cmp_gt_u32 s59, 40000
    s_waitcnt vmcnt(0)
    s_cbranch_scc0 L_tag
L_tagok:
    s_barrier
    s_cmp_lg_u32 s18, 7
    s_cbranch_scc1 L_noflag
    s_mov_b64 exec, 0xff
    buffer_store_dwordx3 v[60:62], v63, s[20:23], s57 offen sc1
    s_mov_b64 exec, -1
L_noflag:
    s_mov_b32 s57, s58
    v_mov_b32 v21, v24
    s_waitcnt lgkmcnt(0)
    s_and_b32 s58, s2, 7
    s_lshr_b32 s59, s2, 3
    s_mul_i32 s19, s58, 18
    s_add_u32 s19, s19, s59
    s_cmp_lt_u32 s59, 18
    s_cselect_b32 s19, s19, s2
    s_cselect_b32 s69, 5308416, 0
    s_mov_b32 s24, s10
    s_mov_b32 s25, s11
    s_mov_b32 s26, s69
    s_mov_b32 s27, 0x20000
    s_mov_b32 s28, s12
    s_mov_b32 s29, s13
    s_mov_b32 s30, s69
    s_mov_b32 s31, 0x20000
    s_mov_b32 s32, s14
    s_mov_b32 s33, s15
    s_mov_b32 s34, s69
    s_mov_b32 s35, 0x20000
    s_mov_b32 s36, s4
    s_mov_b32 s37, s5
    s_mov_b32 s38, 0x240000
    s_mov_b32 s39, 0x20000
    s_mov_b32 s40, s6
    s_mov_b32 s41, s7
    s_mov_b32 s42, 0x240000
    s_mov_b32 s43, 0x20000
    s_mov_b32 s44, s8
    s_mov_b32 s45, s9
    s_mov_b32 s46, 0x480
    s_mov_b32 s47, 0x20000
    s_mul_i32 s53, s18, 147456
    s_lshl_b32 s58, s19, 6
    s_add_u32 s53, s53, s58
    s_mul_i32 s54, s19, 36864
    s_lshl_b32 s58, s18, 10
    s_add_u32 s54, s54, s58
    s_mov_b32 s49, s58
    s_cmp_lt_u32 s18, 6
    s_cselect_b32 s52, s69, 0
    s_mul_i32 s56, s18, 5
    s_lshl_b32 s58, s18, 2
    s_add_u32 s58, s58, 4
    s_cmp_lt_u32 s18, 4
    s_cselect_b32 s56, s56, s58
    s_lshl_b32 s48, s56, 11
    s_add_u32 s48, s48, 2527232
    s_mul_i32 s60, s59, 20736
    s_lshl_b32 s58, s18, 10
    s_add_u32 s60, s60, s58
    s_add_u32 s60, s60, 2527232
    v_lshrrev_b32 v24, 2, v79
    v_mul_u32_u24 v25, 9216, v24
    v_lshrrev_b32 v24, 4, v79
    v_and_b32 v26, 2, v24
    v_and_b32 v27, 3, v79
    v_xor_b32 v26, v26, v27
    v_lshl_add_u32 v77, v26, 4, v25
    v_mov_b32 v68, 0xdddd
    v_mov_b32 v69, 0x4444
    v_mov_b32 v25, 0xeeee
    v_and_b32 v26, 15, v79
    v_cmp_lt_u32 vcc, 7, v26
    v_mul_u32_u24 v27, 80, v3
    s_mul_i32 s58, s18, 2560
    v_cndmask_b32 v69, v69, v25, vcc
    s_add_u32 s58, s58, 110592
    v_add_u32 v27, s58, v27
    v_lshl_add_u32 v70, v4, 4, v27
    v_lshl_add_u32 v80, v4, 3, v27
    v_add_u32 v80, 64, v80
    v_min_u32 v25, 9, v26
    v_mul_u32_u24 v27, 640, v24
    v_lshl_add_u32 v27, v25, 3, v27
    s_mul_i32 s58, s18, 80
    s_add_u32 s58, s58, 110592
    v_add_u32 v71, s58, v27
    s_mul_i32 s58, s18, 144
    s_add_u32 s58, s58, 131072
    v_lshlrev_b32 v27, 5, v24
    v_lshl_add_u32 v27, v26, 2, v27
    v_add_u32 v72, s58, v27
    v_mov_b32 v73, 1152
    s_add_u32 s58, s58, 9216
    v_lshl_add_u32 v27, v24, 2, s58
    v_cmp_eq_u32 vcc, 8, v26
    s_mov_b32 s58, 157824
    v_lshl_add_u32 v28, v79, 2, s58
    v_cndmask_b32 v72, v72, v27, vcc
    v_cndmask_b32 v73, v73, 16, vcc
    v_cmp_lt_u32 vcc, 8, v26
    v_mul_u32_u24 v27, 144, v5
    v_bfe_u32 v25, v79, 3, 1
    v_cndmask_b32 v72, v72, v28, vcc
    v_cndmask_b32 v73, v73, 0, vcc
    v_lshl_add_u32 v27, v25, 6, v27
    v_lshl_add_u32 v27, v24, 4, v27
    v_add_u32 v74, 131072, v27
    v_add_u32 v76, 143488, v75
    v_mov_b32 v32, 0
    v_mov_b32 v33, 0
    v_mov_b32 v34, 0
    v_mov_b32 v35, 0
    v_mov_b32 v36, 0
    v_mov_b32 v37, 0
    v_mov_b32 v38, 0
    v_mov_b32 v39, 0
    v_mov_b32 v40, 0
    v_mov_b32 v41, 0
    v_mov_b32 v42, 0
    v_mov_b32 v43, 0
    v_mov_b32 v44, 0
    v_mov_b32 v45, 0
    v_mov_b32 v46, 0
    v_mov_b32 v47, 0
    v_mov_b32 v48, 0
    v_mov_b32 v49, 0
    v_mov_b32 v50, 0
    v_mov_b32 v51, 0
    v_mad_u32_u24 v72, v73, 7, v72
    s_cmp_lt_u32 s18, 4
    s_cbranch_scc1 L_nored4
    s_sub_u32 s58, s18, 4
    v_lshrrev_b32 v25, 3, v79
    s_mul_i32 s59, s58, 640
    s_add_u32 s59, s59, 110592
    v_mul_u32_u24 v27, 80, v25
    v_add_u32 v27, s59, v27
    v_lshl_add_u32 v48, v5, 3, v27
    v_and_b32 v28, 3, v79
    v_lshl_add_u32 v49, v28, 2, v27
    v_add_u32 v49, 64, v49
    v_mul_u32_u24 v27, 144, v25
    s_lshl_b32 s59, s58, 5
    s_add_u32 s59, s59, 131072
    v_add_u32 v28, s59, v27
    v_lshl_add_u32 v50, v5, 2, v28
    s_lshl_b32 s59, s58, 2
    s_add_u32 s59, s59, 140288
    v_add_u32 v28, s59, v27
    v_lshl_add_u32 v28, v5, 1, v28
    s_mov_b32 s59, 157824
    v_lshl_add_u32 v27, v79, 1, s59
    v_cmp_gt_u32 vcc, 2, v5
    s_nop 1
    v_cndmask_b32 v51, v27, v28, vcc
L_nored4:
    s_mov_b32 s58, s57
    v_mov_b32 v24, v21
    s_cmp_lt_u32 s18, 4
    s_cbranch_scc1 L_allflags
    s_mov_b32 s59, 0
    s_mov_b64 exec, 15
L_kpoll:
    buffer_load_dword v20, v24, s[20:23], s58 offen sc1
    s_add_u32 s59, s59, 1
    s_waitcnt vmcnt(0)
    v_cmp_ne_u32 vcc, v20, v61
    s_and_b64 exec, exec, vcc
    s_cbranch_execz L_kdone
    s_cmp_gt_u32 s59, 40000
    s_cbranch_scc1 L_kdone
    s_sleep 3
    s_branch L_kpoll
L_kdone:
    s_mov_b64 exec, -1
    s_setprio 3
    buffer_load_dwordx4 a[0:3], v75, s[20:23], s67 offen sc1
    s_mov_b32 exec_hi, 0
    buffer_load_dword a32, v66, s[20:23], s67 offen offset:2176 sc1
    s_mov_b64 exec, s[64:65]
    buffer_load_dwordx4 a[40:43], v83, s[20:23], s67 offen offset:1024 sc1
    buffer_load_dwordx4 a[44:47], v83, s[20:23], s67 offen offset:1600 sc1
    s_mov_b64 exec, -1
    s_add_u32 s67, s67, 2304
    s_cmp_ge_u32 s67, s63
    s_cselect_b32 s67, s62, s67
    s_setprio 2
    buffer_load_dwordx4 a[4:7], v75, s[20:23], s67 offen sc1
    s_mov_b32 exec_hi, 0
    buffer_load_dword a33, v66, s[20:23], s67 offen offset:2176 sc1
    s_mov_b64 exec, s[64:65]
    buffer_load_dwordx4 a[48:51], v83, s[20:23], s67 offen offset:1024 sc1
    buffer_load_dwordx4 a[52:55], v83, s[20:23], s67 offen offset:1600 sc1
    s_mov_b64 exec, -1
    s_add_u32 s67, s67, 2304
    s_cmp_ge_u32 s67, s63
    s_cselect_b32 s67, s62, s67
    s_setprio 1
    buffer_load_dwordx4 a[8:11], v75, s[20:23], s67 offen sc1
    s_mov_b32 exec_hi, 0
    buffer_load_dword a34, v66, s[20:23], s67 offen offset:2176 sc1
    s_mov_b64 exec, s[64:65]
    buffer_load_dwordx4 a[56:59], v83, s[20:23], s67 offen offset:1024 sc1
    buffer_load_dwordx4 a[60:63], v83, s[20:23], s67 offen offset:1600 sc1
    s_mov_b64 exec, -1
    s_add_u32 s67, s67, 2304
    s_cmp_ge_u32 s67, s63
    s_cselect_b32 s67, s62, s67
    s_setprio 3
    v_accvgpr_write_b32 a64, v10
    v_accvgpr_write_b32 a65, v10
    v_accvgpr_write_b32 a66, v10
    v_accvgpr_write_b32 a67, v10
    v_accvgpr_write_b32 a68, v10
    v_accvgpr_write_b32 a69, v10
    v_accvgpr_write_b32 a70, v10
    v_accvgpr_write_b32 a71, v10
    v_accvgpr_write_b32 a72, v10
    v_accvgpr_write_b32 a73, v10
    v_accvgpr_write_b32 a74, v10
    v_accvgpr_write_b32 a75, v10
    v_accvgpr_write_b32 a76, v10
    v_accvgpr_write_b32 a77, v10
    v_accvgpr_write_b32 a78, v10
    v_accvgpr_write_b32 a79, v10
    v_accvgpr_write_b32 a80, v10
    v_accvgpr_write_b32 a81, v10
    v_accvgpr_write_b32 a82, v10
    v_accvgpr_write_b32 a83, v10
    v_accvgpr_write_b32 a84, v10
    v_accvgpr_write_b32 a85, v10
    v_accvgpr_write_b32 a86, v10
    v_accvgpr_write_b32 a87, v10
    v_accvgpr_write_b32 a88, v10
    v_accvgpr_write_b32 a89, v10
    v_accvgpr_write_b32 a90, v10
    v_accvgpr_write_b32 a91, v10
    v_accvgpr_write_b32 a92, v10
    v_accvgpr_write_b32 a93, v10
    v_accvgpr_write_b32 a94, v10
    v_accvgpr_write_b32 a95, v10
    v_accvgpr_write_b32 a96, v10
    v_accvgpr_write_b32 a97, v10
    v_accvgpr_write_b32 a98, v10
    v_accvgpr_write_b32 a99, v10
    v_accvgpr_write_b32 a100, v10
    v_accvgpr_write_b32 a101, v10
    v_accvgpr_write_b32 a102, v10
    v_accvgpr_write_b32 a103, v10
    s_barrier
    s_mov_b32 m0, s68
    s_mov_b64 exec, 0xff
    buffer_load_dwordx4 v75, s[20:23], s61 offen offset:1024 sc1 lds
    s_mov_b64 exec, -1
    buffer_load_dwordx4 v75, s[20:23], s61 offen sc1 lds
    s_branch L_synced
L_allflags:
    v_accvgpr_write_b32 a64, v10
    v_accvgpr_write_b32 a65, v10
    v_accvgpr_write_b32 a66, v10
    v_accvgpr_write_b32 a67, v10
    v_accvgpr_write_b32 a68, v10
    v_accvgpr_write_b32 a69, v10
    v_accvgpr_write_b32 a70, v10
    v_accvgpr_write_b32 a71, v10
    v_accvgpr_write_b32 a72, v10
    v_accvgpr_write_b32 a73, v10
    v_accvgpr_write_b32 a74, v10
    v_accvgpr_write_b32 a75, v10
    v_accvgpr_write_b32 a76, v10
    v_accvgpr_write_b32 a77, v10
    v_accvgpr_write_b32 a78, v10
    v_accvgpr_write_b32 a79, v10
    v_accvgpr_write_b32 a80, v10
    v_accvgpr_write_b32 a81, v10
    v_accvgpr_write_b32 a82, v10
    v_accvgpr_write_b32 a83, v10
    v_accvgpr_write_b32 a84, v10
    v_accvgpr_write_b32 a85, v10
    v_accvgpr_write_b32 a86, v10
    v_accvgpr_write_b32 a87, v10
    v_accvgpr_write_b32 a88, v10
    v_accvgpr_write_b32 a89, v10
    v_accvgpr_write_b32 a90, v10
    v_accvgpr_write_b32 a91, v10
    v_accvgpr_write_b32 a92, v10
    v_accvgpr_write_b32 a93, v10
    v_accvgpr_write_b32 a94, v10
    v_accvgpr_write_b32 a95, v10
    v_accvgpr_write_b32 a96, v10
    v_accvgpr_write_b32 a97, v10
    v_accvgpr_write_b32 a98, v10
    v_accvgpr_write_b32 a99, v10
    v_accvgpr_write_b32 a100, v10
    v_accvgpr_write_b32 a101, v10
    v_accvgpr_write_b32 a102, v10
    v_accvgpr_write_b32 a103, v10
    s_mul_i32 s59, s18, 8192
    s_add_u32 s58, s58, s59
    v_lshlrev_b32 v24, 7, v79
    s_mov_b32 s59, 0
    s_sleep 5
L_fpoll:
    s_add_u32 s57, s58, 0
    buffer_load_dwordx2 v[20:21], v24, s[20:23], s57 offen sc1
    s_add_u32 s59, s59, 1
    s_waitcnt vmcnt(0)
    v_xor_b32 v22, v20, v61
    v_cmp_ne_u32 vcc, 0, v22
    s_and_b64 exec, exec, vcc
    s_cbranch_execz L_fdone
    s_cmp_gt_u32 s59, 40000
    s_cbranch_scc1 L_fdone
    s_sleep 4
    s_branch L_fpoll
L_fdone:
    s_mov_b64 exec, -1
    s_barrier
    s_mov_b32 m0, s68
    s_mov_b64 exec, 0xff
    buffer_load_dwordx4 v75, s[20:23], s61 offen offset:1024 sc1 lds
    s_mov_b64 exec, -1
    buffer_load_dwordx4 v75, s[20:23], s61 offen sc1 lds
    s_setprio 2
    buffer_load_dwordx4 a[0:3], v75, s[20:23], s67 offen sc1
    s_mov_b32 exec_hi, 0
    buffer_load_dword a32, v66, s[20:23], s67 offen offset:2176 sc1
    s_mov_b64 exec, s[64:65]
    buffer_load_dwordx4 a[40:43], v83, s[20:23], s67 offen offset:1024 sc1
    buffer_load_dwordx4 a[44:47], v83, s[20:23], s67 offen offset:1600 sc1
    s_mov_b64 exec, -1
    s_add_u32 s67, s67, 2304
    s_cmp_ge_u32 s67, s63
    s_cselect_b32 s67, s62, s67
    s_setprio 1
    buffer_load_dwordx4 a[4:7], v75, s[20:23], s67 offen sc1
    s_mov_b32 exec_hi, 0
    buffer_load_dword a33, v66, s[20:23], s67 offen offset:2176 sc1
    s_mov_b64 exec, s[64:65]
    buffer_load_dwordx4 a[48:51], v83, s[20:23], s67 offen offset:1024 sc1
    buffer_load_dwordx4 a[52:55], v83, s[20:23], s67 offen offset:1600 sc1
    s_mov_b64 exec, -1
    s_add_u32 s67, s67, 2304
    s_cmp_ge_u32 s67, s63
    s_cselect_b32 s67, s62, s67
    s_setprio 0
    buffer_load_dwordx4 a[8:11], v75, s[20:23], s67 offen sc1
    s_mov_b32 exec_hi, 0
    buffer_load_dword a34, v66, s[20:23], s67 offen offset:2176 sc1
    s_mov_b64 exec, s[64:65]
    buffer_load_dwordx4 a[56:59], v83, s[20:23], s67 offen offset:1024 sc1
    buffer_load_dwordx4 a[60:63], v83, s[20:23], s67 offen offset:1600 sc1
    s_mov_b64 exec, -1
    s_add_u32 s67, s67, 2304
    s_cmp_ge_u32 s67, s63
    s_cselect_b32 s67, s62, s67
    s_setprio 3
L_synced:
    s_setprio 0
    s_cmp_lg_u32 s18, 3
    s_cbranch_scc1 L_nokmax
    s_nop 1
    v_max_f32_dpp v21, v21, v21 row_shr:1 row_mask:0xf bank_mask:0xf
    s_nop 1
    v_max_f32_dpp v21, v21, v21 row_shr:2 row_mask:0xf bank_mask:0xf
    s_nop 1
    v_max_f32_dpp v21, v21, v21 row_shr:4 row_mask:0xf bank_mask:0xf
    s_nop 1
    v_max_f32_dpp v21, v21, v21 row_shr:8 row_mask:0xf bank_mask:0xf
    s_nop 1
    v_max_f32_dpp v21, v21, v21 row_bcast:15 row_mask:0xa bank_mask:0xf
    s_nop 1
    v_max_f32_dpp v21, v21, v21 row_bcast:31 row_mask:0xc bank_mask:0xf
    v_mov_b32 v22, 158912
    s_mov_b32 exec_lo, 0
    s_mov_b32 exec_hi, 0x80000000
    ds_write_b32 v22, v21
    s_mov_b64 exec, -1
L_nokmax:
    s_mov_b32 s68, -1
    s_mov_b32 s69, 0
    v_mov_b32 v81, v7
    v_mov_b32 v82, v8
    s_mul_i32 s58, s18, 144
    v_subrev_u32 v7, s58, v7
    v_subrev_u32 v8, s58, v8
    v_mov_b32 v9, 0xc240
    v_accvgpr_write_b32 a164, v9
    v_accvgpr_write_b32 a165, 0
    v_accvgpr_write_b32 a166, 0
    v_accvgpr_write_b32 a167, v9
    s_waitcnt lgkmcnt(0)
    s_cmp_lt_u32 s18, 4
    s_cbranch_scc1 L_qlow
    s_waitcnt vmcnt(0)
L_qlow:
    s_waitcnt vmcnt(12)
    s_barrier
    ds_read2_b32 a[160:161], v8 offset0:0 offset1:1
    ds_read2_b32 a[162:163], v8 offset0:2 offset1:3
    s_mov_b32 exec_hi, 0
    ds_read_b32 a164, v7 offset:32
    ds_read_b32 a167, v7 offset:32
    s_mov_b32 exec_hi, -1
    s_cmp_ge_u32 s18, 4
    s_cbranch_scc1 L_f4
    s_waitcnt lgkmcnt(0)
    s_waitcnt vmcnt(10)
    v_mfma_f32_32x32x8bf16_1k v[0:15], a[32:33], a[164:165], 0
    v_mfma_f32_32x32x16_bf16 v[0:15], a[0:3], a[160:163], v[0:15]
    v_mfma_f32_32x32x8bf16_1k a[104:119], a[164:165], a[166:167], 0
    s_nop 5
    s_setprio 1
    v_exp_f32 v0, v0
    buffer_load_dwordx4 a[12:15], v75, s[20:23], s67 offen sc1
    v_exp_f32 v1, v1
    v_exp_f32 v2, v2
    ds_read2_b32 v[52:53], v82 offset0:0 offset1:1
    v_exp_f32 v3, v3
    s_mov_b32 exec_hi, 0
    buffer_load_dword a35, v66, s[20:23], s67 offen offset:2176 sc1
    s_mov_b32 exec_hi, -1
    v_exp_f32 v4, v4
    v_exp_f32 v5, v5
    s_waitcnt vmcnt(8)
    v_mfma_f32_32x32x8bf16_1k v[16:31], a[32:33], a[166:167], 0
    v_exp_f32 v6, v6
    ds_read2_b32 v[54:55], v82 offset0:2 offset1:3
    v_exp_f32 v7, v7
    s_mov_b64 exec, s[64:65]
    buffer_load_dwordx4 a[64:67], v83, s[20:23], s67 offen offset:1024 sc1
    s_mov_b64 exec, -1
    v_exp_f32 v8, v8
    v_exp_f32 v9, v9
    v_mfma_f32_32x32x16_bf16 v[16:31], a[4:7], a[160:163], v[16:31]
    v_exp_f32 v10, v10
    ds_read_b32 v56, v81 offset:32
    v_mov_b32 v73, 158912
    v_exp_f32 v11, v11
    s_mov_b64 exec, s[64:65]
    buffer_load_dwordx4 a[68:71], v83, s[20:23], s67 offen offset:1600 sc1
    s_mov_b64 exec, -1
    s_add_u32 s67, s67, 2304
    s_cmp_ge_u32 s67, s63
    s_cselect_b32 s67, s62, s67
    v_exp_f32 v12, v12
    v_exp_f32 v13, v13
    v_smfmac_f32_32x32x32_bf16 a[104:119], a[40:43], v[0:7], v68
    v_exp_f32 v14, v14
    ds_read_b32 v60, v73
    v_mov_b32 v64, 0
    v_exp_f32 v15, v15
    s_setprio 3
    v_exp_f32 v16, v16
    buffer_load_dwordx4 a[16:19], v75, s[20:23], s67 offen sc1
    v_exp_f32 v17, v17
    v_smfmac_f32_32x32x32_bf16 a[104:119], a[44:47], v[8:15], v68
    v_exp_f32 v18, v18
    s_waitcnt lgkmcnt(0)
    v_cndmask_b32 v65, 0, v56, s[68:69]
    v_dot2c_f32_bf16 v64, v52, v52
    v_exp_f32 v19, v19
    s_mov_b32 exec_hi, 0
    buffer_load_dword a36, v66, s[20:23], s67 offen offset:2176 sc1
    s_mov_b32 exec_hi, -1
    v_dot2c_f32_bf16 v64, v53, v53
    v_exp_f32 v20, v20
    v_exp_f32 v21, v21
    s_waitcnt vmcnt(8)
    v_mfma_f32_32x32x8bf16_1k v[0:15], a[34:35], a[164:165], 0
    v_exp_f32 v22, v22
    v_dot2c_f32_bf16 v64, v54, v54
    v_exp_f32 v23, v23
    s_mov_b64 exec, s[64:65]
    buffer_load_dwordx4 a[72:75], v83, s[20:23], s67 offen offset:1024 sc1
    s_mov_b64 exec, -1
    v_dot2c_f32_bf16 v64, v55, v55
    v_exp_f32 v24, v24
    v_exp_f32 v25, v25
    v_mfma_f32_32x32x16_bf16 v[0:15], a[8:11], a[160:163], v[0:15]
    v_exp_f32 v26, v26
    v_dot2c_f32_bf16 v64, v65, v65
    v_exp_f32 v27, v27
    s_mov_b64 exec, s[64:65]
    buffer_load_dwordx4 a[76:79], v83, s[20:23], s67 offen offset:1600 sc1
    s_mov_b64 exec, -1
    s_add_u32 s67, s67, 2304
    s_cmp_ge_u32 s67, s63
    s_cselect_b32 s67, s62, s67
    v_exp_f32 v28, v28
    v_exp_f32 v29, v29
    v_smfmac_f32_32x32x32_bf16 a[104:119], a[48:51], v[16:23], v68
    v_mov_b32 v61, 0xc240
    v_exp_f32 v30, v30
    v_mov_b32 v65, v64
    v_cndmask_b32 v56, v61, v56, s[68:69]
    v_exp_f32 v31, v31
    s_setprio 1
    v_exp_f32 v0, v0
    buffer_load_dwordx4 a[20:23], v75, s[20:23], s67 offen sc1
    v_exp_f32 v1, v1
    v_smfmac_f32_32x32x32_bf16 a[104:119], a[52:55], v[24:31], v68
    v_permlane32_swap_b32 v64, v65
    s_lshl_b32 s59, s18, 11
    s_add_u32 s59, s59, 141440
    v_exp_f32 v2, v2
    v_add_f32 v64, v64, v65
    v_add_u32 v78, s59, v75
    v_exp_f32 v3, v3
    s_mov_b32 exec_hi, 0
    buffer_load_dword a37, v66, s[20:23], s67 offen offset:2176 sc1
    s_mov_b32 exec_hi, -1
    v_mul_f32 v64, v60, v64
    v_mov_b32 v57, 0
    v_exp_f32 v4, v4
    v_exp_f32 v5, v5
    s_waitcnt vmcnt(8)
    v_mfma_f32_32x32x8bf16_1k v[16:31], a[34:35], a[166:167], 0
    v_exp_f32 v6, v6
    ds_write_b128 v78, v[52:55]
    v_mov_b32 v58, 0
    v_exp_f32 v7, v7
    s_mov_b64 exec, s[64:65]
    buffer_load_dwordx4 a[80:83], v83, s[20:23], s67 offen offset:1024 sc1
    s_mov_b64 exec, -1
    v_cmp_nge_f32 vcc, 0x450d29a2, v64
    v_mov_b32 v59, v56
    v_exp_f32 v8, v8
    v_exp_f32 v9, v9
    v_mfma_f32_32x32x16_bf16 v[16:31], a[12:15], a[160:163], v[16:31]
    v_exp_f32 v10, v10
    ds_write_b128 v78, v[56:59] offset:1024
    v_exp_f32 v11, v11
    s_mov_b64 exec, s[64:65]
    buffer_load_dwordx4 a[84:87], v83, s[20:23], s67 offen offset:1600 sc1
    s_mov_b64 exec, -1
    s_add_u32 s67, s67, 2304
    s_cmp_ge_u32 s67, s63
    s_cselect_b32 s67, s62, s67
    s_cmp_lg_u64 vcc, 0
    s_cselect_b32 s58, 1, 0
    s_lshl_b32 s59, s18, 2
    s_add_u32 s59, s59, 158848
    v_mov_b32 v60, s59
    v_exp_f32 v12, v12
    v_exp_f32 v13, v13
    v_smfmac_f32_32x32x32_bf16 a[104:119], a[56:59], v[0:7], v68
    v_exp_f32 v14, v14
    v_mov_b32 v61, s58
    v_exp_f32 v15, v15
    s_setprio 0
    v_exp_f32 v16, v16
    buffer_load_dwordx4 a[24:27], v75, s[20:23], s67 offen sc1
    v_exp_f32 v17, v17
    v_smfmac_f32_32x32x32_bf16 a[104:119], a[60:63], v[8:15], v68
    ds_write_b32 v60, v61
    v_exp_f32 v18, v18
    v_exp_f32 v19, v19
    s_mov_b32 exec_hi, 0
    buffer_load_dword a38, v66, s[20:23], s67 offen offset:2176 sc1
    s_mov_b32 exec_hi, -1
    v_exp_f32 v20, v20
    v_exp_f32 v21, v21
    s_waitcnt vmcnt(8)
    v_mfma_f32_32x32x8bf16_1k v[0:15], a[36:37], a[164:165], 0
    v_exp_f32 v22, v22
    v_exp_f32 v23, v23
    s_mov_b64 exec, s[64:65]
    buffer_load_dwordx4 a[88:91], v83, s[20:23], s67 offen offset:1024 sc1
    s_mov_b64 exec, -1
    v_and_b32 v62, 7, v79
    s_mov_b32 s58, 158848
    v_exp_f32 v24, v24
    v_exp_f32 v25, v25
    v_mfma_f32_32x32x16_bf16 v[0:15], a[16:19], a[160:163], v[0:15]
    v_exp_f32 v26, v26
    v_exp_f32 v27, v27
    s_mov_b64 exec, s[64:65]
    buffer_load_dwordx4 a[92:95], v83, s[20:23], s67 offen offset:1600 sc1
    s_mov_b64 exec, -1
    s_add_u32 s67, s67, 2304
    s_cmp_ge_u32 s67, s63
    s_cselect_b32 s67, s62, s67
    v_lshl_add_u32 v62, v62, 2, s58
    v_exp_f32 v28, v28
    v_exp_f32 v29, v29
    v_smfmac_f32_32x32x32_bf16 a[104:119], a[64:67], v[16:23], v68
    v_exp_f32 v30, v30
    v_exp_f32 v31, v31
    s_waitcnt lgkmcnt(0)
    s_barrier
    s_setprio 3
    v_exp_f32 v0, v0
    buffer_load_dwordx4 a[28:31], v75, s[20:23], s67 offen sc1
    ds_read_b32 v63, v62
    v_exp_f32 v1, v1
    v_smfmac_f32_32x32x32_bf16 a[104:119], a[68:71], v[24:31], v68
    v_exp_f32 v2, v2
    v_exp_f32 v3, v3
    s_mov_b32 exec_hi, 0
    buffer_load_dword a39, v66, s[20:23], s67 offen offset:2176 sc1
    s_mov_b32 exec_hi, -1
    v_exp_f32 v4, v4
    v_exp_f32 v5, v5
    s_waitcnt vmcnt(8)
    v_mfma_f32_32x32x8bf16_1k v[16:31], a[36:37], a[166:167], 0
    v_exp_f32 v6, v6
    v_exp_f32 v7, v7
    s_mov_b64 exec, s[64:65]
    buffer_load_dwordx4 a[96:99], v83, s[20:23], s67 offen offset:1024 sc1
    s_mov_b64 exec, -1
    v_exp_f32 v8, v8
    v_exp_f32 v9, v9
    v_mfma_f32_32x32x16_bf16 v[16:31], a[20:23], a[160:163], v[16:31]
    v_exp_f32 v10, v10
    v_exp_f32 v11, v11
    s_mov_b64 exec, s[64:65]
    buffer_load_dwordx4 a[100:103], v83, s[20:23], s67 offen offset:1600 sc1
    s_mov_b64 exec, -1
    s_waitcnt lgkmcnt(0)
    v_cmp_ne_u32 vcc, 0, v63
    v_exp_f32 v12, v12
    v_exp_f32 v13, v13
    v_smfmac_f32_32x32x32_bf16 a[104:119], a[72:75], v[0:7], v68
    v_exp_f32 v14, v14
    v_exp_f32 v15, v15
    s_cbranch_vccnz L_slow
    s_setprio 3
    v_exp_f32 v16, v16
    v_exp_f32 v17, v17
    v_smfmac_f32_32x32x32_bf16 a[104:119], a[76:79], v[8:15], v68
    v_exp_f32 v18, v18
    v_exp_f32 v19, v19
    v_exp_f32 v20, v20
    v_exp_f32 v21, v21
    s_waitcnt vmcnt(6)
    v_mfma_f32_32x32x8bf16_1k v[0:15], a[38:39], a[164:165], 0
    v_exp_f32 v22, v22
    v_exp_f32 v23, v23
    v_exp_f32 v24, v24
    v_exp_f32 v25, v25
    v_mfma_f32_32x32x16_bf16 v[0:15], a[24:27], a[160:163], v[0:15]
    v_exp_f32 v26, v26
    v_exp_f32 v27, v27
    s_add_u32 s58, s48, 0
    buffer_load_dwordx4 a[120:123], v75, s[20:23], s58 offen sc1
    buffer_load_dwordx4 a[124:127], v75, s[20:23], s58 offen offset:1024 sc1
    v_exp_f32 v28, v28
    v_exp_f32 v29, v29
    v_smfmac_f32_32x32x32_bf16 a[104:119], a[80:83], v[16:23], v68
    v_exp_f32 v30, v30
    v_exp_f32 v31, v31
    s_setprio 2
    v_exp_f32 v0, v0
    s_add_u32 s58, s48, 2048
    buffer_load_dwordx4 a[128:131], v75, s[20:23], s58 offen sc1
    buffer_load_dwordx4 a[132:135], v75, s[20:23], s58 offen offset:1024 sc1
    v_exp_f32 v1, v1
    v_smfmac_f32_32x32x32_bf16 a[104:119], a[84:87], v[24:31], v68
    v_exp_f32 v2, v2
    v_exp_f32 v3, v3
    v_exp_f32 v4, v4
    v_exp_f32 v5, v5
    s_waitcnt vmcnt(6)
    v_mfma_f32_32x32x8bf16_1k v[16:31], a[38:39], a[166:167], 0
    v_exp_f32 v6, v6
    v_exp_f32 v7, v7
    s_add_u32 s58, s48, 4096
    buffer_load_dwordx4 a[136:139], v75, s[20:23], s58 offen sc1
    buffer_load_dwordx4 a[140:143], v75, s[20:23], s58 offen offset:1024 sc1
    v_exp_f32 v8, v8
    v_exp_f32 v9, v9
    v_mfma_f32_32x32x16_bf16 v[16:31], a[28:31], a[160:163], v[16:31]
    v_exp_f32 v10, v10
    ds_read_b128 a[160:163], v76
    ds_read_b128 a[164:167], v76 offset:1024
    v_add_u32 v76, 2048, v76
    v_exp_f32 v11, v11
    v_exp_f32 v12, v12
    v_exp_f32 v13, v13
    v_smfmac_f32_32x32x32_bf16 a[104:119], a[88:91], v[0:7], v68
    v_exp_f32 v14, v14
    v_exp_f32 v15, v15
    s_setprio 1
    v_exp_f32 v16, v16
    s_add_u32 s58, s48, 6144
    buffer_load_dwordx4 a[144:147], v75, s[20:23], s58 offen sc1
    buffer_load_dwordx4 a[148:151], v75, s[20:23], s58 offen offset:1024 sc1
    v_exp_f32 v17, v17
    v_smfmac_f32_32x32x32_bf16 a[104:119], a[92:95], v[8:15], v68
    v_exp_f32 v18, v18
    v_exp_f32 v19, v19
    v_exp_f32 v20, v20
    v_exp_f32 v21, v21
    s_waitcnt lgkmcnt(0)
    v_mfma_f32_32x32x8bf16_1k v[0:15], a[32:33], a[164:165], 0
    v_exp_f32 v22, v22
    v_exp_f32 v23, v23
    v_exp_f32 v24, v24
    v_exp_f32 v25, v25
    v_mfma_f32_32x32x16_bf16 v[0:15], a[0:3], a[160:163], v[0:15]
    v_exp_f32 v26, v26
    v_exp_f32 v27, v27
    v_exp_f32 v28, v28
    v_exp_f32 v29, v29
    s_waitcnt vmcnt(8)
    v_smfmac_f32_32x32x32_bf16 a[104:119], a[96:99], v[16:23], v68
    v_exp_f32 v30, v30
    s_add_u32 s58, s48, 8192
    buffer_load_dwordx4 a[152:155], v75, s[20:23], s58 offen sc1
    buffer_load_dwordx4 a[156:159], v75, s[20:23], s58 offen offset:1024 sc1
    v_exp_f32 v31, v31
    s_add_u32 s48, s48, 73728
    s_mov_b32 s55, 6
    s_cmp_eq_u32 s52, 0
    s_cbranch_scc1 L_a5n_loop
.p2align 3
L_a5x_loop:
    s_setprio 1
    v_exp_f32 v0, v0
    v_exp_f32 v1, v1
    v_smfmac_f32_32x32x32_bf16 a[104:119], a[100:103], v[24:31], v68
    v_exp_f32 v2, v2
    v_exp_f32 v3, v3
    v_exp_f32 v4, v4
    v_mfma_f32_32x32x8bf16_1k v[16:31], a[32:33], a[166:167], 0
    v_exp_f32 v5, v5
    v_exp_f32 v6, v6
    v_exp_f32 v7, v7
    v_exp_f32 v8, v8
    v_mfma_f32_32x32x16_bf16 v[16:31], a[4:7], a[160:163], v[16:31]
    ds_write_b128 v70, a[104:107]
    ds_write_b128 v70, a[108:111] offset:32
    ds_write_b64 v80, a[112:113]
    v_exp_f32 v9, v9
    s_setprio 0
    v_exp_f32 v10, v10
    v_exp_f32 v11, v11
    v_mfma_f32_32x32x8bf16_1k a[104:119], a[164:165], a[166:167], 0
    v_exp_f32 v12, v12
    v_exp_f32 v13, v13
    s_add_u32 m0, s49, 0
    s_nop 0
    buffer_load_dwordx4 v77, s[24:27], s53 offen nt lds
    v_exp_f32 v14, v14
    v_exp_f32 v15, v15
    v_smfmac_f32_32x32x32_bf16 a[104:119], a[40:43], v[0:7], v68
    s_waitcnt lgkmcnt(0)
    s_barrier
    s_setprio 3
    v_exp_f32 v16, v16
    v_exp_f32 v17, v17
    v_exp_f32 v18, v18
    v_smfmac_f32_32x32x32_bf16 a[104:119], a[44:47], v[8:15], v68
    v_exp_f32 v19, v19
    v_exp_f32 v20, v20
    v_exp_f32 v21, v21
    v_mfma_f32_32x32x8bf16_1k v[0:15], a[34:35], a[164:165], 0
    v_exp_f32 v22, v22
    v_exp_f32 v23, v23
    s_setprio 2
    v_exp_f32 v24, v24
    v_exp_f32 v25, v25
    v_mfma_f32_32x32x16_bf16 v[0:15], a[8:11], a[160:163], v[0:15]
    v_exp_f32 v26, v26
    v_exp_f32 v27, v27
    v_exp_f32 v28, v28
    v_exp_f32 v29, v29
    v_smfmac_f32_32x32x32_bf16 a[104:119], a[48:51], v[16:23], v68
    s_add_u32 m0, s49, 36864
    s_nop 0
    buffer_load_dwordx4 v77, s[28:31], s53 offen nt lds
    s_add_u32 s53, s53, 884736
    v_exp_f32 v30, v30
    v_exp_f32 v31, v31
    s_setprio 1
    v_exp_f32 v0, v0
    v_exp_f32 v1, v1
    v_smfmac_f32_32x32x32_bf16 a[104:119], a[52:55], v[24:31], v68
    v_exp_f32 v2, v2
    v_exp_f32 v3, v3
    v_exp_f32 v4, v4
    v_exp_f32 v5, v5
    v_mfma_f32_32x32x8bf16_1k v[16:31], a[34:35], a[166:167], 0
    v_exp_f32 v6, v6
    v_exp_f32 v7, v7
    v_exp_f32 v8, v8
    v_exp_f32 v9, v9
    v_mfma_f32_32x32x16_bf16 v[16:31], a[12:15], a[160:163], v[16:31]
    v_exp_f32 v10, v10
    v_exp_f32 v11, v11
    v_exp_f32 v12, v12
    v_exp_f32 v13, v13
    v_smfmac_f32_32x32x32_bf16 a[104:119], a[56:59], v[0:7], v68
    s_add_u32 m0, s49, 73728
    s_nop 0
    buffer_load_dwordx4 v75, s[32:35], s54 offen nt lds
    s_add_u32 s49, s49, 6144
    s_add_u32 s54, s54, 6144
    v_exp_f32 v14, v14
    v_exp_f32 v15, v15
    s_setprio 0
    v_exp_f32 v16, v16
    v_exp_f32 v17, v17
    v_smfmac_f32_32x32x32_bf16 a[104:119], a[60:63], v[8:15], v68
    v_exp_f32 v18, v18
    v_exp_f32 v19, v19
    v_exp_f32 v20, v20
    v_exp_f32 v21, v21
    v_mfma_f32_32x32x8bf16_1k v[0:15], a[36:37], a[164:165], 0
    v_exp_f32 v22, v22
    v_exp_f32 v23, v23
    v_exp_f32 v24, v24
    v_exp_f32 v25, v25
    v_mfma_f32_32x32x16_bf16 v[0:15], a[16:19], a[160:163], v[0:15]
    v_exp_f32 v26, v26
    v_exp_f32 v27, v27
    v_exp_f32 v28, v28
    v_exp_f32 v29, v29
    v_smfmac_f32_32x32x32_bf16 a[104:119], a[64:67], v[16:23], v68
    v_exp_f32 v30, v30
    v_exp_f32 v31, v31
    s_waitcnt lgkmcnt(0)
    s_barrier
    s_setprio 3
    v_exp_f32 v0, v0
    ds_read_b128 a[168:171], v74
    v_add_u32 v74, 1152, v74
    v_exp_f32 v1, v1
    v_smfmac_f32_32x32x32_bf16 a[104:119], a[68:71], v[24:31], v68
    v_exp_f32 v2, v2
    v_exp_f32 v3, v3
    v_exp_f32 v4, v4
    v_exp_f32 v5, v5
    v_mfma_f32_32x32x8bf16_1k v[16:31], a[36:37], a[166:167], 0
    v_exp_f32 v6, v6
    v_exp_f32 v7, v7
    v_exp_f32 v8, v8
    v_exp_f32 v9, v9
    v_mfma_f32_32x32x16_bf16 v[16:31], a[20:23], a[160:163], v[16:31]
    v_exp_f32 v10, v10
    v_exp_f32 v11, v11
    v_exp_f32 v12, v12
    s_waitcnt lgkmcnt(0)
    s_waitcnt vmcnt(7)
    v_smfmac_f32_16x16x64_bf16 v[32:35], a[168:171], a[120:127], v69
    v_exp_f32 v13, v13
    v_smfmac_f32_32x32x32_bf16 a[104:119], a[72:75], v[0:7], v68
    v_exp_f32 v14, v14
    s_add_u32 s58, s48, 0
    buffer_load_dwordx4 a[120:123], v75, s[20:23], s58 offen sc1
    buffer_load_dwordx4 a[124:127], v75, s[20:23], s58 offen offset:1024 sc1
    v_exp_f32 v15, v15
    s_setprio 3
    v_exp_f32 v16, v16
    v_exp_f32 v17, v17
    v_smfmac_f32_32x32x32_bf16 a[104:119], a[76:79], v[8:15], v68
    v_exp_f32 v18, v18
    v_exp_f32 v19, v19
    v_exp_f32 v20, v20
    v_smfmac_f32_16x16x64_bf16 v[36:39], a[168:171], a[128:135], v69
    v_exp_f32 v21, v21
    v_mfma_f32_32x32x8bf16_1k v[0:15], a[38:39], a[164:165], 0
    v_exp_f32 v22, v22
    v_exp_f32 v23, v23
    s_add_u32 s58, s48, 2048
    buffer_load_dwordx4 a[128:131], v75, s[20:23], s58 offen sc1
    buffer_load_dwordx4 a[132:135], v75, s[20:23], s58 offen offset:1024 sc1
    v_exp_f32 v24, v24
    v_exp_f32 v25, v25
    v_mfma_f32_32x32x16_bf16 v[0:15], a[24:27], a[160:163], v[0:15]
    v_exp_f32 v26, v26
    v_exp_f32 v27, v27
    v_exp_f32 v28, v28
    v_exp_f32 v29, v29
    v_smfmac_f32_32x32x32_bf16 a[104:119], a[80:83], v[16:23], v68
    v_exp_f32 v30, v30
    v_exp_f32 v31, v31
    s_setprio 2
    v_exp_f32 v0, v0
    v_exp_f32 v1, v1
    v_smfmac_f32_32x32x32_bf16 a[104:119], a[84:87], v[24:31], v68
    v_exp_f32 v2, v2
    v_exp_f32 v3, v3
    v_exp_f32 v4, v4
    v_smfmac_f32_16x16x64_bf16 v[40:43], a[168:171], a[136:143], v69
    v_exp_f32 v5, v5
    v_mfma_f32_32x32x8bf16_1k v[16:31], a[38:39], a[166:167], 0
    v_exp_f32 v6, v6
    v_exp_f32 v7, v7
    s_add_u32 s58, s48, 4096
    buffer_load_dwordx4 a[136:139], v75, s[20:23], s58 offen sc1
    buffer_load_dwordx4 a[140:143], v75, s[20:23], s58 offen offset:1024 sc1
    v_exp_f32 v8, v8
    v_exp_f32 v9, v9
    v_mfma_f32_32x32x16_bf16 v[16:31], a[28:31], a[160:163], v[16:31]
    v_exp_f32 v10, v10
    ds_read_b128 a[160:163], v76
    ds_read_b128 a[164:167], v76 offset:1024
    v_add_u32 v76, 2048, v76
    v_exp_f32 v11, v11
    v_exp_f32 v12, v12
    v_exp_f32 v13, v13
    v_smfmac_f32_32x32x32_bf16 a[104:119], a[88:91], v[0:7], v68
    v_exp_f32 v14, v14
    v_exp_f32 v15, v15
    s_setprio 1
    v_exp_f32 v16, v16
    v_exp_f32 v17, v17
    v_smfmac_f32_32x32x32_bf16 a[104:119], a[92:95], v[8:15], v68
    v_exp_f32 v18, v18
    v_exp_f32 v19, v19
    v_exp_f32 v20, v20
    s_waitcnt vmcnt(9)
    v_smfmac_f32_16x16x64_bf16 v[44:47], a[168:171], a[144:151], v69
    v_exp_f32 v21, v21
    s_waitcnt lgkmcnt(0)
    v_mfma_f32_32x32x8bf16_1k v[0:15], a[32:33], a[164:165], 0
    v_exp_f32 v22, v22
    v_exp_f32 v23, v23
    s_add_u32 s58, s48, 6144
    buffer_load_dwordx4 a[144:147], v75, s[20:23], s58 offen sc1
    buffer_load_dwordx4 a[148:151], v75, s[20:23], s58 offen offset:1024 sc1
    v_exp_f32 v24, v24
    v_exp_f32 v25, v25
    v_mfma_f32_32x32x16_bf16 v[0:15], a[0:3], a[160:163], v[0:15]
    v_exp_f32 v26, v26
    v_exp_f32 v27, v27
    v_exp_f32 v28, v28
    v_smfmac_f32_16x16x64_bf16 v[48:51], a[168:171], a[152:159], v69
    v_exp_f32 v29, v29
    v_smfmac_f32_32x32x32_bf16 a[104:119], a[96:99], v[16:23], v68
    v_exp_f32 v30, v30
    s_add_u32 s58, s48, 8192
    buffer_load_dwordx4 a[152:155], v75, s[20:23], s58 offen sc1
    buffer_load_dwordx4 a[156:159], v75, s[20:23], s58 offen offset:1024 sc1
    v_exp_f32 v31, v31
    s_add_u32 s48, s48, 73728
    s_sub_u32 s55, s55, 1
    s_cmp_lg_u32 s55, 0
    s_cbranch_scc1 L_a5x_loop
    s_branch L_a5_last
.p2align 3
L_a5n_loop:
    s_setprio 1
    v_exp_f32 v0, v0
    v_exp_f32 v1, v1
    v_smfmac_f32_32x32x32_bf16 a[104:119], a[100:103], v[24:31], v68
    v_exp_f32 v2, v2
    v_exp_f32 v3, v3
    v_exp_f32 v4, v4
    v_mfma_f32_32x32x8bf16_1k v[16:31], a[32:33], a[166:167], 0
    v_exp_f32 v5, v5
    v_exp_f32 v6, v6
    v_exp_f32 v7, v7
    v_exp_f32 v8, v8
    v_mfma_f32_32x32x16_bf16 v[16:31], a[4:7], a[160:163], v[16:31]
    ds_write_b128 v70, a[104:107]
    ds_write_b128 v70, a[108:111] offset:32
    ds_write_b64 v80, a[112:113]
    v_exp_f32 v9, v9
    s_setprio 0
    v_exp_f32 v10, v10
    v_exp_f32 v11, v11
    v_mfma_f32_32x32x8bf16_1k a[104:119], a[164:165], a[166:167], 0
    v_exp_f32 v12, v12
    v_exp_f32 v13, v13
    v_exp_f32 v14, v14
    v_exp_f32 v15, v15
    v_smfmac_f32_32x32x32_bf16 a[104:119], a[40:43], v[0:7], v68
    s_waitcnt lgkmcnt(0)
    s_barrier
    s_setprio 3
    v_exp_f32 v16, v16
    v_exp_f32 v17, v17
    v_exp_f32 v18, v18
    v_smfmac_f32_32x32x32_bf16 a[104:119], a[44:47], v[8:15], v68
    v_exp_f32 v19, v19
    v_exp_f32 v20, v20
    v_exp_f32 v21, v21
    v_mfma_f32_32x32x8bf16_1k v[0:15], a[34:35], a[164:165], 0
    v_exp_f32 v22, v22
    v_exp_f32 v23, v23
    s_setprio 2
    v_exp_f32 v24, v24
    v_exp_f32 v25, v25
    v_mfma_f32_32x32x16_bf16 v[0:15], a[8:11], a[160:163], v[0:15]
    v_exp_f32 v26, v26
    v_exp_f32 v27, v27
    v_exp_f32 v28, v28
    v_exp_f32 v29, v29
    v_smfmac_f32_32x32x32_bf16 a[104:119], a[48:51], v[16:23], v68
    v_exp_f32 v30, v30
    v_exp_f32 v31, v31
    s_setprio 1
    v_exp_f32 v0, v0
    v_exp_f32 v1, v1
    v_smfmac_f32_32x32x32_bf16 a[104:119], a[52:55], v[24:31], v68
    v_exp_f32 v2, v2
    v_exp_f32 v3, v3
    v_exp_f32 v4, v4
    v_exp_f32 v5, v5
    v_mfma_f32_32x32x8bf16_1k v[16:31], a[34:35], a[166:167], 0
    v_exp_f32 v6, v6
    v_exp_f32 v7, v7
    v_exp_f32 v8, v8
    v_exp_f32 v9, v9
    v_mfma_f32_32x32x16_bf16 v[16:31], a[12:15], a[160:163], v[16:31]
    v_exp_f32 v10, v10
    v_exp_f32 v11, v11
    v_exp_f32 v12, v12
    v_exp_f32 v13, v13
    v_smfmac_f32_32x32x32_bf16 a[104:119], a[56:59], v[0:7], v68
    v_exp_f32 v14, v14
    v_exp_f32 v15, v15
    s_setprio 0
    v_exp_f32 v16, v16
    v_exp_f32 v17, v17
    v_smfmac_f32_32x32x32_bf16 a[104:119], a[60:63], v[8:15], v68
    v_exp_f32 v18, v18
    v_exp_f32 v19, v19
    v_exp_f32 v20, v20
    v_exp_f32 v21, v21
    v_mfma_f32_32x32x8bf16_1k v[0:15], a[36:37], a[164:165], 0
    v_exp_f32 v22, v22
    v_exp_f32 v23, v23
    v_exp_f32 v24, v24
    v_exp_f32 v25, v25
    v_mfma_f32_32x32x16_bf16 v[0:15], a[16:19], a[160:163], v[0:15]
    v_exp_f32 v26, v26
    v_exp_f32 v27, v27
    v_exp_f32 v28, v28
    v_exp_f32 v29, v29
    v_smfmac_f32_32x32x32_bf16 a[104:119], a[64:67], v[16:23], v68
    v_exp_f32 v30, v30
    v_exp_f32 v31, v31
    s_waitcnt lgkmcnt(0)
    s_barrier
    s_setprio 3
    v_exp_f32 v0, v0
    ds_read_b128 a[168:171], v74
    v_add_u32 v74, 1152, v74
    v_exp_f32 v1, v1
    v_smfmac_f32_32x32x32_bf16 a[104:119], a[68:71], v[24:31], v68
    v_exp_f32 v2, v2
    v_exp_f32 v3, v3
    v_exp_f32 v4, v4
    v_exp_f32 v5, v5
    v_mfma_f32_32x32x8bf16_1k v[16:31], a[36:37], a[166:167], 0
    v_exp_f32 v6, v6
    v_exp_f32 v7, v7
    v_exp_f32 v8, v8
    v_exp_f32 v9, v9
    v_mfma_f32_32x32x16_bf16 v[16:31], a[20:23], a[160:163], v[16:31]
    v_exp_f32 v10, v10
    v_exp_f32 v11, v11
    v_exp_f32 v12, v12
    s_waitcnt lgkmcnt(0)
    s_waitcnt vmcnt(4)
    v_smfmac_f32_16x16x64_bf16 v[32:35], a[168:171], a[120:127], v69
    v_exp_f32 v13, v13
    v_smfmac_f32_32x32x32_bf16 a[104:119], a[72:75], v[0:7], v68
    v_exp_f32 v14, v14
    s_add_u32 s58, s48, 0
    buffer_load_dwordx4 a[120:123], v75, s[20:23], s58 offen sc1
    buffer_load_dwordx4 a[124:127], v75, s[20:23], s58 offen offset:1024 sc1
    v_exp_f32 v15, v15
    s_setprio 3
    v_exp_f32 v16, v16
    v_exp_f32 v17, v17
    v_smfmac_f32_32x32x32_bf16 a[104:119], a[76:79], v[8:15], v68
    v_exp_f32 v18, v18
    v_exp_f32 v19, v19
    v_exp_f32 v20, v20
    v_smfmac_f32_16x16x64_bf16 v[36:39], a[168:171], a[128:135], v69
    v_exp_f32 v21, v21
    v_mfma_f32_32x32x8bf16_1k v[0:15], a[38:39], a[164:165], 0
    v_exp_f32 v22, v22
    v_exp_f32 v23, v23
    s_add_u32 s58, s48, 2048
    buffer_load_dwordx4 a[128:131], v75, s[20:23], s58 offen sc1
    buffer_load_dwordx4 a[132:135], v75, s[20:23], s58 offen offset:1024 sc1
    v_exp_f32 v24, v24
    v_exp_f32 v25, v25
    v_mfma_f32_32x32x16_bf16 v[0:15], a[24:27], a[160:163], v[0:15]
    v_exp_f32 v26, v26
    v_exp_f32 v27, v27
    v_exp_f32 v28, v28
    v_exp_f32 v29, v29
    v_smfmac_f32_32x32x32_bf16 a[104:119], a[80:83], v[16:23], v68
    v_exp_f32 v30, v30
    v_exp_f32 v31, v31
    s_setprio 2
    v_exp_f32 v0, v0
    v_exp_f32 v1, v1
    v_smfmac_f32_32x32x32_bf16 a[104:119], a[84:87], v[24:31], v68
    v_exp_f32 v2, v2
    v_exp_f32 v3, v3
    v_exp_f32 v4, v4
    v_smfmac_f32_16x16x64_bf16 v[40:43], a[168:171], a[136:143], v69
    v_exp_f32 v5, v5
    v_mfma_f32_32x32x8bf16_1k v[16:31], a[38:39], a[166:167], 0
    v_exp_f32 v6, v6
    v_exp_f32 v7, v7
    s_add_u32 s58, s48, 4096
    buffer_load_dwordx4 a[136:139], v75, s[20:23], s58 offen sc1
    buffer_load_dwordx4 a[140:143], v75, s[20:23], s58 offen offset:1024 sc1
    v_exp_f32 v8, v8
    v_exp_f32 v9, v9
    v_mfma_f32_32x32x16_bf16 v[16:31], a[28:31], a[160:163], v[16:31]
    v_exp_f32 v10, v10
    ds_read_b128 a[160:163], v76
    ds_read_b128 a[164:167], v76 offset:1024
    v_add_u32 v76, 2048, v76
    v_exp_f32 v11, v11
    v_exp_f32 v12, v12
    v_exp_f32 v13, v13
    v_smfmac_f32_32x32x32_bf16 a[104:119], a[88:91], v[0:7], v68
    v_exp_f32 v14, v14
    v_exp_f32 v15, v15
    s_setprio 1
    v_exp_f32 v16, v16
    v_exp_f32 v17, v17
    v_smfmac_f32_32x32x32_bf16 a[104:119], a[92:95], v[8:15], v68
    v_exp_f32 v18, v18
    v_exp_f32 v19, v19
    v_exp_f32 v20, v20
    s_waitcnt vmcnt(6)
    v_smfmac_f32_16x16x64_bf16 v[44:47], a[168:171], a[144:151], v69
    v_exp_f32 v21, v21
    s_waitcnt lgkmcnt(0)
    v_mfma_f32_32x32x8bf16_1k v[0:15], a[32:33], a[164:165], 0
    v_exp_f32 v22, v22
    v_exp_f32 v23, v23
    s_add_u32 s58, s48, 6144
    buffer_load_dwordx4 a[144:147], v75, s[20:23], s58 offen sc1
    buffer_load_dwordx4 a[148:151], v75, s[20:23], s58 offen offset:1024 sc1
    v_exp_f32 v24, v24
    v_exp_f32 v25, v25
    v_mfma_f32_32x32x16_bf16 v[0:15], a[0:3], a[160:163], v[0:15]
    v_exp_f32 v26, v26
    v_exp_f32 v27, v27
    v_exp_f32 v28, v28
    v_smfmac_f32_16x16x64_bf16 v[48:51], a[168:171], a[152:159], v69
    v_exp_f32 v29, v29
    v_smfmac_f32_32x32x32_bf16 a[104:119], a[96:99], v[16:23], v68
    v_exp_f32 v30, v30
    s_add_u32 s58, s48, 8192
    buffer_load_dwordx4 a[152:155], v75, s[20:23], s58 offen sc1
    buffer_load_dwordx4 a[156:159], v75, s[20:23], s58 offen offset:1024 sc1
    v_exp_f32 v31, v31
    s_add_u32 s48, s48, 73728
    s_sub_u32 s55, s55, 1
    s_cmp_lg_u32 s55, 0
    s_cbranch_scc1 L_a5n_loop
L_a5_last:
    s_setprio 1
    v_exp_f32 v0, v0
    v_exp_f32 v1, v1
    v_smfmac_f32_32x32x32_bf16 a[104:119], a[100:103], v[24:31], v68
    v_exp_f32 v2, v2
    v_exp_f32 v3, v3
    v_exp_f32 v4, v4
    v_mfma_f32_32x32x8bf16_1k v[16:31], a[32:33], a[166:167], 0
    v_exp_f32 v5, v5
    v_exp_f32 v6, v6
    v_exp_f32 v7, v7
    v_exp_f32 v8, v8
    v_mfma_f32_32x32x16_bf16 v[16:31], a[4:7], a[160:163], v[16:31]
    ds_write_b128 v70, a[104:107]
    ds_write_b128 v70, a[108:111] offset:32
    ds_write_b64 v80, a[112:113]
    v_exp_f32 v9, v9
    s_setprio 0
    v_exp_f32 v10, v10
    v_exp_f32 v11, v11
    v_mfma_f32_32x32x8bf16_1k a[104:119], a[164:165], a[166:167], 0
    v_exp_f32 v12, v12
    v_exp_f32 v13, v13
    v_exp_f32 v14, v14
    v_exp_f32 v15, v15
    v_smfmac_f32_32x32x32_bf16 a[104:119], a[40:43], v[0:7], v68
    s_waitcnt lgkmcnt(0)
    s_barrier
    s_setprio 3
    v_exp_f32 v16, v16
    v_exp_f32 v17, v17
    v_exp_f32 v18, v18
    v_smfmac_f32_32x32x32_bf16 a[104:119], a[44:47], v[8:15], v68
    v_exp_f32 v19, v19
    v_exp_f32 v20, v20
    v_exp_f32 v21, v21
    v_mfma_f32_32x32x8bf16_1k v[0:15], a[34:35], a[164:165], 0
    v_exp_f32 v22, v22
    v_exp_f32 v23, v23
    s_setprio 2
    v_exp_f32 v24, v24
    v_exp_f32 v25, v25
    v_mfma_f32_32x32x16_bf16 v[0:15], a[8:11], a[160:163], v[0:15]
    v_exp_f32 v26, v26
    s_add_u32 s58, s48, 73728
    buffer_load_dwordx4 a[0:3], v75, s[20:23], s58 offen sc1
    buffer_load_dwordx4 a[4:7], v75, s[20:23], s58 offen offset:1024 sc1
    v_exp_f32 v27, v27
    v_exp_f32 v28, v28
    v_exp_f32 v29, v29
    v_smfmac_f32_32x32x32_bf16 a[104:119], a[48:51], v[16:23], v68
    s_add_u32 s58, s48, 75776
    buffer_load_dwordx4 a[40:43], v75, s[20:23], s58 offen sc1
    buffer_load_dwordx4 a[44:47], v75, s[20:23], s58 offen offset:1024 sc1
    v_exp_f32 v30, v30
    v_exp_f32 v31, v31
    s_setprio 1
    v_exp_f32 v0, v0
    v_exp_f32 v1, v1
    v_smfmac_f32_32x32x32_bf16 a[104:119], a[52:55], v[24:31], v68
    v_exp_f32 v2, v2
    v_exp_f32 v3, v3
    v_exp_f32 v4, v4
    v_exp_f32 v5, v5
    v_mfma_f32_32x32x8bf16_1k v[16:31], a[34:35], a[166:167], 0
    v_exp_f32 v6, v6
    v_exp_f32 v7, v7
    v_exp_f32 v8, v8
    v_exp_f32 v9, v9
    v_mfma_f32_32x32x16_bf16 v[16:31], a[12:15], a[160:163], v[16:31]
    v_exp_f32 v10, v10
    s_add_u32 s58, s48, 77824
    buffer_load_dwordx4 a[48:51], v75, s[20:23], s58 offen sc1
    buffer_load_dwordx4 a[52:55], v75, s[20:23], s58 offen offset:1024 sc1
    v_exp_f32 v11, v11
    v_exp_f32 v12, v12
    v_exp_f32 v13, v13
    v_smfmac_f32_32x32x32_bf16 a[104:119], a[56:59], v[0:7], v68
    v_exp_f32 v14, v14
    v_exp_f32 v15, v15
    s_setprio 0
    v_exp_f32 v16, v16
    v_exp_f32 v17, v17
    v_smfmac_f32_32x32x32_bf16 a[104:119], a[60:63], v[8:15], v68
    v_exp_f32 v18, v18
    v_exp_f32 v19, v19
    v_exp_f32 v20, v20
    v_exp_f32 v21, v21
    v_mfma_f32_32x32x8bf16_1k v[0:15], a[36:37], a[164:165], 0
    v_exp_f32 v22, v22
    v_exp_f32 v23, v23
    v_exp_f32 v24, v24
    v_exp_f32 v25, v25
    v_mfma_f32_32x32x16_bf16 v[0:15], a[16:19], a[160:163], v[0:15]
    v_exp_f32 v26, v26
    s_add_u32 s58, s48, 79872
    buffer_load_dwordx4 a[8:11], v75, s[20:23], s58 offen sc1
    buffer_load_dwordx4 a[12:15], v75, s[20:23], s58 offen offset:1024 sc1
    v_exp_f32 v27, v27
    v_exp_f32 v28, v28
    v_exp_f32 v29, v29
    v_smfmac_f32_32x32x32_bf16 a[104:119], a[64:67], v[16:23], v68
    s_add_u32 s58, s48, 81920
    buffer_load_dwordx4 a[56:59], v75, s[20:23], s58 offen sc1
    buffer_load_dwordx4 a[60:63], v75, s[20:23], s58 offen offset:1024 sc1
    v_exp_f32 v30, v30
    v_exp_f32 v31, v31
    s_waitcnt lgkmcnt(0)
    s_barrier
    s_setprio 3
    v_exp_f32 v0, v0
    ds_read_b128 a[168:171], v74
    v_add_u32 v74, 1152, v74
    v_exp_f32 v1, v1
    v_smfmac_f32_32x32x32_bf16 a[104:119], a[68:71], v[24:31], v68
    v_exp_f32 v2, v2
    v_exp_f32 v3, v3
    v_exp_f32 v4, v4
    v_exp_f32 v5, v5
    v_mfma_f32_32x32x8bf16_1k v[16:31], a[36:37], a[166:167], 0
    v_exp_f32 v6, v6
    v_exp_f32 v7, v7
    v_exp_f32 v8, v8
    v_exp_f32 v9, v9
    v_mfma_f32_32x32x16_bf16 v[16:31], a[20:23], a[160:163], v[16:31]
    v_exp_f32 v10, v10
    v_exp_f32 v11, v11
    v_exp_f32 v12, v12
    s_waitcnt lgkmcnt(0)
    s_waitcnt vmcnt(18)
    v_smfmac_f32_16x16x64_bf16 v[32:35], a[168:171], a[120:127], v69
    v_exp_f32 v13, v13
    v_smfmac_f32_32x32x32_bf16 a[104:119], a[72:75], v[0:7], v68
    v_exp_f32 v14, v14
    s_add_u32 s58, s48, 0
    buffer_load_dwordx4 a[120:123], v75, s[20:23], s58 offen sc1
    buffer_load_dwordx4 a[124:127], v75, s[20:23], s58 offen offset:1024 sc1
    v_exp_f32 v15, v15
    s_setprio 3
    v_exp_f32 v16, v16
    v_exp_f32 v17, v17
    v_smfmac_f32_32x32x32_bf16 a[104:119], a[76:79], v[8:15], v68
    v_exp_f32 v18, v18
    v_exp_f32 v19, v19
    v_exp_f32 v20, v20
    s_waitcnt vmcnt(18)
    v_smfmac_f32_16x16x64_bf16 v[36:39], a[168:171], a[128:135], v69
    v_exp_f32 v21, v21
    v_mfma_f32_32x32x8bf16_1k v[0:15], a[38:39], a[164:165], 0
    v_exp_f32 v22, v22
    v_exp_f32 v23, v23
    s_add_u32 s58, s48, 2048
    buffer_load_dwordx4 a[128:131], v75, s[20:23], s58 offen sc1
    buffer_load_dwordx4 a[132:135], v75, s[20:23], s58 offen offset:1024 sc1
    v_exp_f32 v24, v24
    v_exp_f32 v25, v25
    v_mfma_f32_32x32x16_bf16 v[0:15], a[24:27], a[160:163], v[0:15]
    v_exp_f32 v26, v26
    v_exp_f32 v27, v27
    v_exp_f32 v28, v28
    v_exp_f32 v29, v29
    v_smfmac_f32_32x32x32_bf16 a[104:119], a[80:83], v[16:23], v68
    v_exp_f32 v30, v30
    v_exp_f32 v31, v31
    s_setprio 2
    v_exp_f32 v0, v0
    v_exp_f32 v1, v1
    v_smfmac_f32_32x32x32_bf16 a[104:119], a[84:87], v[24:31], v68
    v_exp_f32 v2, v2
    v_exp_f32 v3, v3
    v_exp_f32 v4, v4
    s_waitcnt vmcnt(18)
    v_smfmac_f32_16x16x64_bf16 v[40:43], a[168:171], a[136:143], v69
    v_exp_f32 v5, v5
    v_mfma_f32_32x32x8bf16_1k v[16:31], a[38:39], a[166:167], 0
    v_exp_f32 v6, v6
    v_exp_f32 v7, v7
    s_add_u32 s58, s48, 4096
    buffer_load_dwordx4 a[136:139], v75, s[20:23], s58 offen sc1
    buffer_load_dwordx4 a[140:143], v75, s[20:23], s58 offen offset:1024 sc1
    v_exp_f32 v8, v8
    v_exp_f32 v9, v9
    v_mfma_f32_32x32x16_bf16 v[16:31], a[28:31], a[160:163], v[16:31]
    v_exp_f32 v10, v10
    v_exp_f32 v11, v11
    v_exp_f32 v12, v12
    v_exp_f32 v13, v13
    v_smfmac_f32_32x32x32_bf16 a[104:119], a[88:91], v[0:7], v68
    v_exp_f32 v14, v14
    v_exp_f32 v15, v15
    s_setprio 1
    v_exp_f32 v16, v16
    v_exp_f32 v17, v17
    v_smfmac_f32_32x32x32_bf16 a[104:119], a[92:95], v[8:15], v68
    v_exp_f32 v18, v18
    v_lshlrev_b32 v82, 2, v79
    s_lshl_b32 s59, s2, 3
    s_add_u32 s59, s59, s18
    s_mul_i32 s59, s59, 1152
    buffer_load_dwordx4 v[0:3], v75, s[36:39], s59 offen
    buffer_load_dword v4, v82, s[36:39], s59 offen offset:1024
    buffer_load_dwordx4 v[6:9], v75, s[44:47], 0 offen
    buffer_load_dword v10, v82, s[44:47], 0 offen offset:1024
    v_exp_f32 v19, v19
    v_exp_f32 v20, v20
    s_waitcnt vmcnt(22)
    v_smfmac_f32_16x16x64_bf16 v[44:47], a[168:171], a[144:151], v69
    v_exp_f32 v21, v21
    v_exp_f32 v22, v22
    v_exp_f32 v23, v23
    s_add_u32 s58, s48, 6144
    buffer_load_dwordx4 a[144:147], v75, s[20:23], s58 offen sc1
    buffer_load_dwordx4 a[148:151], v75, s[20:23], s58 offen offset:1024 sc1
    v_exp_f32 v24, v24
    v_exp_f32 v25, v25
    v_exp_f32 v26, v26
    v_exp_f32 v27, v27
    v_exp_f32 v28, v28
    s_waitcnt vmcnt(22)
    v_smfmac_f32_16x16x64_bf16 v[48:51], a[168:171], a[152:159], v69
    v_exp_f32 v29, v29
    v_smfmac_f32_32x32x32_bf16 a[104:119], a[96:99], v[16:23], v68
    v_exp_f32 v30, v30
    s_add_u32 s58, s48, 8192
    buffer_load_dwordx4 a[152:155], v75, s[20:23], s58 offen sc1
    buffer_load_dwordx4 a[156:159], v75, s[20:23], s58 offen offset:1024 sc1
    v_exp_f32 v31, v31
    s_setprio 0
    s_nop 0
    v_smfmac_f32_32x32x32_bf16 a[104:119], a[100:103], v[24:31], v68
    s_nop 9
    ds_write_b128 v70, a[104:107]
    ds_write_b128 v70, a[108:111] offset:32
    ds_write_b64 v80, a[112:113]
    s_waitcnt lgkmcnt(0)
    s_barrier
    ds_read2st64_b64 v[52:55], v71 offset0:0 offset1:5
    ds_read2st64_b64 v[56:59], v71 offset0:10 offset1:15
    ds_read2st64_b64 v[60:63], v71 offset0:20 offset1:25
    ds_read2st64_b64 v[64:67], v71 offset0:30 offset1:35
    v_and_b32 v22, 15, v79
    v_bfe_u32 v23, v79, 4, 1
    v_mul_u32_u24 v23, 10304, v23
    v_lshl_add_u32 v22, v22, 2, v23
    s_lshl_b32 s58, s56, 6
    s_add_u32 s58, s58, 110592
    v_add_u32 v22, s58, v22
    v_lshrrev_b32 v23, 5, v79
    v_lshl_add_u32 v23, v23, 6, v22
    v_add_u32 v24, 128, v23
    s_waitcnt lgkmcnt(2)
    v_add_f32 v52, v52, v54
    v_add_f32 v53, v53, v55
    v_add_f32 v56, v56, v58
    v_add_f32 v57, v57, v59
    v_add_f32 v52, v52, v56
    v_add_f32 v53, v53, v57
    s_waitcnt lgkmcnt(0)
    v_add_f32 v60, v60, v62
    v_add_f32 v61, v61, v63
    v_add_f32 v64, v64, v66
    v_add_f32 v65, v65, v67
    v_add_f32 v60, v60, v64
    v_add_f32 v61, v61, v65
    v_add_f32 v52, v52, v60
    v_add_f32 v53, v53, v61
    s_nop 0
    v_rcp_f32_dpp v54, v52 row_newbcast:9 row_mask:0xf bank_mask:0xf
    s_nop 0
    v_mul_f32 v52, v52, v54
    v_mul_f32 v53, v53, v54
    v_cvt_pk_bf16_f32 v56, v52, v53
    ds_write_b32 v72, v56
    s_waitcnt vmcnt(4)
    v_lshlrev_b32 v12, 16, v0
    v_and_b32 v13, 0xffff0000, v0
    v_lshlrev_b32 v14, 16, v1
    v_and_b32 v15, 0xffff0000, v1
    v_lshlrev_b32 v16, 16, v2
    v_and_b32 v17, 0xffff0000, v2
    v_lshlrev_b32 v18, 16, v3
    v_and_b32 v19, 0xffff0000, v3
    v_lshlrev_b32 v20, 16, v4
    v_and_b32 v21, 0xffff0000, v4
    s_waitcnt lgkmcnt(0)
    s_barrier
    ds_read_b128 a[160:163], v74 offset:1152
    ds_read_b128 a[168:171], v74
    v_mov_b32 v60, 0
    v_mov_b32 v61, 0x3f803f80
    s_mul_i32 s58, s18, 2560
    s_lshr_b32 s59, s18, 2
    s_lshl_b32 s59, s59, 6
    s_add_u32 s58, s58, s59
    s_add_u32 s58, s58, 110592
    v_lshl_add_u32 v62, v79, 5, s58
    v_lshl_add_u32 v63, v79, 3, s58
    v_dot2c_f32_bf16 v60, v6, v61
    v_dot2c_f32_bf16 v60, v7, v61
    v_dot2c_f32_bf16 v60, v8, v61
    v_dot2c_f32_bf16 v60, v9, v61
    v_dot2c_f32_bf16 v60, v10, v61
    s_waitcnt lgkmcnt(1)
    v_smfmac_f32_16x16x64_bf16 v[32:35], a[160:163], a[0:7], v69
    v_smfmac_f32_16x16x64_bf16 v[36:39], a[160:163], a[40:47], v69
    v_smfmac_f32_16x16x64_bf16 v[40:43], a[160:163], a[48:55], v69
    v_smfmac_f32_16x16x64_bf16 v[44:47], a[160:163], a[8:15], v69
    v_smfmac_f32_16x16x64_bf16 v[48:51], a[160:163], a[56:63], v69
    s_waitcnt lgkmcnt(0)
    v_smfmac_f32_16x16x64_bf16 v[32:35], a[168:171], a[120:127], v69
    v_smfmac_f32_16x16x64_bf16 v[36:39], a[168:171], a[128:135], v69
    v_smfmac_f32_16x16x64_bf16 v[40:43], a[168:171], a[136:143], v69
    s_waitcnt vmcnt(2)
    v_smfmac_f32_16x16x64_bf16 v[44:47], a[168:171], a[144:151], v69
    s_waitcnt vmcnt(0)
    v_smfmac_f32_16x16x64_bf16 v[48:51], a[168:171], a[152:159], v69
    s_nop 4
    v_permlane32_swap_b32 v32, v36
    v_permlane32_swap_b32 v33, v37
    v_permlane32_swap_b32 v34, v38
    v_permlane32_swap_b32 v35, v39
    v_add_f32 v32, v32, v36
    v_add_f32 v33, v33, v37
    v_add_f32 v34, v34, v38
    v_add_f32 v35, v35, v39
    ds_write2st64_b32 v23, v32, v33 offset0:0 offset1:10
    ds_write2st64_b32 v23, v34, v35 offset0:20 offset1:30
    v_permlane32_swap_b32 v40, v44
    v_permlane32_swap_b32 v41, v45
    v_permlane32_swap_b32 v42, v46
    v_permlane32_swap_b32 v43, v47
    v_add_f32 v40, v40, v44
    v_add_f32 v41, v41, v45
    v_add_f32 v42, v42, v46
    v_add_f32 v43, v43, v47
    ds_write2st64_b32 v24, v40, v41 offset0:0 offset1:10
    ds_write2st64_b32 v24, v42, v43 offset0:20 offset1:30
    v_mov_b32 v56, v48
    v_mov_b32 v57, v49
    v_mov_b32 v58, v50
    v_mov_b32 v59, v51
    v_permlane32_swap_b32 v48, v56
    v_permlane32_swap_b32 v49, v57
    v_permlane32_swap_b32 v50, v58
    v_permlane32_swap_b32 v51, v59
    v_add_f32 v48, v48, v56
    v_add_f32 v49, v49, v57
    v_add_f32 v50, v50, v58
    v_add_f32 v51, v51, v59
    ds_write2st64_b32 v22, v48, v49 offset0:1 offset1:11
    ds_write2st64_b32 v22, v50, v51 offset0:21 offset1:31
    s_branch L_tail
L_f4:
    s_waitcnt lgkmcnt(0)
    s_waitcnt vmcnt(10)
    v_mfma_f32_32x32x8bf16_1k v[0:15], a[32:33], a[164:165], 0
    v_mfma_f32_32x32x16_bf16 v[0:15], a[0:3], a[160:163], v[0:15]
    v_mfma_f32_32x32x8bf16_1k a[104:119], a[164:165], a[166:167], 0
    s_nop 5
    s_setprio 1
    v_exp_f32 v0, v0
    buffer_load_dwordx4 a[12:15], v75, s[20:23], s67 offen sc1
    v_exp_f32 v1, v1
    v_exp_f32 v2, v2
    ds_read2_b32 v[52:53], v82 offset0:0 offset1:1
    v_exp_f32 v3, v3
    s_mov_b32 exec_hi, 0
    buffer_load_dword a35, v66, s[20:23], s67 offen offset:2176 sc1
    s_mov_b32 exec_hi, -1
    v_exp_f32 v4, v4
    v_exp_f32 v5, v5
    s_waitcnt vmcnt(8)
    v_mfma_f32_32x32x8bf16_1k v[16:31], a[32:33], a[166:167], 0
    v_exp_f32 v6, v6
    ds_read2_b32 v[54:55], v82 offset0:2 offset1:3
    v_exp_f32 v7, v7
    s_mov_b64 exec, s[64:65]
    buffer_load_dwordx4 a[64:67], v83, s[20:23], s67 offen offset:1024 sc1
    s_mov_b64 exec, -1
    v_exp_f32 v8, v8
    v_exp_f32 v9, v9
    v_mfma_f32_32x32x16_bf16 v[16:31], a[4:7], a[160:163], v[16:31]
    v_exp_f32 v10, v10
    ds_read_b32 v56, v81 offset:32
    v_mov_b32 v73, 158912
    v_exp_f32 v11, v11
    s_mov_b64 exec, s[64:65]
    buffer_load_dwordx4 a[68:71], v83, s[20:23], s67 offen offset:1600 sc1
    s_mov_b64 exec, -1
    s_add_u32 s67, s67, 2304
    s_cmp_ge_u32 s67, s63
    s_cselect_b32 s67, s62, s67
    v_exp_f32 v12, v12
    v_exp_f32 v13, v13
    v_smfmac_f32_32x32x32_bf16 a[104:119], a[40:43], v[0:7], v68
    v_exp_f32 v14, v14
    ds_read_b32 v60, v73
    v_mov_b32 v64, 0
    v_exp_f32 v15, v15
    s_setprio 3
    v_exp_f32 v16, v16
    buffer_load_dwordx4 a[16:19], v75, s[20:23], s67 offen sc1
    v_exp_f32 v17, v17
    v_smfmac_f32_32x32x32_bf16 a[104:119], a[44:47], v[8:15], v68
    v_exp_f32 v18, v18
    s_waitcnt lgkmcnt(0)
    v_cndmask_b32 v65, 0, v56, s[68:69]
    v_dot2c_f32_bf16 v64, v52, v52
    v_exp_f32 v19, v19
    s_mov_b32 exec_hi, 0
    buffer_load_dword a36, v66, s[20:23], s67 offen offset:2176 sc1
    s_mov_b32 exec_hi, -1
    v_dot2c_f32_bf16 v64, v53, v53
    v_exp_f32 v20, v20
    v_exp_f32 v21, v21
    s_waitcnt vmcnt(8)
    v_mfma_f32_32x32x8bf16_1k v[0:15], a[34:35], a[164:165], 0
    v_exp_f32 v22, v22
    v_dot2c_f32_bf16 v64, v54, v54
    v_exp_f32 v23, v23
    s_mov_b64 exec, s[64:65]
    buffer_load_dwordx4 a[72:75], v83, s[20:23], s67 offen offset:1024 sc1
    s_mov_b64 exec, -1
    v_dot2c_f32_bf16 v64, v55, v55
    v_exp_f32 v24, v24
    v_exp_f32 v25, v25
    v_mfma_f32_32x32x16_bf16 v[0:15], a[8:11], a[160:163], v[0:15]
    v_exp_f32 v26, v26
    v_dot2c_f32_bf16 v64, v65, v65
    v_exp_f32 v27, v27
    s_mov_b64 exec, s[64:65]
    buffer_load_dwordx4 a[76:79], v83, s[20:23], s67 offen offset:1600 sc1
    s_mov_b64 exec, -1
    s_add_u32 s67, s67, 2304
    s_cmp_ge_u32 s67, s63
    s_cselect_b32 s67, s62, s67
    v_exp_f32 v28, v28
    v_exp_f32 v29, v29
    v_smfmac_f32_32x32x32_bf16 a[104:119], a[48:51], v[16:23], v68
    v_mov_b32 v61, 0xc240
    v_exp_f32 v30, v30
    v_mov_b32 v65, v64
    v_cndmask_b32 v56, v61, v56, s[68:69]
    v_exp_f32 v31, v31
    s_setprio 2
    v_exp_f32 v0, v0
    buffer_load_dwordx4 a[20:23], v75, s[20:23], s67 offen sc1
    v_exp_f32 v1, v1
    v_smfmac_f32_32x32x32_bf16 a[104:119], a[52:55], v[24:31], v68
    v_permlane32_swap_b32 v64, v65
    s_lshl_b32 s59, s18, 11
    s_add_u32 s59, s59, 141440
    v_exp_f32 v2, v2
    v_add_f32 v64, v64, v65
    v_add_u32 v78, s59, v75
    v_exp_f32 v3, v3
    s_mov_b32 exec_hi, 0
    buffer_load_dword a37, v66, s[20:23], s67 offen offset:2176 sc1
    s_mov_b32 exec_hi, -1
    v_mul_f32 v64, v60, v64
    v_mov_b32 v57, 0
    v_exp_f32 v4, v4
    v_exp_f32 v5, v5
    s_waitcnt vmcnt(8)
    v_mfma_f32_32x32x8bf16_1k v[16:31], a[34:35], a[166:167], 0
    v_exp_f32 v6, v6
    ds_write_b128 v78, v[52:55]
    v_mov_b32 v58, 0
    v_exp_f32 v7, v7
    s_mov_b64 exec, s[64:65]
    buffer_load_dwordx4 a[80:83], v83, s[20:23], s67 offen offset:1024 sc1
    s_mov_b64 exec, -1
    v_cmp_nge_f32 vcc, 0x450d29a2, v64
    v_mov_b32 v59, v56
    v_exp_f32 v8, v8
    v_exp_f32 v9, v9
    v_mfma_f32_32x32x16_bf16 v[16:31], a[12:15], a[160:163], v[16:31]
    v_exp_f32 v10, v10
    ds_write_b128 v78, v[56:59] offset:1024
    v_exp_f32 v11, v11
    s_mov_b64 exec, s[64:65]
    buffer_load_dwordx4 a[84:87], v83, s[20:23], s67 offen offset:1600 sc1
    s_mov_b64 exec, -1
    s_add_u32 s67, s67, 2304
    s_cmp_ge_u32 s67, s63
    s_cselect_b32 s67, s62, s67
    s_cmp_lg_u64 vcc, 0
    s_cselect_b32 s58, 1, 0
    s_lshl_b32 s59, s18, 2
    s_add_u32 s59, s59, 158848
    v_mov_b32 v60, s59
    v_exp_f32 v12, v12
    v_exp_f32 v13, v13
    v_smfmac_f32_32x32x32_bf16 a[104:119], a[56:59], v[0:7], v68
    v_exp_f32 v14, v14
    v_mov_b32 v61, s58
    v_exp_f32 v15, v15
    s_setprio 1
    v_exp_f32 v16, v16
    buffer_load_dwordx4 a[24:27], v75, s[20:23], s67 offen sc1
    v_exp_f32 v17, v17
    v_smfmac_f32_32x32x32_bf16 a[104:119], a[60:63], v[8:15], v68
    ds_write_b32 v60, v61
    v_exp_f32 v18, v18
    v_exp_f32 v19, v19
    s_mov_b32 exec_hi, 0
    buffer_load_dword a38, v66, s[20:23], s67 offen offset:2176 sc1
    s_mov_b32 exec_hi, -1
    v_exp_f32 v20, v20
    v_exp_f32 v21, v21
    s_waitcnt vmcnt(8)
    v_mfma_f32_32x32x8bf16_1k v[0:15], a[36:37], a[164:165], 0
    v_exp_f32 v22, v22
    v_exp_f32 v23, v23
    s_mov_b64 exec, s[64:65]
    buffer_load_dwordx4 a[88:91], v83, s[20:23], s67 offen offset:1024 sc1
    s_mov_b64 exec, -1
    v_and_b32 v62, 7, v79
    s_mov_b32 s58, 158848
    v_exp_f32 v24, v24
    v_exp_f32 v25, v25
    v_mfma_f32_32x32x16_bf16 v[0:15], a[16:19], a[160:163], v[0:15]
    v_exp_f32 v26, v26
    v_exp_f32 v27, v27
    s_mov_b64 exec, s[64:65]
    buffer_load_dwordx4 a[92:95], v83, s[20:23], s67 offen offset:1600 sc1
    s_mov_b64 exec, -1
    s_add_u32 s67, s67, 2304
    s_cmp_ge_u32 s67, s63
    s_cselect_b32 s67, s62, s67
    v_lshl_add_u32 v62, v62, 2, s58
    v_exp_f32 v28, v28
    v_exp_f32 v29, v29
    v_smfmac_f32_32x32x32_bf16 a[104:119], a[64:67], v[16:23], v68
    v_exp_f32 v30, v30
    v_exp_f32 v31, v31
    s_waitcnt lgkmcnt(0)
    s_barrier
    s_setprio 3
    v_exp_f32 v0, v0
    buffer_load_dwordx4 a[28:31], v75, s[20:23], s67 offen sc1
    ds_read_b32 v63, v62
    v_exp_f32 v1, v1
    v_smfmac_f32_32x32x32_bf16 a[104:119], a[68:71], v[24:31], v68
    v_exp_f32 v2, v2
    v_exp_f32 v3, v3
    s_mov_b32 exec_hi, 0
    buffer_load_dword a39, v66, s[20:23], s67 offen offset:2176 sc1
    s_mov_b32 exec_hi, -1
    v_exp_f32 v4, v4
    v_exp_f32 v5, v5
    s_waitcnt vmcnt(8)
    v_mfma_f32_32x32x8bf16_1k v[16:31], a[36:37], a[166:167], 0
    v_exp_f32 v6, v6
    v_exp_f32 v7, v7
    s_mov_b64 exec, s[64:65]
    buffer_load_dwordx4 a[96:99], v83, s[20:23], s67 offen offset:1024 sc1
    s_mov_b64 exec, -1
    v_exp_f32 v8, v8
    v_exp_f32 v9, v9
    v_mfma_f32_32x32x16_bf16 v[16:31], a[20:23], a[160:163], v[16:31]
    v_exp_f32 v10, v10
    v_exp_f32 v11, v11
    s_mov_b64 exec, s[64:65]
    buffer_load_dwordx4 a[100:103], v83, s[20:23], s67 offen offset:1600 sc1
    s_mov_b64 exec, -1
    s_waitcnt lgkmcnt(0)
    v_cmp_ne_u32 vcc, 0, v63
    v_exp_f32 v12, v12
    v_exp_f32 v13, v13
    v_smfmac_f32_32x32x32_bf16 a[104:119], a[72:75], v[0:7], v68
    v_exp_f32 v14, v14
    v_exp_f32 v15, v15
    s_cbranch_vccnz L_slow
    s_setprio 3
    v_exp_f32 v16, v16
    v_exp_f32 v17, v17
    v_smfmac_f32_32x32x32_bf16 a[104:119], a[76:79], v[8:15], v68
    v_exp_f32 v18, v18
    v_exp_f32 v19, v19
    v_exp_f32 v20, v20
    v_exp_f32 v21, v21
    s_waitcnt vmcnt(6)
    v_mfma_f32_32x32x8bf16_1k v[0:15], a[38:39], a[164:165], 0
    v_exp_f32 v22, v22
    v_exp_f32 v23, v23
    v_exp_f32 v24, v24
    v_exp_f32 v25, v25
    v_mfma_f32_32x32x16_bf16 v[0:15], a[24:27], a[160:163], v[0:15]
    v_exp_f32 v26, v26
    v_exp_f32 v27, v27
    s_add_u32 s58, s48, 0
    buffer_load_dwordx4 a[120:123], v75, s[20:23], s58 offen sc1
    buffer_load_dwordx4 a[124:127], v75, s[20:23], s58 offen offset:1024 sc1
    v_exp_f32 v28, v28
    v_exp_f32 v29, v29
    v_smfmac_f32_32x32x32_bf16 a[104:119], a[80:83], v[16:23], v68
    v_exp_f32 v30, v30
    v_exp_f32 v31, v31
    s_setprio 2
    v_exp_f32 v0, v0
    s_add_u32 s58, s48, 2048
    buffer_load_dwordx4 a[128:131], v75, s[20:23], s58 offen sc1
    buffer_load_dwordx4 a[132:135], v75, s[20:23], s58 offen offset:1024 sc1
    v_exp_f32 v1, v1
    v_smfmac_f32_32x32x32_bf16 a[104:119], a[84:87], v[24:31], v68
    v_exp_f32 v2, v2
    v_exp_f32 v3, v3
    v_exp_f32 v4, v4
    v_exp_f32 v5, v5
    s_waitcnt vmcnt(6)
    v_mfma_f32_32x32x8bf16_1k v[16:31], a[38:39], a[166:167], 0
    v_exp_f32 v6, v6
    v_exp_f32 v7, v7
    s_add_u32 s58, s48, 4096
    buffer_load_dwordx4 a[136:139], v75, s[20:23], s58 offen sc1
    buffer_load_dwordx4 a[140:143], v75, s[20:23], s58 offen offset:1024 sc1
    v_exp_f32 v8, v8
    v_exp_f32 v9, v9
    v_mfma_f32_32x32x16_bf16 v[16:31], a[28:31], a[160:163], v[16:31]
    v_exp_f32 v10, v10
    ds_read_b128 a[160:163], v76
    ds_read_b128 a[164:167], v76 offset:1024
    v_add_u32 v76, 2048, v76
    v_exp_f32 v11, v11
    v_exp_f32 v12, v12
    v_exp_f32 v13, v13
    v_smfmac_f32_32x32x32_bf16 a[104:119], a[88:91], v[0:7], v68
    v_exp_f32 v14, v14
    v_exp_f32 v15, v15
    s_setprio 1
    v_exp_f32 v16, v16
    s_add_u32 s58, s48, 6144
    buffer_load_dwordx4 a[144:147], v75, s[20:23], s58 offen sc1
    buffer_load_dwordx4 a[148:151], v75, s[20:23], s58 offen offset:1024 sc1
    v_exp_f32 v17, v17
    v_smfmac_f32_32x32x32_bf16 a[104:119], a[92:95], v[8:15], v68
    v_exp_f32 v18, v18
    v_exp_f32 v19, v19
    v_exp_f32 v20, v20
    v_exp_f32 v21, v21
    s_waitcnt lgkmcnt(0)
    v_mfma_f32_32x32x8bf16_1k v[0:15], a[32:33], a[164:165], 0
    v_exp_f32 v22, v22
    v_exp_f32 v23, v23
    v_exp_f32 v24, v24
    v_exp_f32 v25, v25
    v_mfma_f32_32x32x16_bf16 v[0:15], a[0:3], a[160:163], v[0:15]
    v_exp_f32 v26, v26
    v_exp_f32 v27, v27
    v_exp_f32 v28, v28
    v_exp_f32 v29, v29
    s_waitcnt vmcnt(8)
    v_smfmac_f32_32x32x32_bf16 a[104:119], a[96:99], v[16:23], v68
    v_exp_f32 v30, v30
    v_exp_f32 v31, v31
    s_add_u32 s48, s48, 73728
    s_mov_b32 s55, 6
    s_cmp_eq_u32 s52, 0
    s_cbranch_scc1 L_a4n_loop
.p2align 3
L_a4x_loop:
    s_setprio 1
    v_exp_f32 v0, v0
    v_exp_f32 v1, v1
    v_smfmac_f32_32x32x32_bf16 a[104:119], a[100:103], v[24:31], v68
    v_exp_f32 v2, v2
    v_exp_f32 v3, v3
    v_exp_f32 v4, v4
    v_mfma_f32_32x32x8bf16_1k v[16:31], a[32:33], a[166:167], 0
    v_exp_f32 v5, v5
    v_exp_f32 v6, v6
    v_exp_f32 v7, v7
    v_exp_f32 v8, v8
    v_mfma_f32_32x32x16_bf16 v[16:31], a[4:7], a[160:163], v[16:31]
    ds_write_b128 v70, a[104:107]
    ds_write_b128 v70, a[108:111] offset:32
    ds_write_b64 v80, a[112:113]
    v_exp_f32 v9, v9
    s_setprio 0
    v_exp_f32 v10, v10
    v_exp_f32 v11, v11
    v_mfma_f32_32x32x8bf16_1k a[104:119], a[164:165], a[166:167], 0
    v_exp_f32 v12, v12
    v_exp_f32 v13, v13
    s_add_u32 m0, s49, 0
    s_nop 0
    buffer_load_dwordx4 v77, s[24:27], s53 offen nt lds
    v_exp_f32 v14, v14
    v_exp_f32 v15, v15
    v_smfmac_f32_32x32x32_bf16 a[104:119], a[40:43], v[0:7], v68
    s_waitcnt lgkmcnt(0)
    s_barrier
    s_setprio 3
    v_exp_f32 v16, v16
    ds_read2st64_b32 v[52:53], v49 offset0:0 offset1:10
    v_exp_f32 v17, v17
    v_exp_f32 v18, v18
    v_smfmac_f32_32x32x32_bf16 a[104:119], a[44:47], v[8:15], v68
    ds_read2st64_b32 v[54:55], v49 offset0:20 offset1:30
    v_exp_f32 v19, v19
    v_exp_f32 v20, v20
    ds_read2st64_b32 v[56:57], v49 offset0:40 offset1:50
    v_exp_f32 v21, v21
    v_mfma_f32_32x32x8bf16_1k v[0:15], a[34:35], a[164:165], 0
    v_exp_f32 v22, v22
    ds_read2st64_b32 v[58:59], v49 offset0:60 offset1:70
    v_exp_f32 v23, v23
    v_exp_f32 v24, v24
    ds_read2st64_b64 v[60:63], v48 offset0:0 offset1:5
    v_exp_f32 v25, v25
    v_mfma_f32_32x32x16_bf16 v[0:15], a[8:11], a[160:163], v[0:15]
    v_exp_f32 v26, v26
    ds_read2st64_b64 v[64:67], v48 offset0:10 offset1:15
    v_exp_f32 v27, v27
    v_exp_f32 v28, v28
    s_waitcnt lgkmcnt(2)
    v_add_f32 v52, v52, v53
    v_add_f32 v54, v54, v55
    v_exp_f32 v29, v29
    v_smfmac_f32_32x32x32_bf16 a[104:119], a[48:51], v[16:23], v68
    v_add_f32 v56, v56, v57
    v_add_f32 v58, v58, v59
    s_add_u32 m0, s49, 36864
    s_nop 0
    buffer_load_dwordx4 v77, s[28:31], s53 offen nt lds
    s_add_u32 s53, s53, 884736
    v_exp_f32 v30, v30
    v_add_f32 v52, v52, v54
    v_add_f32 v56, v56, v58
    v_exp_f32 v31, v31
    s_setprio 2
    v_exp_f32 v0, v0
    v_add_f32 v81, v52, v56
    v_exp_f32 v1, v1
    v_smfmac_f32_32x32x32_bf16 a[104:119], a[52:55], v[24:31], v68
    ds_read2st64_b64 v[52:55], v48 offset0:20 offset1:25
    v_exp_f32 v2, v2
    ds_read2st64_b64 v[56:59], v48 offset0:30 offset1:35
    v_exp_f32 v3, v3
    v_rcp_f32_dpp v73, v81 quad_perm:[2,2,2,2] row_mask:0xf bank_mask:0xf
    v_exp_f32 v4, v4
    s_waitcnt lgkmcnt(2)
    v_add_f32 v60, v60, v62
    v_add_f32 v61, v61, v63
    v_exp_f32 v5, v5
    v_mfma_f32_32x32x8bf16_1k v[16:31], a[34:35], a[166:167], 0
    v_exp_f32 v6, v6
    v_add_f32 v64, v64, v66
    v_add_f32 v65, v65, v67
    v_exp_f32 v7, v7
    v_mul_f32 v81, v81, v73
    v_exp_f32 v8, v8
    v_add_f32 v60, v60, v64
    v_add_f32 v61, v61, v65
    v_exp_f32 v9, v9
    v_mfma_f32_32x32x16_bf16 v[16:31], a[12:15], a[160:163], v[16:31]
    v_exp_f32 v10, v10
    v_cvt_pk_bf16_f32 v81, v81, v81
    v_exp_f32 v11, v11
    s_waitcnt lgkmcnt(0)
    v_add_f32 v52, v52, v54
    v_add_f32 v53, v53, v55
    v_exp_f32 v12, v12
    ds_write_b16 v51, v81
    v_exp_f32 v13, v13
    v_smfmac_f32_32x32x32_bf16 a[104:119], a[56:59], v[0:7], v68
    s_add_u32 m0, s49, 73728
    s_nop 0
    buffer_load_dwordx4 v75, s[32:35], s54 offen nt lds
    s_add_u32 s49, s49, 6144
    s_add_u32 s54, s54, 6144
    v_exp_f32 v14, v14
    v_add_f32 v56, v56, v58
    v_add_f32 v57, v57, v59
    v_exp_f32 v15, v15
    s_setprio 1
    v_add_f32 v52, v52, v56
    v_add_f32 v53, v53, v57
    v_exp_f32 v16, v16
    v_exp_f32 v17, v17
    v_smfmac_f32_32x32x32_bf16 a[104:119], a[60:63], v[8:15], v68
    v_add_f32 v52, v52, v60
    v_add_f32 v53, v53, v61
    v_exp_f32 v18, v18
    v_exp_f32 v19, v19
    v_mul_f32 v52, v52, v73
    v_mul_f32 v53, v53, v73
    v_exp_f32 v20, v20
    v_cvt_pk_bf16_f32 v56, v52, v53
    v_exp_f32 v21, v21
    v_mfma_f32_32x32x8bf16_1k v[0:15], a[36:37], a[164:165], 0
    v_exp_f32 v22, v22
    ds_write_b32 v50, v56
    v_exp_f32 v23, v23
    v_add_u32 v51, 16, v51
    v_exp_f32 v24, v24
    v_add_u32 v50, 1152, v50
    v_exp_f32 v25, v25
    v_mfma_f32_32x32x16_bf16 v[0:15], a[16:19], a[160:163], v[0:15]
    v_exp_f32 v26, v26
    v_exp_f32 v27, v27
    s_setprio 0
    v_exp_f32 v28, v28
    v_exp_f32 v29, v29
    v_smfmac_f32_32x32x32_bf16 a[104:119], a[64:67], v[16:23], v68
    v_exp_f32 v30, v30
    v_exp_f32 v31, v31
    s_waitcnt lgkmcnt(0)
    s_barrier
    s_setprio 3
    v_exp_f32 v0, v0
    ds_read_b128 a[168:171], v74
    v_add_u32 v74, 1152, v74
    v_exp_f32 v1, v1
    v_smfmac_f32_32x32x32_bf16 a[104:119], a[68:71], v[24:31], v68
    v_exp_f32 v2, v2
    v_exp_f32 v3, v3
    v_exp_f32 v4, v4
    v_exp_f32 v5, v5
    v_mfma_f32_32x32x8bf16_1k v[16:31], a[36:37], a[166:167], 0
    v_exp_f32 v6, v6
    v_exp_f32 v7, v7
    v_exp_f32 v8, v8
    v_exp_f32 v9, v9
    v_mfma_f32_32x32x16_bf16 v[16:31], a[20:23], a[160:163], v[16:31]
    v_exp_f32 v10, v10
    v_exp_f32 v11, v11
    v_exp_f32 v12, v12
    s_waitcnt lgkmcnt(0)
    s_waitcnt vmcnt(5)
    v_smfmac_f32_16x16x64_bf16 v[32:35], a[168:171], a[120:127], v69
    v_exp_f32 v13, v13
    v_smfmac_f32_32x32x32_bf16 a[104:119], a[72:75], v[0:7], v68
    v_exp_f32 v14, v14
    s_add_u32 s58, s48, 0
    buffer_load_dwordx4 a[120:123], v75, s[20:23], s58 offen sc1
    buffer_load_dwordx4 a[124:127], v75, s[20:23], s58 offen offset:1024 sc1
    v_exp_f32 v15, v15
    s_setprio 3
    v_exp_f32 v16, v16
    v_exp_f32 v17, v17
    v_smfmac_f32_32x32x32_bf16 a[104:119], a[76:79], v[8:15], v68
    v_exp_f32 v18, v18
    v_exp_f32 v19, v19
    v_exp_f32 v20, v20
    v_smfmac_f32_16x16x64_bf16 v[36:39], a[168:171], a[128:135], v69
    v_exp_f32 v21, v21
    v_mfma_f32_32x32x8bf16_1k v[0:15], a[38:39], a[164:165], 0
    v_exp_f32 v22, v22
    v_exp_f32 v23, v23
    s_add_u32 s58, s48, 2048
    buffer_load_dwordx4 a[128:131], v75, s[20:23], s58 offen sc1
    buffer_load_dwordx4 a[132:135], v75, s[20:23], s58 offen offset:1024 sc1
    v_exp_f32 v24, v24
    v_exp_f32 v25, v25
    v_mfma_f32_32x32x16_bf16 v[0:15], a[24:27], a[160:163], v[0:15]
    v_exp_f32 v26, v26
    v_exp_f32 v27, v27
    v_exp_f32 v28, v28
    v_exp_f32 v29, v29
    v_smfmac_f32_32x32x32_bf16 a[104:119], a[80:83], v[16:23], v68
    v_exp_f32 v30, v30
    v_exp_f32 v31, v31
    s_setprio 2
    v_exp_f32 v0, v0
    v_exp_f32 v1, v1
    v_smfmac_f32_32x32x32_bf16 a[104:119], a[84:87], v[24:31], v68
    v_exp_f32 v2, v2
    v_exp_f32 v3, v3
    v_exp_f32 v4, v4
    v_smfmac_f32_16x16x64_bf16 v[40:43], a[168:171], a[136:143], v69
    v_exp_f32 v5, v5
    v_mfma_f32_32x32x8bf16_1k v[16:31], a[38:39], a[166:167], 0
    v_exp_f32 v6, v6
    v_exp_f32 v7, v7
    s_add_u32 s58, s48, 4096
    buffer_load_dwordx4 a[136:139], v75, s[20:23], s58 offen sc1
    buffer_load_dwordx4 a[140:143], v75, s[20:23], s58 offen offset:1024 sc1
    v_exp_f32 v8, v8
    v_exp_f32 v9, v9
    v_mfma_f32_32x32x16_bf16 v[16:31], a[28:31], a[160:163], v[16:31]
    v_exp_f32 v10, v10
    ds_read_b128 a[160:163], v76
    ds_read_b128 a[164:167], v76 offset:1024
    v_add_u32 v76, 2048, v76
    v_exp_f32 v11, v11
    v_exp_f32 v12, v12
    v_exp_f32 v13, v13
    v_smfmac_f32_32x32x32_bf16 a[104:119], a[88:91], v[0:7], v68
    v_exp_f32 v14, v14
    v_exp_f32 v15, v15
    s_setprio 1
    v_exp_f32 v16, v16
    v_exp_f32 v17, v17
    v_smfmac_f32_32x32x32_bf16 a[104:119], a[92:95], v[8:15], v68
    v_exp_f32 v18, v18
    v_exp_f32 v19, v19
    v_exp_f32 v20, v20
    s_waitcnt vmcnt(9)
    v_smfmac_f32_16x16x64_bf16 v[44:47], a[168:171], a[144:151], v69
    v_exp_f32 v21, v21
    s_waitcnt lgkmcnt(0)
    v_mfma_f32_32x32x8bf16_1k v[0:15], a[32:33], a[164:165], 0
    v_exp_f32 v22, v22
    v_exp_f32 v23, v23
    s_add_u32 s58, s48, 6144
    buffer_load_dwordx4 a[144:147], v75, s[20:23], s58 offen sc1
    buffer_load_dwordx4 a[148:151], v75, s[20:23], s58 offen offset:1024 sc1
    v_exp_f32 v24, v24
    v_exp_f32 v25, v25
    v_mfma_f32_32x32x16_bf16 v[0:15], a[0:3], a[160:163], v[0:15]
    v_exp_f32 v26, v26
    v_exp_f32 v27, v27
    v_exp_f32 v28, v28
    v_exp_f32 v29, v29
    v_smfmac_f32_32x32x32_bf16 a[104:119], a[96:99], v[16:23], v68
    v_exp_f32 v30, v30
    v_exp_f32 v31, v31
    s_add_u32 s48, s48, 73728
    s_sub_u32 s55, s55, 1
    s_cmp_lg_u32 s55, 0
    s_cbranch_scc1 L_a4x_loop
    s_branch L_a4_last
.p2align 3
L_a4n_loop:
    s_setprio 1
    v_exp_f32 v0, v0
    v_exp_f32 v1, v1
    v_smfmac_f32_32x32x32_bf16 a[104:119], a[100:103], v[24:31], v68
    v_exp_f32 v2, v2
    v_exp_f32 v3, v3
    v_exp_f32 v4, v4
    v_mfma_f32_32x32x8bf16_1k v[16:31], a[32:33], a[166:167], 0
    v_exp_f32 v5, v5
    v_exp_f32 v6, v6
    v_exp_f32 v7, v7
    v_exp_f32 v8, v8
    v_mfma_f32_32x32x16_bf16 v[16:31], a[4:7], a[160:163], v[16:31]
    ds_write_b128 v70, a[104:107]
    ds_write_b128 v70, a[108:111] offset:32
    ds_write_b64 v80, a[112:113]
    v_exp_f32 v9, v9
    s_setprio 0
    v_exp_f32 v10, v10
    v_exp_f32 v11, v11
    v_mfma_f32_32x32x8bf16_1k a[104:119], a[164:165], a[166:167], 0
    v_exp_f32 v12, v12
    v_exp_f32 v13, v13
    v_exp_f32 v14, v14
    v_exp_f32 v15, v15
    v_smfmac_f32_32x32x32_bf16 a[104:119], a[40:43], v[0:7], v68
    s_waitcnt lgkmcnt(0)
    s_barrier
    s_setprio 3
    v_exp_f32 v16, v16
    ds_read2st64_b32 v[52:53], v49 offset0:0 offset1:10
    v_exp_f32 v17, v17
    v_exp_f32 v18, v18
    v_smfmac_f32_32x32x32_bf16 a[104:119], a[44:47], v[8:15], v68
    ds_read2st64_b32 v[54:55], v49 offset0:20 offset1:30
    v_exp_f32 v19, v19
    v_exp_f32 v20, v20
    ds_read2st64_b32 v[56:57], v49 offset0:40 offset1:50
    v_exp_f32 v21, v21
    v_mfma_f32_32x32x8bf16_1k v[0:15], a[34:35], a[164:165], 0
    v_exp_f32 v22, v22
    ds_read2st64_b32 v[58:59], v49 offset0:60 offset1:70
    v_exp_f32 v23, v23
    v_exp_f32 v24, v24
    ds_read2st64_b64 v[60:63], v48 offset0:0 offset1:5
    v_exp_f32 v25, v25
    v_mfma_f32_32x32x16_bf16 v[0:15], a[8:11], a[160:163], v[0:15]
    v_exp_f32 v26, v26
    ds_read2st64_b64 v[64:67], v48 offset0:10 offset1:15
    v_exp_f32 v27, v27
    v_exp_f32 v28, v28
    s_waitcnt lgkmcnt(2)
    v_add_f32 v52, v52, v53
    v_add_f32 v54, v54, v55
    v_exp_f32 v29, v29
    v_smfmac_f32_32x32x32_bf16 a[104:119], a[48:51], v[16:23], v68
    v_add_f32 v56, v56, v57
    v_add_f32 v58, v58, v59
    v_exp_f32 v30, v30
    v_add_f32 v52, v52, v54
    v_add_f32 v56, v56, v58
    v_exp_f32 v31, v31
    s_setprio 2
    v_exp_f32 v0, v0
    v_add_f32 v81, v52, v56
    v_exp_f32 v1, v1
    v_smfmac_f32_32x32x32_bf16 a[104:119], a[52:55], v[24:31], v68
    ds_read2st64_b64 v[52:55], v48 offset0:20 offset1:25
    v_exp_f32 v2, v2
    ds_read2st64_b64 v[56:59], v48 offset0:30 offset1:35
    v_exp_f32 v3, v3
    v_rcp_f32_dpp v73, v81 quad_perm:[2,2,2,2] row_mask:0xf bank_mask:0xf
    v_exp_f32 v4, v4
    s_waitcnt lgkmcnt(2)
    v_add_f32 v60, v60, v62
    v_add_f32 v61, v61, v63
    v_exp_f32 v5, v5
    v_mfma_f32_32x32x8bf16_1k v[16:31], a[34:35], a[166:167], 0
    v_exp_f32 v6, v6
    v_add_f32 v64, v64, v66
    v_add_f32 v65, v65, v67
    v_exp_f32 v7, v7
    v_mul_f32 v81, v81, v73
    v_exp_f32 v8, v8
    v_add_f32 v60, v60, v64
    v_add_f32 v61, v61, v65
    v_exp_f32 v9, v9
    v_mfma_f32_32x32x16_bf16 v[16:31], a[12:15], a[160:163], v[16:31]
    v_exp_f32 v10, v10
    v_cvt_pk_bf16_f32 v81, v81, v81
    v_exp_f32 v11, v11
    s_waitcnt lgkmcnt(0)
    v_add_f32 v52, v52, v54
    v_add_f32 v53, v53, v55
    v_exp_f32 v12, v12
    ds_write_b16 v51, v81
    v_exp_f32 v13, v13
    v_smfmac_f32_32x32x32_bf16 a[104:119], a[56:59], v[0:7], v68
    v_exp_f32 v14, v14
    v_add_f32 v56, v56, v58
    v_add_f32 v57, v57, v59
    v_exp_f32 v15, v15
    s_setprio 1
    v_add_f32 v52, v52, v56
    v_add_f32 v53, v53, v57
    v_exp_f32 v16, v16
    v_exp_f32 v17, v17
    v_smfmac_f32_32x32x32_bf16 a[104:119], a[60:63], v[8:15], v68
    v_add_f32 v52, v52, v60
    v_add_f32 v53, v53, v61
    v_exp_f32 v18, v18
    v_exp_f32 v19, v19
    v_mul_f32 v52, v52, v73
    v_mul_f32 v53, v53, v73
    v_exp_f32 v20, v20
    v_cvt_pk_bf16_f32 v56, v52, v53
    v_exp_f32 v21, v21
    v_mfma_f32_32x32x8bf16_1k v[0:15], a[36:37], a[164:165], 0
    v_exp_f32 v22, v22
    ds_write_b32 v50, v56
    v_exp_f32 v23, v23
    v_add_u32 v51, 16, v51
    v_exp_f32 v24, v24
    v_add_u32 v50, 1152, v50
    v_exp_f32 v25, v25
    v_mfma_f32_32x32x16_bf16 v[0:15], a[16:19], a[160:163], v[0:15]
    v_exp_f32 v26, v26
    v_exp_f32 v27, v27
    s_setprio 0
    v_exp_f32 v28, v28
    v_exp_f32 v29, v29
    v_smfmac_f32_32x32x32_bf16 a[104:119], a[64:67], v[16:23], v68
    v_exp_f32 v30, v30
    v_exp_f32 v31, v31
    s_waitcnt lgkmcnt(0)
    s_barrier
    s_setprio 3
    v_exp_f32 v0, v0
    ds_read_b128 a[168:171], v74
    v_add_u32 v74, 1152, v74
    v_exp_f32 v1, v1
    v_smfmac_f32_32x32x32_bf16 a[104:119], a[68:71], v[24:31], v68
    v_exp_f32 v2, v2
    v_exp_f32 v3, v3
    v_exp_f32 v4, v4
    v_exp_f32 v5, v5
    v_mfma_f32_32x32x8bf16_1k v[16:31], a[36:37], a[166:167], 0
    v_exp_f32 v6, v6
    v_exp_f32 v7, v7
    v_exp_f32 v8, v8
    v_exp_f32 v9, v9
    v_mfma_f32_32x32x16_bf16 v[16:31], a[20:23], a[160:163], v[16:31]
    v_exp_f32 v10, v10
    v_exp_f32 v11, v11
    v_exp_f32 v12, v12
    s_waitcnt lgkmcnt(0)
    s_waitcnt vmcnt(2)
    v_smfmac_f32_16x16x64_bf16 v[32:35], a[168:171], a[120:127], v69
    v_exp_f32 v13, v13
    v_smfmac_f32_32x32x32_bf16 a[104:119], a[72:75], v[0:7], v68
    v_exp_f32 v14, v14
    s_add_u32 s58, s48, 0
    buffer_load_dwordx4 a[120:123], v75, s[20:23], s58 offen sc1
    buffer_load_dwordx4 a[124:127], v75, s[20:23], s58 offen offset:1024 sc1
    v_exp_f32 v15, v15
    s_setprio 3
    v_exp_f32 v16, v16
    v_exp_f32 v17, v17
    v_smfmac_f32_32x32x32_bf16 a[104:119], a[76:79], v[8:15], v68
    v_exp_f32 v18, v18
    v_exp_f32 v19, v19
    v_exp_f32 v20, v20
    v_smfmac_f32_16x16x64_bf16 v[36:39], a[168:171], a[128:135], v69
    v_exp_f32 v21, v21
    v_mfma_f32_32x32x8bf16_1k v[0:15], a[38:39], a[164:165], 0
    v_exp_f32 v22, v22
    v_exp_f32 v23, v23
    s_add_u32 s58, s48, 2048
    buffer_load_dwordx4 a[128:131], v75, s[20:23], s58 offen sc1
    buffer_load_dwordx4 a[132:135], v75, s[20:23], s58 offen offset:1024 sc1
    v_exp_f32 v24, v24
    v_exp_f32 v25, v25
    v_mfma_f32_32x32x16_bf16 v[0:15], a[24:27], a[160:163], v[0:15]
    v_exp_f32 v26, v26
    v_exp_f32 v27, v27
    v_exp_f32 v28, v28
    v_exp_f32 v29, v29
    v_smfmac_f32_32x32x32_bf16 a[104:119], a[80:83], v[16:23], v68
    v_exp_f32 v30, v30
    v_exp_f32 v31, v31
    s_setprio 2
    v_exp_f32 v0, v0
    v_exp_f32 v1, v1
    v_smfmac_f32_32x32x32_bf16 a[104:119], a[84:87], v[24:31], v68
    v_exp_f32 v2, v2
    v_exp_f32 v3, v3
    v_exp_f32 v4, v4
    v_smfmac_f32_16x16x64_bf16 v[40:43], a[168:171], a[136:143], v69
    v_exp_f32 v5, v5
    v_mfma_f32_32x32x8bf16_1k v[16:31], a[38:39], a[166:167], 0
    v_exp_f32 v6, v6
    v_exp_f32 v7, v7
    s_add_u32 s58, s48, 4096
    buffer_load_dwordx4 a[136:139], v75, s[20:23], s58 offen sc1
    buffer_load_dwordx4 a[140:143], v75, s[20:23], s58 offen offset:1024 sc1
    v_exp_f32 v8, v8
    v_exp_f32 v9, v9
    v_mfma_f32_32x32x16_bf16 v[16:31], a[28:31], a[160:163], v[16:31]
    v_exp_f32 v10, v10
    ds_read_b128 a[160:163], v76
    ds_read_b128 a[164:167], v76 offset:1024
    v_add_u32 v76, 2048, v76
    v_exp_f32 v11, v11
    v_exp_f32 v12, v12
    v_exp_f32 v13, v13
    v_smfmac_f32_32x32x32_bf16 a[104:119], a[88:91], v[0:7], v68
    v_exp_f32 v14, v14
    v_exp_f32 v15, v15
    s_setprio 1
    v_exp_f32 v16, v16
    v_exp_f32 v17, v17
    v_smfmac_f32_32x32x32_bf16 a[104:119], a[92:95], v[8:15], v68
    v_exp_f32 v18, v18
    v_exp_f32 v19, v19
    v_exp_f32 v20, v20
    s_waitcnt vmcnt(6)
    v_smfmac_f32_16x16x64_bf16 v[44:47], a[168:171], a[144:151], v69
    v_exp_f32 v21, v21
    s_waitcnt lgkmcnt(0)
    v_mfma_f32_32x32x8bf16_1k v[0:15], a[32:33], a[164:165], 0
    v_exp_f32 v22, v22
    v_exp_f32 v23, v23
    s_add_u32 s58, s48, 6144
    buffer_load_dwordx4 a[144:147], v75, s[20:23], s58 offen sc1
    buffer_load_dwordx4 a[148:151], v75, s[20:23], s58 offen offset:1024 sc1
    v_exp_f32 v24, v24
    v_exp_f32 v25, v25
    v_mfma_f32_32x32x16_bf16 v[0:15], a[0:3], a[160:163], v[0:15]
    v_exp_f32 v26, v26
    v_exp_f32 v27, v27
    v_exp_f32 v28, v28
    v_exp_f32 v29, v29
    v_smfmac_f32_32x32x32_bf16 a[104:119], a[96:99], v[16:23], v68
    v_exp_f32 v30, v30
    v_exp_f32 v31, v31
    s_add_u32 s48, s48, 73728
    s_sub_u32 s55, s55, 1
    s_cmp_lg_u32 s55, 0
    s_cbranch_scc1 L_a4n_loop
L_a4_last:
    s_setprio 1
    v_exp_f32 v0, v0
    v_exp_f32 v1, v1
    v_smfmac_f32_32x32x32_bf16 a[104:119], a[100:103], v[24:31], v68
    v_exp_f32 v2, v2
    v_exp_f32 v3, v3
    v_exp_f32 v4, v4
    v_mfma_f32_32x32x8bf16_1k v[16:31], a[32:33], a[166:167], 0
    v_exp_f32 v5, v5
    v_exp_f32 v6, v6
    v_exp_f32 v7, v7
    v_exp_f32 v8, v8
    v_mfma_f32_32x32x16_bf16 v[16:31], a[4:7], a[160:163], v[16:31]
    ds_write_b128 v70, a[104:107]
    ds_write_b128 v70, a[108:111] offset:32
    ds_write_b64 v80, a[112:113]
    v_exp_f32 v9, v9
    s_setprio 0
    v_exp_f32 v10, v10
    v_exp_f32 v11, v11
    v_mfma_f32_32x32x8bf16_1k a[104:119], a[164:165], a[166:167], 0
    v_exp_f32 v12, v12
    v_exp_f32 v13, v13
    v_exp_f32 v14, v14
    v_exp_f32 v15, v15
    v_smfmac_f32_32x32x32_bf16 a[104:119], a[40:43], v[0:7], v68
    s_waitcnt lgkmcnt(0)
    s_barrier
    s_setprio 3
    v_exp_f32 v16, v16
    ds_read2st64_b32 v[52:53], v49 offset0:0 offset1:10
    v_exp_f32 v17, v17
    v_exp_f32 v18, v18
    v_smfmac_f32_32x32x32_bf16 a[104:119], a[44:47], v[8:15], v68
    ds_read2st64_b32 v[54:55], v49 offset0:20 offset1:30
    v_exp_f32 v19, v19
    v_exp_f32 v20, v20
    ds_read2st64_b32 v[56:57], v49 offset0:40 offset1:50
    v_exp_f32 v21, v21
    v_mfma_f32_32x32x8bf16_1k v[0:15], a[34:35], a[164:165], 0
    v_exp_f32 v22, v22
    ds_read2st64_b32 v[58:59], v49 offset0:60 offset1:70
    v_exp_f32 v23, v23
    v_exp_f32 v24, v24
    ds_read2st64_b64 v[60:63], v48 offset0:0 offset1:5
    v_exp_f32 v25, v25
    v_mfma_f32_32x32x16_bf16 v[0:15], a[8:11], a[160:163], v[0:15]
    v_exp_f32 v26, v26
    ds_read2st64_b64 v[64:67], v48 offset0:10 offset1:15
    s_add_u32 s58, s48, 73728
    buffer_load_dwordx4 a[0:3], v75, s[20:23], s58 offen sc1
    buffer_load_dwordx4 a[4:7], v75, s[20:23], s58 offen offset:1024 sc1
    v_exp_f32 v27, v27
    v_exp_f32 v28, v28
    s_waitcnt lgkmcnt(2)
    v_add_f32 v52, v52, v53
    v_add_f32 v54, v54, v55
    v_exp_f32 v29, v29
    v_smfmac_f32_32x32x32_bf16 a[104:119], a[48:51], v[16:23], v68
    v_add_f32 v56, v56, v57
    v_add_f32 v58, v58, v59
    s_add_u32 s58, s48, 75776
    buffer_load_dwordx4 a[40:43], v75, s[20:23], s58 offen sc1
    buffer_load_dwordx4 a[44:47], v75, s[20:23], s58 offen offset:1024 sc1
    v_exp_f32 v30, v30
    v_add_f32 v52, v52, v54
    v_add_f32 v56, v56, v58
    v_exp_f32 v31, v31
    s_setprio 2
    v_exp_f32 v0, v0
    v_add_f32 v81, v52, v56
    v_exp_f32 v1, v1
    v_smfmac_f32_32x32x32_bf16 a[104:119], a[52:55], v[24:31], v68
    ds_read2st64_b64 v[52:55], v48 offset0:20 offset1:25
    v_exp_f32 v2, v2
    ds_read2st64_b64 v[56:59], v48 offset0:30 offset1:35
    v_exp_f32 v3, v3
    v_rcp_f32_dpp v73, v81 quad_perm:[2,2,2,2] row_mask:0xf bank_mask:0xf
    v_exp_f32 v4, v4
    s_waitcnt lgkmcnt(2)
    v_add_f32 v60, v60, v62
    v_add_f32 v61, v61, v63
    v_exp_f32 v5, v5
    v_mfma_f32_32x32x8bf16_1k v[16:31], a[34:35], a[166:167], 0
    v_exp_f32 v6, v6
    v_add_f32 v64, v64, v66
    v_add_f32 v65, v65, v67
    v_exp_f32 v7, v7
    v_mul_f32 v81, v81, v73
    v_exp_f32 v8, v8
    v_add_f32 v60, v60, v64
    v_add_f32 v61, v61, v65
    v_exp_f32 v9, v9
    v_mfma_f32_32x32x16_bf16 v[16:31], a[12:15], a[160:163], v[16:31]
    v_exp_f32 v10, v10
    v_cvt_pk_bf16_f32 v81, v81, v81
    s_add_u32 s58, s48, 77824
    buffer_load_dwordx4 a[48:51], v75, s[20:23], s58 offen sc1
    buffer_load_dwordx4 a[52:55], v75, s[20:23], s58 offen offset:1024 sc1
    v_exp_f32 v11, v11
    s_waitcnt lgkmcnt(0)
    v_add_f32 v52, v52, v54
    v_add_f32 v53, v53, v55
    v_exp_f32 v12, v12
    ds_write_b16 v51, v81
    v_exp_f32 v13, v13
    v_smfmac_f32_32x32x32_bf16 a[104:119], a[56:59], v[0:7], v68
    v_exp_f32 v14, v14
    v_add_f32 v56, v56, v58
    v_add_f32 v57, v57, v59
    v_exp_f32 v15, v15
    s_setprio 1
    v_add_f32 v52, v52, v56
    v_add_f32 v53, v53, v57
    v_exp_f32 v16, v16
    v_exp_f32 v17, v17
    v_smfmac_f32_32x32x32_bf16 a[104:119], a[60:63], v[8:15], v68
    v_add_f32 v52, v52, v60
    v_add_f32 v53, v53, v61
    v_exp_f32 v18, v18
    v_exp_f32 v19, v19
    v_mul_f32 v52, v52, v73
    v_mul_f32 v53, v53, v73
    v_exp_f32 v20, v20
    v_cvt_pk_bf16_f32 v56, v52, v53
    v_exp_f32 v21, v21
    v_mfma_f32_32x32x8bf16_1k v[0:15], a[36:37], a[164:165], 0
    v_exp_f32 v22, v22
    ds_write_b32 v50, v56
    v_exp_f32 v23, v23
    v_add_u32 v51, 16, v51
    v_exp_f32 v24, v24
    v_add_u32 v50, 1152, v50
    v_exp_f32 v25, v25
    v_mfma_f32_32x32x16_bf16 v[0:15], a[16:19], a[160:163], v[0:15]
    v_exp_f32 v26, v26
    s_add_u32 s58, s48, 79872
    buffer_load_dwordx4 a[8:11], v75, s[20:23], s58 offen sc1
    buffer_load_dwordx4 a[12:15], v75, s[20:23], s58 offen offset:1024 sc1
    v_exp_f32 v27, v27
    s_setprio 0
    v_exp_f32 v28, v28
    v_exp_f32 v29, v29
    v_smfmac_f32_32x32x32_bf16 a[104:119], a[64:67], v[16:23], v68
    v_exp_f32 v30, v30
    v_exp_f32 v31, v31
    s_waitcnt lgkmcnt(0)
    s_barrier
    s_setprio 3
    v_exp_f32 v0, v0
    ds_read_b128 a[168:171], v74
    v_add_u32 v74, 1152, v74
    v_exp_f32 v1, v1
    v_smfmac_f32_32x32x32_bf16 a[104:119], a[68:71], v[24:31], v68
    v_exp_f32 v2, v2
    v_exp_f32 v3, v3
    v_exp_f32 v4, v4
    v_exp_f32 v5, v5
    v_mfma_f32_32x32x8bf16_1k v[16:31], a[36:37], a[166:167], 0
    v_exp_f32 v6, v6
    v_exp_f32 v7, v7
    v_exp_f32 v8, v8
    v_exp_f32 v9, v9
    v_mfma_f32_32x32x16_bf16 v[16:31], a[20:23], a[160:163], v[16:31]
    v_exp_f32 v10, v10
    v_exp_f32 v11, v11
    v_exp_f32 v12, v12
    s_waitcnt lgkmcnt(0)
    s_waitcnt vmcnt(14)
    v_smfmac_f32_16x16x64_bf16 v[32:35], a[168:171], a[120:127], v69
    v_exp_f32 v13, v13
    v_smfmac_f32_32x32x32_bf16 a[104:119], a[72:75], v[0:7], v68
    v_exp_f32 v14, v14
    s_add_u32 s58, s48, 0
    buffer_load_dwordx4 a[120:123], v75, s[20:23], s58 offen sc1
    buffer_load_dwordx4 a[124:127], v75, s[20:23], s58 offen offset:1024 sc1
    v_exp_f32 v15, v15
    s_setprio 3
    v_exp_f32 v16, v16
    v_exp_f32 v17, v17
    v_smfmac_f32_32x32x32_bf16 a[104:119], a[76:79], v[8:15], v68
    v_exp_f32 v18, v18
    v_exp_f32 v19, v19
    v_exp_f32 v20, v20
    s_waitcnt vmcnt(14)
    v_smfmac_f32_16x16x64_bf16 v[36:39], a[168:171], a[128:135], v69
    v_exp_f32 v21, v21
    v_mfma_f32_32x32x8bf16_1k v[0:15], a[38:39], a[164:165], 0
    v_exp_f32 v22, v22
    v_exp_f32 v23, v23
    s_add_u32 s58, s48, 2048
    buffer_load_dwordx4 a[128:131], v75, s[20:23], s58 offen sc1
    buffer_load_dwordx4 a[132:135], v75, s[20:23], s58 offen offset:1024 sc1
    v_exp_f32 v24, v24
    v_exp_f32 v25, v25
    v_mfma_f32_32x32x16_bf16 v[0:15], a[24:27], a[160:163], v[0:15]
    v_exp_f32 v26, v26
    v_exp_f32 v27, v27
    v_exp_f32 v28, v28
    v_exp_f32 v29, v29
    v_smfmac_f32_32x32x32_bf16 a[104:119], a[80:83], v[16:23], v68
    v_exp_f32 v30, v30
    v_exp_f32 v31, v31
    s_setprio 2
    v_exp_f32 v0, v0
    v_exp_f32 v1, v1
    v_smfmac_f32_32x32x32_bf16 a[104:119], a[84:87], v[24:31], v68
    v_exp_f32 v2, v2
    v_exp_f32 v3, v3
    v_exp_f32 v4, v4
    s_waitcnt vmcnt(14)
    v_smfmac_f32_16x16x64_bf16 v[40:43], a[168:171], a[136:143], v69
    v_exp_f32 v5, v5
    v_mfma_f32_32x32x8bf16_1k v[16:31], a[38:39], a[166:167], 0
    v_exp_f32 v6, v6
    v_exp_f32 v7, v7
    s_add_u32 s58, s48, 4096
    buffer_load_dwordx4 a[136:139], v75, s[20:23], s58 offen sc1
    buffer_load_dwordx4 a[140:143], v75, s[20:23], s58 offen offset:1024 sc1
    v_exp_f32 v8, v8
    v_exp_f32 v9, v9
    v_mfma_f32_32x32x16_bf16 v[16:31], a[28:31], a[160:163], v[16:31]
    v_exp_f32 v10, v10
    v_exp_f32 v11, v11
    v_exp_f32 v12, v12
    v_exp_f32 v13, v13
    v_smfmac_f32_32x32x32_bf16 a[104:119], a[88:91], v[0:7], v68
    v_exp_f32 v14, v14
    v_exp_f32 v15, v15
    s_setprio 1
    v_exp_f32 v16, v16
    v_exp_f32 v17, v17
    v_smfmac_f32_32x32x32_bf16 a[104:119], a[92:95], v[8:15], v68
    v_exp_f32 v18, v18
    v_lshlrev_b32 v82, 2, v79
    s_lshl_b32 s59, s2, 3
    s_add_u32 s59, s59, s18
    s_mul_i32 s59, s59, 1152
    buffer_load_dwordx4 v[0:3], v75, s[36:39], s59 offen
    buffer_load_dword v4, v82, s[36:39], s59 offen offset:1024
    buffer_load_dwordx4 v[6:9], v75, s[44:47], 0 offen
    buffer_load_dword v10, v82, s[44:47], 0 offen offset:1024
    v_exp_f32 v19, v19
    v_exp_f32 v20, v20
    s_waitcnt vmcnt(18)
    v_smfmac_f32_16x16x64_bf16 v[44:47], a[168:171], a[144:151], v69
    v_exp_f32 v21, v21
    v_exp_f32 v22, v22
    v_exp_f32 v23, v23
    s_add_u32 s58, s48, 6144
    buffer_load_dwordx4 a[144:147], v75, s[20:23], s58 offen sc1
    buffer_load_dwordx4 a[148:151], v75, s[20:23], s58 offen offset:1024 sc1
    v_exp_f32 v24, v24
    v_exp_f32 v25, v25
    v_exp_f32 v26, v26
    v_exp_f32 v27, v27
    v_exp_f32 v28, v28
    v_exp_f32 v29, v29
    v_smfmac_f32_32x32x32_bf16 a[104:119], a[96:99], v[16:23], v68
    v_exp_f32 v30, v30
    v_exp_f32 v31, v31
    s_setprio 0
    s_nop 0
    v_smfmac_f32_32x32x32_bf16 a[104:119], a[100:103], v[24:31], v68
    s_nop 9
    ds_write_b128 v70, a[104:107]
    ds_write_b128 v70, a[108:111] offset:32
    ds_write_b64 v80, a[112:113]
    s_waitcnt lgkmcnt(0)
    s_barrier
    ds_read2st64_b64 v[52:55], v71 offset0:0 offset1:5
    ds_read2st64_b64 v[56:59], v71 offset0:10 offset1:15
    ds_read2st64_b64 v[60:63], v71 offset0:20 offset1:25
    ds_read2st64_b64 v[64:67], v71 offset0:30 offset1:35
    v_and_b32 v22, 15, v79
    v_bfe_u32 v23, v79, 4, 1
    v_mul_u32_u24 v23, 10304, v23
    v_lshl_add_u32 v22, v22, 2, v23
    s_lshl_b32 s58, s56, 6
    s_add_u32 s58, s58, 110592
    v_add_u32 v22, s58, v22
    v_lshrrev_b32 v23, 5, v79
    v_lshl_add_u32 v23, v23, 6, v22
    v_add_u32 v24, 128, v23
    s_waitcnt lgkmcnt(2)
    v_add_f32 v52, v52, v54
    v_add_f32 v53, v53, v55
    v_add_f32 v56, v56, v58
    v_add_f32 v57, v57, v59
    v_add_f32 v52, v52, v56
    v_add_f32 v53, v53, v57
    s_waitcnt lgkmcnt(0)
    v_add_f32 v60, v60, v62
    v_add_f32 v61, v61, v63
    v_add_f32 v64, v64, v66
    v_add_f32 v65, v65, v67
    v_add_f32 v60, v60, v64
    v_add_f32 v61, v61, v65
    v_add_f32 v52, v52, v60
    v_add_f32 v53, v53, v61
    s_nop 0
    v_rcp_f32_dpp v54, v52 row_newbcast:9 row_mask:0xf bank_mask:0xf
    s_nop 0
    v_mul_f32 v52, v52, v54
    v_mul_f32 v53, v53, v54
    v_cvt_pk_bf16_f32 v56, v52, v53
    ds_write_b32 v72, v56
    s_waitcnt vmcnt(2)
    v_lshlrev_b32 v12, 16, v0
    v_and_b32 v13, 0xffff0000, v0
    v_lshlrev_b32 v14, 16, v1
    v_and_b32 v15, 0xffff0000, v1
    v_lshlrev_b32 v16, 16, v2
    v_and_b32 v17, 0xffff0000, v2
    v_lshlrev_b32 v18, 16, v3
    v_and_b32 v19, 0xffff0000, v3
    v_lshlrev_b32 v20, 16, v4
    v_and_b32 v21, 0xffff0000, v4
    s_waitcnt lgkmcnt(0)
    s_barrier
    ds_read_b128 a[160:163], v74 offset:1152
    ds_read_b128 a[168:171], v74
    v_mov_b32 v60, 0
    v_mov_b32 v61, 0x3f803f80
    s_mul_i32 s58, s18, 2560
    s_lshr_b32 s59, s18, 2
    s_lshl_b32 s59, s59, 6
    s_add_u32 s58, s58, s59
    s_add_u32 s58, s58, 110592
    v_lshl_add_u32 v62, v79, 5, s58
    v_lshl_add_u32 v63, v79, 3, s58
    v_dot2c_f32_bf16 v60, v6, v61
    v_dot2c_f32_bf16 v60, v7, v61
    v_dot2c_f32_bf16 v60, v8, v61
    v_dot2c_f32_bf16 v60, v9, v61
    v_dot2c_f32_bf16 v60, v10, v61
    s_waitcnt lgkmcnt(1)
    v_smfmac_f32_16x16x64_bf16 v[32:35], a[160:163], a[0:7], v69
    v_smfmac_f32_16x16x64_bf16 v[36:39], a[160:163], a[40:47], v69
    v_smfmac_f32_16x16x64_bf16 v[40:43], a[160:163], a[48:55], v69
    v_smfmac_f32_16x16x64_bf16 v[44:47], a[160:163], a[8:15], v69
    s_waitcnt lgkmcnt(0)
    v_smfmac_f32_16x16x64_bf16 v[32:35], a[168:171], a[120:127], v69
    v_smfmac_f32_16x16x64_bf16 v[36:39], a[168:171], a[128:135], v69
    v_smfmac_f32_16x16x64_bf16 v[40:43], a[168:171], a[136:143], v69
    s_waitcnt vmcnt(0)
    v_smfmac_f32_16x16x64_bf16 v[44:47], a[168:171], a[144:151], v69
    s_nop 5
    v_permlane32_swap_b32 v32, v36
    v_permlane32_swap_b32 v33, v37
    v_permlane32_swap_b32 v34, v38
    v_permlane32_swap_b32 v35, v39
    v_add_f32 v32, v32, v36
    v_add_f32 v33, v33, v37
    v_add_f32 v34, v34, v38
    v_add_f32 v35, v35, v39
    ds_write2st64_b32 v23, v32, v33 offset0:0 offset1:10
    ds_write2st64_b32 v23, v34, v35 offset0:20 offset1:30
    v_permlane32_swap_b32 v40, v44
    v_permlane32_swap_b32 v41, v45
    v_permlane32_swap_b32 v42, v46
    v_permlane32_swap_b32 v43, v47
    v_add_f32 v40, v40, v44
    v_add_f32 v41, v41, v45
    v_add_f32 v42, v42, v46
    v_add_f32 v43, v43, v47
    ds_write2st64_b32 v24, v40, v41 offset0:0 offset1:10
    ds_write2st64_b32 v24, v42, v43 offset0:20 offset1:30
    s_branch L_tail
L_tail:
    v_mov_b32 v46, 0
    v_mov_b32 v47, 0
    s_waitcnt lgkmcnt(0)
    v_mov_b32 v48, 0
    v_mov_b32 v49, v60
    v_mov_b32 v51, v61
    s_barrier
    ds_read_b128 v[22:25], v62
    ds_read_b128 v[26:29], v62 offset:16
    ds_read_b64 v[30:31], v63 offset:2048
    s_mov_b32 s62, -1
    s_mov_b32 s63, 0
    s_lshl_b32 s59, s2, 3
    s_add_u32 s59, s59, s18
    s_sub_u32 s69, 2047, s59
    s_lshl_b32 s58, s18, 2
    s_add_u32 s58, s58, 158880
    v_mov_b32 v57, s58
    v_and_b32 v55, 7, v79
    s_mov_b32 s58, 158880
    v_lshl_add_u32 v55, v55, 2, s58
    s_mov_b32 s60, 33024
    v_mul_lo_u32 v56, s60, v79
    v_mov_b32 v52, 0x3ae38e39
    s_waitcnt lgkmcnt(2)
    v_pk_add_f32 v[22:23], v[22:23], v[12:13]
    v_cvt_pk_bf16_f32 v32, v22, v23
    v_dot2c_f32_bf16 v46, v32, v51
    v_dot2c_f32_bf16 v47, v32, v32
    v_dot2c_f32_bf16 v48, v32, v6
    v_pk_add_f32 v[24:25], v[24:25], v[14:15]
    v_cvt_pk_bf16_f32 v33, v24, v25
    v_dot2c_f32_bf16 v46, v33, v51
    v_dot2c_f32_bf16 v47, v33, v33
    v_dot2c_f32_bf16 v48, v33, v7
    s_waitcnt lgkmcnt(1)
    v_pk_add_f32 v[26:27], v[26:27], v[16:17]
    v_cvt_pk_bf16_f32 v34, v26, v27
    v_dot2c_f32_bf16 v46, v34, v51
    v_dot2c_f32_bf16 v47, v34, v34
    v_dot2c_f32_bf16 v48, v34, v8
    v_pk_add_f32 v[28:29], v[28:29], v[18:19]
    v_cvt_pk_bf16_f32 v35, v28, v29
    v_dot2c_f32_bf16 v46, v35, v51
    v_dot2c_f32_bf16 v47, v35, v35
    v_dot2c_f32_bf16 v48, v35, v9
    s_waitcnt lgkmcnt(0)
    v_pk_add_f32 v[30:31], v[30:31], v[20:21]
    v_cvt_pk_bf16_f32 v36, v30, v31
    v_cndmask_b32 v36, 0, v36, s[62:63]
    v_dot2c_f32_bf16 v46, v36, v51
    v_dot2c_f32_bf16 v47, v36, v36
    v_dot2c_f32_bf16 v48, v36, v10
    s_lshl_b32 s60, s2, 7
    s_add_u32 s60, s60, 3211264
    s_nop 0
    v_permlane32_swap_b32 v46, v47
    v_permlane32_swap_b32 v48, v49
    v_add_f32 v46, v46, v47
    v_add_f32 v48, v48, v49
    s_nop 1
    v_permlane16_swap_b32 v46, v48
    v_add_f32 v46, v46, v48
    s_nop 1
    v_add_f32_dpp v46, v46, v46 row_ror:8 row_mask:0xf bank_mask:0xf
    s_nop 1
    v_add_f32_dpp v46, v46, v46 row_ror:4 row_mask:0xf bank_mask:0xf
    s_nop 1
    v_add_f32_dpp v46, v46, v46 row_ror:2 row_mask:0xf bank_mask:0xf
    s_nop 1
    v_add_f32_dpp v46, v46, v46 row_ror:1 row_mask:0xf bank_mask:0xf
    s_nop 0
    v_readlane_b32 s64, v46, 0
    v_readlane_b32 s65, v46, 32
    v_readlane_b32 s66, v46, 16
    v_readlane_b32 s67, v46, 48
    v_mul_f32 v46, s64, v52
    v_mul_f32 v47, s65, v52
    v_fma_f32 v47, -v46, v46, v47
    v_max_f32 v47, 0, v47
    v_cvt_pk_bf16_f32 v47, v47, v47
    v_and_b32 v47, 0xffff0000, v47
    v_add_f32 v47, 0x3727c5ac, v47
    v_cvt_pk_bf16_f32 v47, v47, v47
    v_and_b32 v47, 0xffff0000, v47
    v_sqrt_f32 v47, v47
    v_cvt_pk_bf16_f32 v46, v46, v46
    v_and_b32 v46, 0xffff0000, v46
    v_cvt_pk_bf16_f32 v47, v47, v47
    v_and_b32 v47, 0xffff0000, v47
    v_rcp_f32 v48, v47
    v_mov_b32 v53, s66
    v_fma_f32 v53, -v46, s67, v53
    v_mul_f32 v53, v53, v48
    v_cvt_pk_bf16_f32 v53, v53, v53
    v_ashrrev_i32 v54, 31, v53
    v_or_b32 v54, 0x80000000, v54
    v_xor_b32 v53, v53, v54
    v_lshrrev_b32 v53, 16, v53
    v_lshl_or_b32 v53, v53, 11, s69
    ds_write_b32 v57, v53
    s_getreg_b32 s58, hwreg(HW_REG_XCC_ID)
    s_and_b32 s58, s58, 7
    s_mul_i32 s58, s58, 33024
    s_and_b32 s64, s18, 3
    s_lshl_b32 s64, s64, 13
    s_add_u32 s58, s58, s64
    s_add_u32 s64, s58, 3211264
    v_lshlrev_b32 v65, 7, v79
    s_waitcnt lgkmcnt(0)
    s_barrier
    ds_read_b32 v54, v55
    s_mov_b32 s61, 0
    s_waitcnt lgkmcnt(0)
    v_cmp_gt_u32 vcc, v54, v53
    s_cbranch_vccnz L_notbest
    s_mov_b64 exec, 0xff
    buffer_store_dword v53, v56, s[20:23], s60 offen sc1
    s_mov_b64 exec, -1
    s_mov_b32 s61, 1
L_notbest:
    v_max_u32_dpp v54, v54, v54 row_ror:4 row_mask:0xf bank_mask:0xf
    s_nop 1
    v_max_u32_dpp v54, v54, v54 row_ror:2 row_mask:0xf bank_mask:0xf
    s_nop 1
    v_max_u32_dpp v54, v54, v54 row_ror:1 row_mask:0xf bank_mask:0xf
    s_nop 1
    v_readfirstlane_b32 s65, v54
    s_xor_b32 s65, s65, s18
    s_and_b32 s65, s65, 4
    v_sub_f32 v56, 0, v46
    v_mov_b32 v57, v56
    v_mov_b32 v49, v48
    v_lshlrev_b32 v12, 16, v32
    v_and_b32 v13, 0xffff0000, v32
    v_lshlrev_b32 v14, 16, v33
    v_and_b32 v15, 0xffff0000, v33
    v_lshlrev_b32 v16, 16, v34
    v_and_b32 v17, 0xffff0000, v34
    v_lshlrev_b32 v18, 16, v35
    v_and_b32 v19, 0xffff0000, v35
    v_lshlrev_b32 v20, 16, v36
    v_and_b32 v21, 0xffff0000, v36
    v_pk_add_f32 v[22:23], v[12:13], v[56:57]
    v_pk_add_f32 v[24:25], v[14:15], v[56:57]
    v_pk_add_f32 v[26:27], v[16:17], v[56:57]
    v_pk_add_f32 v[28:29], v[18:19], v[56:57]
    v_pk_add_f32 v[30:31], v[20:21], v[56:57]
    v_cvt_pk_bf16_f32 v38, v22, v23
    v_cvt_pk_bf16_f32 v39, v24, v25
    v_cvt_pk_bf16_f32 v40, v26, v27
    v_cvt_pk_bf16_f32 v41, v28, v29
    v_cvt_pk_bf16_f32 v42, v30, v31
    v_lshlrev_b32 v22, 16, v38
    v_and_b32 v23, 0xffff0000, v38
    v_lshlrev_b32 v24, 16, v39
    v_and_b32 v25, 0xffff0000, v39
    v_lshlrev_b32 v26, 16, v40
    v_and_b32 v27, 0xffff0000, v40
    v_lshlrev_b32 v28, 16, v41
    v_and_b32 v29, 0xffff0000, v41
    v_lshlrev_b32 v30, 16, v42
    v_and_b32 v31, 0xffff0000, v42
    v_pk_mul_f32 v[22:23], v[22:23], v[48:49]
    v_pk_mul_f32 v[24:25], v[24:25], v[48:49]
    v_pk_mul_f32 v[26:27], v[26:27], v[48:49]
    v_pk_mul_f32 v[28:29], v[28:29], v[48:49]
    v_pk_mul_f32 v[30:31], v[30:31], v[48:49]
    v_cvt_pk_bf16_f32 v38, v22, v23
    v_cvt_pk_bf16_f32 v39, v24, v25
    v_cvt_pk_bf16_f32 v40, v26, v27
    v_cvt_pk_bf16_f32 v41, v28, v29
    v_cvt_pk_bf16_f32 v42, v30, v31
    v_lshlrev_b32 v58, 2, v79
    s_cmp_eq_u32 s61, 1
    s_cbranch_scc0 L_norow
    s_mul_i32 s58, s2, 2304
    s_add_u32 s58, s58, 3538944
    buffer_store_dwordx4 v[38:41], v75, s[20:23], s58 offen sc1
    buffer_store_dwordx4 v[32:35], v75, s[20:23], s58 offen offset:1152 sc1
    s_mov_b32 exec_hi, 0
    buffer_store_dword v42, v58, s[20:23], s58 offen offset:1024 sc1
    buffer_store_dword v36, v58, s[20:23], s58 offen offset:2176 sc1
    s_mov_b32 exec_hi, -1
L_norow:
    v_lshlrev_b32 v22, 16, v38
    v_and_b32 v23, 0xffff0000, v38
    v_lshlrev_b32 v24, 16, v39
    v_and_b32 v25, 0xffff0000, v39
    v_lshlrev_b32 v26, 16, v40
    v_and_b32 v27, 0xffff0000, v40
    v_lshlrev_b32 v28, 16, v41
    v_and_b32 v29, 0xffff0000, v41
    v_lshlrev_b32 v30, 16, v42
    v_and_b32 v31, 0xffff0000, v42
    v_pk_add_f32 v[22:23], v[22:23], v[12:13]
    v_pk_add_f32 v[24:25], v[24:25], v[14:15]
    v_pk_add_f32 v[26:27], v[26:27], v[16:17]
    v_pk_add_f32 v[28:29], v[28:29], v[18:19]
    v_pk_add_f32 v[30:31], v[30:31], v[20:21]
    v_cvt_pk_bf16_f32 v60, v22, v23
    v_cvt_pk_bf16_f32 v61, v24, v25
    v_cvt_pk_bf16_f32 v62, v26, v27
    v_cvt_pk_bf16_f32 v63, v28, v29
    v_cvt_pk_bf16_f32 v64, v30, v31
    s_mul_i32 s68, s59, 1152
    s_cmp_eq_u32 s61, 1
    s_cbranch_scc1 L_defer
    buffer_store_dwordx4 v[60:63], v75, s[40:43], s68 offen
    s_mov_b32 exec_hi, 0
    buffer_store_dword v64, v58, s[40:43], s68 offen offset:1024
    s_mov_b32 exec_hi, -1
L_defer:
    v_lshrrev_b32 v1, 4, v79
    v_bfe_u32 v2, v79, 2, 2
    v_and_b32 v3, 3, v79
    v_lshl_add_u32 v2, v1, 3, v2
    s_cmp_ge_u32 s19, 144
    s_cbranch_scc1 L_nopre
    s_and_b32 s58, s18, 1
    v_and_b32 v4, 1, v1
    v_xor_b32 v4, s58, v4
    v_lshlrev_b32 v4, 5, v4
    v_lshl_add_u32 v4, v2, 6, v4
    v_lshl_add_u32 v4, v3, 3, v4
    s_bfe_u32 s58, s18, 0x10001
    s_mul_i32 s58, s58, 36864
    s_lshr_b32 s60, s18, 2
    s_mul_i32 s69, s60, 18432
    s_add_u32 s58, s58, s69
    v_add_u32 v4, s58, v4
    v_mul_u32_u24 v5, 1152, v2
    v_lshl_add_u32 v5, v3, 3, v5
    s_lshl_b32 s58, s56, 5
    s_add_u32 s58, s58, 73728
    v_add_u32 v5, s58, v5
    ds_read_b64_tr_b16 a[0:1], v4 offset:0
    ds_read_b64_tr_b16 a[2:3], v4 offset:256
    ds_read_b64_tr_b16 a[4:5], v4 offset:2048
    ds_read_b64_tr_b16 a[6:7], v4 offset:2304
    ds_read_b64_tr_b16 a[8:9], v4 offset:4096
    ds_read_b64_tr_b16 a[10:11], v4 offset:4352
    ds_read_b64_tr_b16 a[12:13], v4 offset:6144
    ds_read_b64_tr_b16 a[14:15], v4 offset:6400
    ds_read_b64_tr_b16 a[16:17], v4 offset:8192
    ds_read_b64_tr_b16 a[18:19], v4 offset:8448
    ds_read_b64_tr_b16 a[20:21], v4 offset:10240
    ds_read_b64_tr_b16 a[22:23], v4 offset:10496
    ds_read_b64_tr_b16 a[24:25], v4 offset:12288
    ds_read_b64_tr_b16 a[26:27], v4 offset:12544
    ds_read_b64_tr_b16 a[28:29], v4 offset:14336
    ds_read_b64_tr_b16 a[30:31], v4 offset:14592
    ds_read_b64_tr_b16 a[32:33], v4 offset:16384
    ds_read_b64_tr_b16 a[34:35], v4 offset:16640
    ds_read_b64_tr_b16 a[60:61], v5 offset:0
    ds_read_b64_tr_b16 a[62:63], v5 offset:4608
    ds_read_b64_tr_b16 a[64:65], v5 offset:32
    ds_read_b64_tr_b16 a[66:67], v5 offset:4640
    ds_read_b64_tr_b16 a[68:69], v5 offset:64
    ds_read_b64_tr_b16 a[70:71], v5 offset:4672
    ds_read_b64_tr_b16 a[72:73], v5 offset:96
    ds_read_b64_tr_b16 a[74:75], v5 offset:4704
    ds_read_b64_tr_b16 a[76:77], v5 offset:128
    ds_read_b64_tr_b16 a[78:79], v5 offset:4736
L_nopre:
    s_cmp_lg_u32 s65, 0
    s_cbranch_scc1 L_polled
    s_mov_b32 s60, 0
L_poll:
    buffer_load_dword v66, v65, s[20:23], s64 offen sc1
    s_add_u32 s60, s60, 1
    s_waitcnt vmcnt(0)
L_pollchk:
    v_cmp_eq_u32 vcc, -1, v66
    s_and_b64 exec, exec, vcc
    s_cbranch_execz L_polldone
    s_cmp_gt_u32 s60, 40000
    s_cbranch_scc1 L_polldone
    s_sleep 3
    s_branch L_poll
L_polldone:
    s_mov_b64 exec, -1
    s_nop 1
    s_nop 1
    v_max_u32_dpp v66, v66, v66 row_shr:1 row_mask:0xf bank_mask:0xf
    s_nop 1
    v_max_u32_dpp v66, v66, v66 row_shr:2 row_mask:0xf bank_mask:0xf
    s_nop 1
    v_max_u32_dpp v66, v66, v66 row_shr:4 row_mask:0xf bank_mask:0xf
    s_nop 1
    v_max_u32_dpp v66, v66, v66 row_shr:8 row_mask:0xf bank_mask:0xf
    s_nop 1
    v_max_u32_dpp v66, v66, v66 row_bcast:15 row_mask:0xa bank_mask:0xf
    s_nop 1
    v_max_u32_dpp v66, v66, v66 row_bcast:31 row_mask:0xc bank_mask:0xf
    s_and_b32 s58, s18, 3
    s_lshl_b32 s58, s58, 2
    s_add_u32 s58, s58, 158912
    v_mov_b32 v8, s58
    s_mov_b32 exec_lo, 0
    s_mov_b32 exec_hi, 0x80000000
    ds_write_b32 v8, v66
    s_mov_b64 exec, -1
L_polled:
    v_mov_b32 v8, 158912
    s_waitcnt lgkmcnt(0)
    s_barrier
    ds_read_b128 v[10:13], v8
    s_waitcnt lgkmcnt(0)
    v_max_u32 v10, v10, v11
    v_max3_u32 v10, v10, v12, v13
    s_nop 0
    v_readfirstlane_b32 s62, v10
    s_and_b32 s63, s62, 2047
    s_sub_u32 s63, 2047, s63
    s_lshr_b32 s64, s63, 3
    s_mul_i32 s64, s64, 2304
    s_add_u32 s64, s64, 3538944
    s_cmp_ge_u32 s19, 144
    s_cbranch_scc1 L_noffn
    s_lshr_b32 s60, s18, 2
    s_mul_i32 s60, s60, 576
    s_add_u32 s60, s60, s64
    s_mul_i32 s68, s18, 576
    s_add_u32 m0, s68, 110592
    s_mov_b32 s66, -1
    s_mov_b32 s67, 0xf
    v_lshlrev_b32 v6, 4, v1
    s_mov_b32 s65, 0
L_xsel:
    s_mov_b64 exec, s[66:67]
    buffer_load_dwordx4 v75, s[20:23], s60 offen sc1 lds
    s_mov_b64 exec, -1
    s_add_u32 s65, s65, 1
    s_lshl_b32 s58, s18, 6
    s_add_u32 s58, s58, 158976
    v_add_u32 v7, s58, v6
    v_and_b32 v8, 31, v79
    s_mov_b32 s58, 158976
    v_lshl_add_u32 v9, v8, 2, s58
    s_lshl_b32 s58, s18, 6
    s_add_u32 s58, s58, 159488
    v_lshl_add_u32 v8, v8, 1, s58
    v_add_u32 v51, s58, v6
    v_lshrrev_b32 v2, 3, v79
    v_mul_u32_u24 v2, 4608, v2
    v_and_b32 v3, 7, v79
    v_lshl_add_u32 v2, v3, 2, v2
    s_mul_i32 s58, s56, 9216
    s_lshl_b32 s69, s19, 5
    s_add_u32 s58, s58, s69
    s_add_u32 s58, s58, 4128768
    s_add_u32 s69, s68, 110592
    v_add_u32 v52, s69, v6
    s_waitcnt vmcnt(0)
    ds_read_b128 v[10:13], v52 offset:0
    ds_read_b128 v[14:17], v52 offset:64
    ds_read_b128 v[18:21], v52 offset:128
    ds_read_b128 v[22:25], v52 offset:192
    ds_read_b128 v[26:29], v52 offset:256
    ds_read_b128 v[30:33], v52 offset:320
    ds_read_b128 v[34:37], v52 offset:384
    ds_read_b128 v[38:41], v52 offset:448
    ds_read_b128 v[42:45], v52 offset:512
    s_waitcnt lgkmcnt(8)
    v_mfma_f32_16x16x32_bf16 v[46:49], a[0:3], v[10:13], 0
    v_max_u32 v50, v10, v11
    v_max3_u32 v50, v50, v12, v13
    s_waitcnt lgkmcnt(7)
    v_mfma_f32_16x16x32_bf16 v[46:49], a[4:7], v[14:17], v[46:49]
    v_max3_u32 v50, v50, v14, v15
    v_max3_u32 v50, v50, v16, v17
    s_waitcnt lgkmcnt(6)
    v_mfma_f32_16x16x32_bf16 v[46:49], a[8:11], v[18:21], v[46:49]
    v_max3_u32 v50, v50, v18, v19
    v_max3_u32 v50, v50, v20, v21
    s_waitcnt lgkmcnt(5)
    v_mfma_f32_16x16x32_bf16 v[46:49], a[12:15], v[22:25], v[46:49]
    v_max3_u32 v50, v50, v22, v23
    v_max3_u32 v50, v50, v24, v25
    s_waitcnt lgkmcnt(4)
    v_mfma_f32_16x16x32_bf16 v[46:49], a[16:19], v[26:29], v[46:49]
    v_max3_u32 v50, v50, v26, v27
    v_max3_u32 v50, v50, v28, v29
    s_waitcnt lgkmcnt(3)
    v_mfma_f32_16x16x32_bf16 v[46:49], a[20:23], v[30:33], v[46:49]
    v_max3_u32 v50, v50, v30, v31
    v_max3_u32 v50, v50, v32, v33
    s_waitcnt lgkmcnt(2)
    v_mfma_f32_16x16x32_bf16 v[46:49], a[24:27], v[34:37], v[46:49]
    v_max3_u32 v50, v50, v34, v35
    v_max3_u32 v50, v50, v36, v37
    s_waitcnt lgkmcnt(1)
    v_mfma_f32_16x16x32_bf16 v[46:49], a[28:31], v[38:41], v[46:49]
    v_max3_u32 v50, v50, v38, v39
    v_max3_u32 v50, v50, v40, v41
    s_waitcnt lgkmcnt(0)
    v_mfma_f32_16x16x32_bf16 v[46:49], a[32:35], v[42:45], v[46:49]
    v_max3_u32 v50, v50, v42, v43
    v_max3_u32 v50, v50, v44, v45
    v_cmp_eq_u32 vcc, -1, v50
    s_cbranch_vccz L_xok
    s_cmp_gt_u32 s65, 40000
    s_cbranch_scc0 L_xsel
L_xok:
    s_mul_i32 s68, s59, 1152
    s_mov_b32 s66, 0x00010001
    s_mov_b32 s67, 0x00010001
    s_mov_b64 exec, s[66:67]
    ds_write_b128 v7, v[46:49]
    s_mov_b64 exec, -1
    s_waitcnt lgkmcnt(0)
    s_barrier
    ds_read2_b32 v[10:11], v9 offset0:0 offset1:64
    ds_read2_b32 v[12:13], v9 offset0:32 offset1:96
    s_waitcnt lgkmcnt(1)
    v_add_f32 v10, v10, v11
    v_cvt_pk_bf16_f32 v10, v10, v10
    v_and_b32 v10, 0xffff0000, v10
    v_mul_f32 v11, 0xbfb8aa3b, v10
    v_exp_f32 v11, v11
    s_waitcnt lgkmcnt(0)
    v_add_f32 v12, v12, v13
    v_add_f32 v11, 1.0, v11
    v_rcp_f32 v11, v11
    v_cvt_pk_bf16_f32 v12, v12, v12
    v_and_b32 v12, 0xffff0000, v12
    v_mul_f32 v10, v10, v11
    v_cvt_pk_bf16_f32 v10, v10, v10
    v_and_b32 v10, 0xffff0000, v10
    v_mul_f32 v10, v10, v12
    v_cvt_pk_bf16_f32 v10, v10, v10
    ds_write_b16 v8, v10
    s_waitcnt lgkmcnt(0)
    ds_read_b128 v[12:15], v51
    s_waitcnt lgkmcnt(0)
    v_mfma_f32_16x16x32_bf16 v[16:19], v[12:15], a[60:63], 0
    v_mfma_f32_16x16x32_bf16 v[20:23], v[12:15], a[64:67], 0
    v_mfma_f32_16x16x32_bf16 v[24:27], v[12:15], a[68:71], 0
    v_mfma_f32_16x16x32_bf16 v[28:31], v[12:15], a[72:75], 0
    v_mfma_f32_16x16x32_bf16 v[32:35], v[12:15], a[76:79], 0
    s_mov_b32 s64, 0xffff0000
    s_mov_b32 s65, 0
    s_mov_b32 s66, 0
    s_mov_b32 s67, 0xffff
    s_nop 0
    v_cndmask_b32 v16, v16, v20, s[64:65]
    s_mov_b32 s65, 0xffff0000
    s_mov_b32 s64, 0
    v_cndmask_b32 v16, v16, v24, s[66:67]
    s_add_u32 s69, s58, 36864
    s_cmp_ge_u32 s18, 4
    v_cndmask_b32 v16, v16, v28, s[64:65]
    buffer_store_dword v16, v2, s[20:23], s58 offen sc1
    s_cbranch_scc1 L_ffndone
    s_mov_b64 exec, 0xffff
    buffer_store_dword v32, v2, s[20:23], s69 offen sc1
L_ffndone:
    s_mov_b64 exec, -1
    s_branch L_last
L_noffn:
    s_sub_u32 s69, s19, 144
    s_cmp_ge_u32 s69, 72
    s_cbranch_scc1 L_last
    s_cmp_lg_u32 s18, 0
    s_cbranch_scc1 L_last
    s_cmp_eq_u32 s61, 0
    s_cbranch_scc1 L_finrow
    s_cmp_eq_u32 s63, s59
    s_cbranch_scc1 L_finrow
    buffer_store_dwordx4 v[60:63], v75, s[40:43], s68 offen
    s_mov_b32 exec_hi, 0
    buffer_store_dword v64, v58, s[40:43], s68 offen offset:1024
    s_mov_b32 exec_hi, -1
L_finrow:
    s_mov_b32 s61, 0
    s_lshl_b32 s58, s69, 4
    s_add_u32 s58, s58, s64
    v_and_b32 v1, 1, v79
    v_lshlrev_b32 v2, 3, v1
    v_bfe_u32 v1, v79, 4, 1
    v_lshl_add_u32 v2, v1, 2, v2
    v_lshrrev_b32 v1, 5, v79
    v_lshl_add_u32 v2, v1, 1, v2
    s_lshr_b32 s65, s62, 11
    s_lshl_b32 s65, s65, 16
    s_not_b32 s66, s65
    s_ashr_i32 s66, s66, 31
    s_or_b32 s66, s66, 0x80000000
    s_xor_b32 s65, s65, s66
    s_and_b32 s65, s65, 0xffff0000
    v_mov_b32 v3, s65
    v_mul_f32 v3, 0xbfb8aa3b, v3
    v_exp_f32 v3, v3
    s_mul_i32 s60, s69, 4608
    s_add_u32 s60, s60, 4128768
    v_add_f32 v3, 1.0, v3
    v_rcp_f32 v3, v3
    s_mov_b32 s65, 0
    v_mov_b32 v26, 0
    v_mov_b32 v27, 0
    v_mov_b32 v28, 0
    v_mov_b32 v29, 0
    v_mov_b32 v30, 0
    v_cvt_pk_bf16_f32 v3, v3, v3
    v_and_b32 v3, 0xffff0000, v3
L_fin0:
    buffer_load_dwordx4 v[10:13], v30, s[20:23], s58 offen sc1
    buffer_load_dwordx4 v[14:17], v30, s[20:23], s58 offen offset:1152 sc1
    s_add_u32 s65, s65, 1
    s_waitcnt vmcnt(0)
    v_max3_u32 v8, v10, v11, v12
    v_max3_u32 v8, v8, v13, v14
    v_max3_u32 v8, v8, v15, v16
    v_max_u32 v8, v8, v17
    v_cmp_eq_u32 vcc, -1, v8
    s_cbranch_vccz L_fin1
    s_cmp_gt_u32 s65, 40000
    s_cbranch_scc0 L_fin0
L_fin1:
    buffer_load_ushort v4, v2, s[20:23], s58 offen sc1
    buffer_load_ushort v5, v2, s[20:23], s58 offen offset:1152 sc1
    s_mul_i32 s59, s63, 1152
    s_lshl_b32 s64, s69, 4
    s_add_u32 s59, s59, s64
    s_sleep 28
L_fin:
    buffer_load_dwordx4 v[10:13], v75, s[20:23], s60 offen offset:0 sc1
    buffer_load_dwordx4 v[14:17], v75, s[20:23], s60 offen offset:1024 sc1
    buffer_load_dwordx4 v[18:21], v75, s[20:23], s60 offen offset:2048 sc1
    buffer_load_dwordx4 v[22:25], v75, s[20:23], s60 offen offset:3072 sc1
    s_add_u32 s66, s60, 4096
    s_mov_b32 s67, exec_hi
    s_mov_b32 exec_hi, 0
    buffer_load_dwordx4 v[26:29], v75, s[20:23], s66 offen sc1
    s_mov_b32 exec_hi, s67
    s_add_u32 s65, s65, 1
    s_waitcnt vmcnt(0)
    v_mov_b32 v8, v10
    v_max3_u32 v8, v8, v11, v12
    v_max3_u32 v8, v8, v13, v14
    v_max3_u32 v8, v8, v15, v16
    v_max3_u32 v8, v8, v17, v18
    v_max3_u32 v8, v8, v19, v20
    v_max3_u32 v8, v8, v21, v22
    v_max3_u32 v8, v8, v23, v24
    v_max3_u32 v8, v8, v25, v26
    v_max3_u32 v8, v8, v27, v28
    v_max_u32 v8, v8, v29
    v_cmp_eq_u32 vcc, -1, v8
    s_and_b64 exec, exec, vcc
    s_cbranch_execz L_finok
    s_cmp_gt_u32 s65, 40000
    s_cbranch_scc1 L_finok
    s_sleep 2
    s_branch L_fin
L_finok:
    s_mov_b64 exec, -1
    v_pk_add_f32 v[10:11], v[10:11], v[14:15]
    v_pk_add_f32 v[12:13], v[12:13], v[16:17]
    v_pk_add_f32 v[18:19], v[18:19], v[22:23]
    v_pk_add_f32 v[20:21], v[20:21], v[24:25]
    v_pk_add_f32 v[10:11], v[10:11], v[26:27]
    v_pk_add_f32 v[12:13], v[12:13], v[28:29]
    v_pk_add_f32 v[10:11], v[10:11], v[18:19]
    v_pk_add_f32 v[12:13], v[12:13], v[20:21]
    v_lshlrev_b32 v4, 16, v4
    v_lshlrev_b32 v5, 16, v5
    v_permlane32_swap_b32 v10, v11
    v_permlane32_swap_b32 v12, v13
    v_add_f32 v10, v10, v11
    v_add_f32 v12, v12, v13
    s_mov_b32 s64, 0x00030003
    s_mov_b32 s65, 0x00030003
    v_permlane16_swap_b32 v10, v12
    v_add_f32 v10, v10, v12
    s_nop 1
    v_add_f32_dpp v10, v10, v10 row_ror:8 row_mask:0xf bank_mask:0xf
    s_nop 1
    v_add_f32_dpp v10, v10, v10 row_ror:4 row_mask:0xf bank_mask:0xf
    s_nop 1
    v_add_f32_dpp v10, v10, v10 row_ror:2 row_mask:0xf bank_mask:0xf
    v_cvt_pk_bf16_f32 v10, v10, v10
    v_and_b32 v10, 0xffff0000, v10
    v_mul_f32 v10, v3, v10
    v_cvt_pk_bf16_f32 v10, v10, v10
    v_and_b32 v10, 0xffff0000, v10
    v_add_f32 v10, v4, v10
    v_cvt_pk_bf16_f32 v10, v10, v10
    v_and_b32 v10, 0xffff0000, v10
    v_add_f32 v10, v5, v10
    v_cvt_pk_bf16_f32 v10, v10, v10
    s_mov_b64 exec, s[64:65]
    buffer_store_short v10, v2, s[40:43], s59 offen
    s_branch L_end
L_last:
    s_cmp_eq_u32 s61, 0
    s_cbranch_scc1 L_end
    s_cmp_eq_u32 s63, s59
    s_cbranch_scc1 L_end
    buffer_store_dwordx4 v[60:63], v75, s[40:43], s68 offen
    s_mov_b32 exec_hi, 0
    buffer_store_dword v64, v58, s[40:43], s68 offen offset:1024
    s_mov_b32 exec_hi, -1
L_end:
    s_endpgm
L_slow:
    s_setprio 0
    v_and_b32 v52, 31, v79
    v_add_u32 v76, 141440, v75
    s_lshl_b32 s58, s18, 7
    s_add_u32 s58, s58, 110592
    v_lshl_add_u32 v53, v52, 2, s58
    s_mov_b32 s55, 8
    s_waitcnt vmcnt(0) lgkmcnt(0)
    s_nop 15
    s_nop 15
L_mx:
    ds_read_b128 a[160:163], v76
    ds_read_b128 a[164:167], v76 offset:1024
    v_add_u32 v76, 2048, v76
    v_mov_b32 v78, 0xff800000
    s_waitcnt lgkmcnt(0)
    v_mfma_f32_32x32x8bf16_1k v[0:15], a[32:33], a[164:165], 0
    v_mfma_f32_32x32x16_bf16 v[0:15], a[0:3], a[160:163], v[0:15]
    s_nop 11
    v_max3_f32 v78, v78, v0, v1
    v_max3_f32 v78, v78, v2, v3
    v_max3_f32 v78, v78, v4, v5
    v_max3_f32 v78, v78, v6, v7
    v_max3_f32 v78, v78, v8, v9
    v_max3_f32 v78, v78, v10, v11
    v_max3_f32 v78, v78, v12, v13
    v_max3_f32 v78, v78, v14, v15
    s_nop 7
    v_mfma_f32_32x32x8bf16_1k v[0:15], a[32:33], a[166:167], 0
    v_mfma_f32_32x32x16_bf16 v[0:15], a[4:7], a[160:163], v[0:15]
    s_nop 11
    v_max3_f32 v78, v78, v0, v1
    v_max3_f32 v78, v78, v2, v3
    v_max3_f32 v78, v78, v4, v5
    v_max3_f32 v78, v78, v6, v7
    v_max3_f32 v78, v78, v8, v9
    v_max3_f32 v78, v78, v10, v11
    v_max3_f32 v78, v78, v12, v13
    v_max3_f32 v78, v78, v14, v15
    s_nop 7
    v_mfma_f32_32x32x8bf16_1k v[0:15], a[34:35], a[164:165], 0
    v_mfma_f32_32x32x16_bf16 v[0:15], a[8:11], a[160:163], v[0:15]
    s_nop 11
    v_max3_f32 v78, v78, v0, v1
    v_max3_f32 v78, v78, v2, v3
    v_max3_f32 v78, v78, v4, v5
    v_max3_f32 v78, v78, v6, v7
    v_max3_f32 v78, v78, v8, v9
    v_max3_f32 v78, v78, v10, v11
    v_max3_f32 v78, v78, v12, v13
    v_max3_f32 v78, v78, v14, v15
    s_nop 7
    v_mfma_f32_32x32x8bf16_1k v[0:15], a[34:35], a[166:167], 0
    v_mfma_f32_32x32x16_bf16 v[0:15], a[12:15], a[160:163], v[0:15]
    s_nop 11
    v_max3_f32 v78, v78, v0, v1
    v_max3_f32 v78, v78, v2, v3
    v_max3_f32 v78, v78, v4, v5
    v_max3_f32 v78, v78, v6, v7
    v_max3_f32 v78, v78, v8, v9
    v_max3_f32 v78, v78, v10, v11
    v_max3_f32 v78, v78, v12, v13
    v_max3_f32 v78, v78, v14, v15
    s_nop 7
    v_mfma_f32_32x32x8bf16_1k v[0:15], a[36:37], a[164:165], 0
    v_mfma_f32_32x32x16_bf16 v[0:15], a[16:19], a[160:163], v[0:15]
    s_nop 11
    v_max3_f32 v78, v78, v0, v1
    v_max3_f32 v78, v78, v2, v3
    v_max3_f32 v78, v78, v4, v5
    v_max3_f32 v78, v78, v6, v7
    v_max3_f32 v78, v78, v8, v9
    v_max3_f32 v78, v78, v10, v11
    v_max3_f32 v78, v78, v12, v13
    v_max3_f32 v78, v78, v14, v15
    s_nop 7
    v_mfma_f32_32x32x8bf16_1k v[0:15], a[36:37], a[166:167], 0
    v_mfma_f32_32x32x16_bf16 v[0:15], a[20:23], a[160:163], v[0:15]
    s_nop 11
    v_max3_f32 v78, v78, v0, v1
    v_max3_f32 v78, v78, v2, v3
    v_max3_f32 v78, v78, v4, v5
    v_max3_f32 v78, v78, v6, v7
    v_max3_f32 v78, v78, v8, v9
    v_max3_f32 v78, v78, v10, v11
    v_max3_f32 v78, v78, v12, v13
    v_max3_f32 v78, v78, v14, v15
    s_nop 7
    v_mfma_f32_32x32x8bf16_1k v[0:15], a[38:39], a[164:165], 0
    v_mfma_f32_32x32x16_bf16 v[0:15], a[24:27], a[160:163], v[0:15]
    s_nop 11
    v_max3_f32 v78, v78, v0, v1
    v_max3_f32 v78, v78, v2, v3
    v_max3_f32 v78, v78, v4, v5
    v_max3_f32 v78, v78, v6, v7
    v_max3_f32 v78, v78, v8, v9
    v_max3_f32 v78, v78, v10, v11
    v_max3_f32 v78, v78, v12, v13
    v_max3_f32 v78, v78, v14, v15
    s_nop 7
    v_mfma_f32_32x32x8bf16_1k v[0:15], a[38:39], a[166:167], 0
    v_mfma_f32_32x32x16_bf16 v[0:15], a[28:31], a[160:163], v[0:15]
    s_nop 11
    v_max3_f32 v78, v78, v0, v1
    v_max3_f32 v78, v78, v2, v3
    v_max3_f32 v78, v78, v4, v5
    v_max3_f32 v78, v78, v6, v7
    v_max3_f32 v78, v78, v8, v9
    v_max3_f32 v78, v78, v10, v11
    v_max3_f32 v78, v78, v12, v13
    v_max3_f32 v78, v78, v14, v15
    s_nop 7
    v_mov_b32 v26, v78
    s_nop 1
    v_permlane32_swap_b32 v78, v26
    v_max_f32 v78, v78, v26
    ds_write_b32 v53, v78
    v_add_u32 v53, 1024, v53
    s_sub_u32 s55, s55, 1
    s_cmp_lg_u32 s55, 0
    s_cbranch_scc1 L_mx
    v_and_b32 v3, 31, v79
    s_lshl_b32 s58, s18, 10
    s_add_u32 s58, s58, 110592
    v_lshl_add_u32 v25, v3, 2, s58
    s_waitcnt lgkmcnt(0)
    s_barrier
    ds_read2_b32 v[8:9], v25 offset0:0 offset1:32
    ds_read2_b32 v[10:11], v25 offset0:64 offset1:96
    ds_read2_b32 v[12:13], v25 offset0:128 offset1:160
    ds_read2_b32 v[14:15], v25 offset0:192 offset1:224
    s_mov_b32 s58, 160000
    v_lshl_add_u32 v82, v3, 2, s58
    s_lshl_b32 s58, s18, 7
    v_add_u32 v25, s58, v82
    s_waitcnt lgkmcnt(0)
    v_max3_f32 v8, v8, v9, v10
    v_max3_f32 v8, v8, v11, v12
    v_max3_f32 v8, v8, v13, v14
    v_max_f32 v8, v8, v15
    ds_write_b32 v25, v8
    v_add_u32 v76, 141440, v75
    s_waitcnt lgkmcnt(0)
    s_barrier
    ds_read_b128 a[160:163], v76
    ds_read_b128 a[164:167], v76 offset:1024
    v_add_u32 v76, 2048, v76
    s_cmp_ge_u32 s18, 4
    s_cbranch_scc1 L_s4
    s_waitcnt lgkmcnt(0)
    v_mfma_f32_32x32x8bf16_1k v[0:15], a[32:33], a[164:165], 0
    v_mfma_f32_32x32x16_bf16 v[0:15], a[0:3], a[160:163], v[0:15]
    v_mfma_f32_32x32x8bf16_1k a[104:119], a[164:165], a[166:167], 0
    ds_read_b32 v78, v82
    v_add_u32 v82, 128, v82
    s_waitcnt lgkmcnt(0)
    s_nop 5
    s_setprio 1
    v_sub_f32 v0, v0, v78
    v_exp_f32 v0, v0
    v_sub_f32 v1, v1, v78
    v_exp_f32 v1, v1
    v_sub_f32 v2, v2, v78
    v_exp_f32 v2, v2
    v_sub_f32 v3, v3, v78
    v_exp_f32 v3, v3
    v_sub_f32 v4, v4, v78
    v_exp_f32 v4, v4
    v_sub_f32 v5, v5, v78
    v_exp_f32 v5, v5
    v_mfma_f32_32x32x8bf16_1k v[16:31], a[32:33], a[166:167], 0
    v_sub_f32 v6, v6, v78
    v_exp_f32 v6, v6
    v_sub_f32 v7, v7, v78
    v_exp_f32 v7, v7
    v_sub_f32 v8, v8, v78
    v_exp_f32 v8, v8
    v_sub_f32 v9, v9, v78
    v_exp_f32 v9, v9
    v_mfma_f32_32x32x16_bf16 v[16:31], a[4:7], a[160:163], v[16:31]
    v_sub_f32 v10, v10, v78
    v_exp_f32 v10, v10
    v_sub_f32 v11, v11, v78
    v_exp_f32 v11, v11
    v_sub_f32 v12, v12, v78
    v_exp_f32 v12, v12
    v_sub_f32 v13, v13, v78
    v_exp_f32 v13, v13
    v_smfmac_f32_32x32x32_bf16 a[104:119], a[40:43], v[0:7], v68
    v_sub_f32 v14, v14, v78
    v_exp_f32 v14, v14
    v_sub_f32 v15, v15, v78
    v_exp_f32 v15, v15
    s_setprio 3
    v_sub_f32 v16, v16, v78
    v_exp_f32 v16, v16
    v_sub_f32 v17, v17, v78
    v_exp_f32 v17, v17
    v_smfmac_f32_32x32x32_bf16 a[104:119], a[44:47], v[8:15], v68
    v_sub_f32 v18, v18, v78
    v_exp_f32 v18, v18
    v_sub_f32 v19, v19, v78
    v_exp_f32 v19, v19
    v_sub_f32 v20, v20, v78
    v_exp_f32 v20, v20
    v_sub_f32 v21, v21, v78
    v_exp_f32 v21, v21
    v_mfma_f32_32x32x8bf16_1k v[0:15], a[34:35], a[164:165], 0
    v_sub_f32 v22, v22, v78
    v_exp_f32 v22, v22
    v_sub_f32 v23, v23, v78
    v_exp_f32 v23, v23
    v_sub_f32 v24, v24, v78
    v_exp_f32 v24, v24
    v_sub_f32 v25, v25, v78
    v_exp_f32 v25, v25
    v_mfma_f32_32x32x16_bf16 v[0:15], a[8:11], a[160:163], v[0:15]
    v_sub_f32 v26, v26, v78
    v_exp_f32 v26, v26
    v_sub_f32 v27, v27, v78
    v_exp_f32 v27, v27
    v_sub_f32 v28, v28, v78
    v_exp_f32 v28, v28
    v_sub_f32 v29, v29, v78
    v_exp_f32 v29, v29
    v_smfmac_f32_32x32x32_bf16 a[104:119], a[48:51], v[16:23], v68
    v_sub_f32 v30, v30, v78
    v_exp_f32 v30, v30
    v_sub_f32 v31, v31, v78
    v_exp_f32 v31, v31
    s_setprio 1
    v_sub_f32 v0, v0, v78
    v_exp_f32 v0, v0
    v_sub_f32 v1, v1, v78
    v_exp_f32 v1, v1
    v_smfmac_f32_32x32x32_bf16 a[104:119], a[52:55], v[24:31], v68
    v_sub_f32 v2, v2, v78
    v_exp_f32 v2, v2
    v_sub_f32 v3, v3, v78
    v_exp_f32 v3, v3
    v_sub_f32 v4, v4, v78
    v_exp_f32 v4, v4
    v_sub_f32 v5, v5, v78
    v_exp_f32 v5, v5
    v_mfma_f32_32x32x8bf16_1k v[16:31], a[34:35], a[166:167], 0
    v_sub_f32 v6, v6, v78
    v_exp_f32 v6, v6
    v_sub_f32 v7, v7, v78
    v_exp_f32 v7, v7
    v_sub_f32 v8, v8, v78
    v_exp_f32 v8, v8
    v_sub_f32 v9, v9, v78
    v_exp_f32 v9, v9
    v_mfma_f32_32x32x16_bf16 v[16:31], a[12:15], a[160:163], v[16:31]
    v_sub_f32 v10, v10, v78
    v_exp_f32 v10, v10
    v_sub_f32 v11, v11, v78
    v_exp_f32 v11, v11
    v_sub_f32 v12, v12, v78
    v_exp_f32 v12, v12
    v_sub_f32 v13, v13, v78
    v_exp_f32 v13, v13
    v_smfmac_f32_32x32x32_bf16 a[104:119], a[56:59], v[0:7], v68
    v_sub_f32 v14, v14, v78
    v_exp_f32 v14, v14
    v_sub_f32 v15, v15, v78
    v_exp_f32 v15, v15
    s_setprio 0
    v_sub_f32 v16, v16, v78
    v_exp_f32 v16, v16
    v_sub_f32 v17, v17, v78
    v_exp_f32 v17, v17
    v_smfmac_f32_32x32x32_bf16 a[104:119], a[60:63], v[8:15], v68
    v_sub_f32 v18, v18, v78
    v_exp_f32 v18, v18
    v_sub_f32 v19, v19, v78
    v_exp_f32 v19, v19
    v_sub_f32 v20, v20, v78
    v_exp_f32 v20, v20
    v_sub_f32 v21, v21, v78
    v_exp_f32 v21, v21
    v_mfma_f32_32x32x8bf16_1k v[0:15], a[36:37], a[164:165], 0
    v_sub_f32 v22, v22, v78
    v_exp_f32 v22, v22
    v_sub_f32 v23, v23, v78
    v_exp_f32 v23, v23
    v_sub_f32 v24, v24, v78
    v_exp_f32 v24, v24
    v_sub_f32 v25, v25, v78
    v_exp_f32 v25, v25
    v_mfma_f32_32x32x16_bf16 v[0:15], a[16:19], a[160:163], v[0:15]
    v_sub_f32 v26, v26, v78
    v_exp_f32 v26, v26
    v_sub_f32 v27, v27, v78
    v_exp_f32 v27, v27
    v_sub_f32 v28, v28, v78
    v_exp_f32 v28, v28
    v_sub_f32 v29, v29, v78
    v_exp_f32 v29, v29
    v_smfmac_f32_32x32x32_bf16 a[104:119], a[64:67], v[16:23], v68
    v_sub_f32 v30, v30, v78
    v_exp_f32 v30, v30
    v_sub_f32 v31, v31, v78
    v_exp_f32 v31, v31
    s_setprio 3
    v_sub_f32 v0, v0, v78
    v_exp_f32 v0, v0
    v_sub_f32 v1, v1, v78
    v_exp_f32 v1, v1
    v_smfmac_f32_32x32x32_bf16 a[104:119], a[68:71], v[24:31], v68
    v_sub_f32 v2, v2, v78
    v_exp_f32 v2, v2
    v_sub_f32 v3, v3, v78
    v_exp_f32 v3, v3
    v_sub_f32 v4, v4, v78
    v_exp_f32 v4, v4
    v_sub_f32 v5, v5, v78
    v_exp_f32 v5, v5
    v_mfma_f32_32x32x8bf16_1k v[16:31], a[36:37], a[166:167], 0
    v_sub_f32 v6, v6, v78
    v_exp_f32 v6, v6
    v_sub_f32 v7, v7, v78
    v_exp_f32 v7, v7
    v_sub_f32 v8, v8, v78
    v_exp_f32 v8, v8
    v_sub_f32 v9, v9, v78
    v_exp_f32 v9, v9
    v_mfma_f32_32x32x16_bf16 v[16:31], a[20:23], a[160:163], v[16:31]
    v_sub_f32 v10, v10, v78
    v_exp_f32 v10, v10
    v_sub_f32 v11, v11, v78
    v_exp_f32 v11, v11
    v_sub_f32 v12, v12, v78
    v_exp_f32 v12, v12
    v_sub_f32 v13, v13, v78
    v_exp_f32 v13, v13
    v_smfmac_f32_32x32x32_bf16 a[104:119], a[72:75], v[0:7], v68
    v_sub_f32 v14, v14, v78
    v_exp_f32 v14, v14
    v_sub_f32 v15, v15, v78
    v_exp_f32 v15, v15
    s_setprio 3
    v_sub_f32 v16, v16, v78
    v_exp_f32 v16, v16
    v_sub_f32 v17, v17, v78
    v_exp_f32 v17, v17
    v_smfmac_f32_32x32x32_bf16 a[104:119], a[76:79], v[8:15], v68
    v_sub_f32 v18, v18, v78
    v_exp_f32 v18, v18
    v_sub_f32 v19, v19, v78
    v_exp_f32 v19, v19
    v_sub_f32 v20, v20, v78
    v_exp_f32 v20, v20
    v_sub_f32 v21, v21, v78
    v_exp_f32 v21, v21
    v_mfma_f32_32x32x8bf16_1k v[0:15], a[38:39], a[164:165], 0
    v_sub_f32 v22, v22, v78
    v_exp_f32 v22, v22
    v_sub_f32 v23, v23, v78
    v_exp_f32 v23, v23
    v_sub_f32 v24, v24, v78
    v_exp_f32 v24, v24
    v_sub_f32 v25, v25, v78
    v_exp_f32 v25, v25
    v_mfma_f32_32x32x16_bf16 v[0:15], a[24:27], a[160:163], v[0:15]
    v_sub_f32 v26, v26, v78
    v_exp_f32 v26, v26
    v_sub_f32 v27, v27, v78
    v_exp_f32 v27, v27
    s_add_u32 s58, s48, 0
    buffer_load_dwordx4 a[120:123], v75, s[20:23], s58 offen sc1
    buffer_load_dwordx4 a[124:127], v75, s[20:23], s58 offen offset:1024 sc1
    v_sub_f32 v28, v28, v78
    v_exp_f32 v28, v28
    v_sub_f32 v29, v29, v78
    v_exp_f32 v29, v29
    v_smfmac_f32_32x32x32_bf16 a[104:119], a[80:83], v[16:23], v68
    v_sub_f32 v30, v30, v78
    v_exp_f32 v30, v30
    v_sub_f32 v31, v31, v78
    v_exp_f32 v31, v31
    s_setprio 2
    v_sub_f32 v0, v0, v78
    v_exp_f32 v0, v0
    s_add_u32 s58, s48, 2048
    buffer_load_dwordx4 a[128:131], v75, s[20:23], s58 offen sc1
    buffer_load_dwordx4 a[132:135], v75, s[20:23], s58 offen offset:1024 sc1
    v_sub_f32 v1, v1, v78
    v_exp_f32 v1, v1
    v_smfmac_f32_32x32x32_bf16 a[104:119], a[84:87], v[24:31], v68
    v_sub_f32 v2, v2, v78
    v_exp_f32 v2, v2
    v_sub_f32 v3, v3, v78
    v_exp_f32 v3, v3
    v_sub_f32 v4, v4, v78
    v_exp_f32 v4, v4
    v_sub_f32 v5, v5, v78
    v_exp_f32 v5, v5
    v_mfma_f32_32x32x8bf16_1k v[16:31], a[38:39], a[166:167], 0
    v_sub_f32 v6, v6, v78
    v_exp_f32 v6, v6
    v_sub_f32 v7, v7, v78
    v_exp_f32 v7, v7
    s_add_u32 s58, s48, 4096
    buffer_load_dwordx4 a[136:139], v75, s[20:23], s58 offen sc1
    buffer_load_dwordx4 a[140:143], v75, s[20:23], s58 offen offset:1024 sc1
    v_sub_f32 v8, v8, v78
    v_exp_f32 v8, v8
    v_sub_f32 v9, v9, v78
    v_exp_f32 v9, v9
    v_mfma_f32_32x32x16_bf16 v[16:31], a[28:31], a[160:163], v[16:31]
    v_sub_f32 v10, v10, v78
    v_exp_f32 v10, v10
    ds_read_b128 a[160:163], v76
    ds_read_b128 a[164:167], v76 offset:1024
    v_add_u32 v76, 2048, v76
    v_sub_f32 v11, v11, v78
    v_exp_f32 v11, v11
    v_sub_f32 v12, v12, v78
    v_exp_f32 v12, v12
    v_sub_f32 v13, v13, v78
    v_exp_f32 v13, v13
    v_smfmac_f32_32x32x32_bf16 a[104:119], a[88:91], v[0:7], v68
    v_sub_f32 v14, v14, v78
    v_exp_f32 v14, v14
    v_sub_f32 v15, v15, v78
    v_exp_f32 v15, v15
    s_setprio 1
    v_sub_f32 v16, v16, v78
    v_exp_f32 v16, v16
    s_add_u32 s58, s48, 6144
    buffer_load_dwordx4 a[144:147], v75, s[20:23], s58 offen sc1
    buffer_load_dwordx4 a[148:151], v75, s[20:23], s58 offen offset:1024 sc1
    v_sub_f32 v17, v17, v78
    v_exp_f32 v17, v17
    v_smfmac_f32_32x32x32_bf16 a[104:119], a[92:95], v[8:15], v68
    v_sub_f32 v18, v18, v78
    v_exp_f32 v18, v18
    v_sub_f32 v19, v19, v78
    v_exp_f32 v19, v19
    v_sub_f32 v20, v20, v78
    v_exp_f32 v20, v20
    v_sub_f32 v21, v21, v78
    v_exp_f32 v21, v21
    s_waitcnt lgkmcnt(0)
    v_mfma_f32_32x32x8bf16_1k v[0:15], a[32:33], a[164:165], 0
    v_sub_f32 v22, v22, v78
    v_exp_f32 v22, v22
    v_sub_f32 v23, v23, v78
    v_exp_f32 v23, v23
    v_sub_f32 v24, v24, v78
    v_exp_f32 v24, v24
    v_sub_f32 v25, v25, v78
    v_exp_f32 v25, v25
    v_mfma_f32_32x32x16_bf16 v[0:15], a[0:3], a[160:163], v[0:15]
    v_sub_f32 v26, v26, v78
    v_exp_f32 v26, v26
    ds_read_b32 v67, v82
    s_waitcnt lgkmcnt(0)
    v_add_u32 v82, 128, v82
    v_sub_f32 v27, v27, v78
    v_exp_f32 v27, v27
    v_sub_f32 v28, v28, v78
    v_exp_f32 v28, v28
    v_sub_f32 v29, v29, v78
    v_exp_f32 v29, v29
    v_smfmac_f32_32x32x32_bf16 a[104:119], a[96:99], v[16:23], v68
    v_sub_f32 v30, v30, v78
    v_exp_f32 v30, v30
    s_add_u32 s58, s48, 8192
    buffer_load_dwordx4 a[152:155], v75, s[20:23], s58 offen sc1
    buffer_load_dwordx4 a[156:159], v75, s[20:23], s58 offen offset:1024 sc1
    v_sub_f32 v31, v31, v78
    v_exp_f32 v31, v31
    s_add_u32 s48, s48, 73728
    v_mov_b32 v78, v67
    s_mov_b32 s55, 6
    s_cmp_eq_u32 s52, 0
    s_cbranch_scc1 L_b5n_loop
.p2align 3
L_b5x_loop:
    s_setprio 1
    v_sub_f32 v0, v0, v78
    v_exp_f32 v0, v0
    v_sub_f32 v1, v1, v78
    v_exp_f32 v1, v1
    v_smfmac_f32_32x32x32_bf16 a[104:119], a[100:103], v[24:31], v68
    v_sub_f32 v2, v2, v78
    v_exp_f32 v2, v2
    v_sub_f32 v3, v3, v78
    v_exp_f32 v3, v3
    v_sub_f32 v4, v4, v78
    v_exp_f32 v4, v4
    v_mfma_f32_32x32x8bf16_1k v[16:31], a[32:33], a[166:167], 0
    v_sub_f32 v5, v5, v78
    v_exp_f32 v5, v5
    v_sub_f32 v6, v6, v78
    v_exp_f32 v6, v6
    v_sub_f32 v7, v7, v78
    v_exp_f32 v7, v7
    v_sub_f32 v8, v8, v78
    v_exp_f32 v8, v8
    v_mfma_f32_32x32x16_bf16 v[16:31], a[4:7], a[160:163], v[16:31]
    ds_write_b128 v70, a[104:107]
    ds_write_b128 v70, a[108:111] offset:32
    ds_write_b64 v80, a[112:113]
    v_sub_f32 v9, v9, v78
    v_exp_f32 v9, v9
    s_setprio 0
    v_sub_f32 v10, v10, v78
    v_exp_f32 v10, v10
    v_sub_f32 v11, v11, v78
    v_exp_f32 v11, v11
    v_mfma_f32_32x32x8bf16_1k a[104:119], a[164:165], a[166:167], 0
    v_sub_f32 v12, v12, v78
    v_exp_f32 v12, v12
    v_sub_f32 v13, v13, v78
    v_exp_f32 v13, v13
    s_add_u32 m0, s49, 0
    s_nop 0
    buffer_load_dwordx4 v77, s[24:27], s53 offen nt lds
    v_sub_f32 v14, v14, v78
    v_exp_f32 v14, v14
    v_sub_f32 v15, v15, v78
    v_exp_f32 v15, v15
    v_smfmac_f32_32x32x32_bf16 a[104:119], a[40:43], v[0:7], v68
    s_waitcnt lgkmcnt(0)
    s_barrier
    s_setprio 3
    v_sub_f32 v16, v16, v78
    v_exp_f32 v16, v16
    v_sub_f32 v17, v17, v78
    v_exp_f32 v17, v17
    v_sub_f32 v18, v18, v78
    v_exp_f32 v18, v18
    v_smfmac_f32_32x32x32_bf16 a[104:119], a[44:47], v[8:15], v68
    v_sub_f32 v19, v19, v78
    v_exp_f32 v19, v19
    v_sub_f32 v20, v20, v78
    v_exp_f32 v20, v20
    v_sub_f32 v21, v21, v78
    v_exp_f32 v21, v21
    v_mfma_f32_32x32x8bf16_1k v[0:15], a[34:35], a[164:165], 0
    v_sub_f32 v22, v22, v78
    v_exp_f32 v22, v22
    v_sub_f32 v23, v23, v78
    v_exp_f32 v23, v23
    s_setprio 2
    v_sub_f32 v24, v24, v78
    v_exp_f32 v24, v24
    v_sub_f32 v25, v25, v78
    v_exp_f32 v25, v25
    v_mfma_f32_32x32x16_bf16 v[0:15], a[8:11], a[160:163], v[0:15]
    v_sub_f32 v26, v26, v78
    v_exp_f32 v26, v26
    v_sub_f32 v27, v27, v78
    v_exp_f32 v27, v27
    v_sub_f32 v28, v28, v78
    v_exp_f32 v28, v28
    v_sub_f32 v29, v29, v78
    v_exp_f32 v29, v29
    v_smfmac_f32_32x32x32_bf16 a[104:119], a[48:51], v[16:23], v68
    s_add_u32 m0, s49, 36864
    s_nop 0
    buffer_load_dwordx4 v77, s[28:31], s53 offen nt lds
    s_add_u32 s53, s53, 884736
    v_sub_f32 v30, v30, v78
    v_exp_f32 v30, v30
    v_sub_f32 v31, v31, v78
    v_exp_f32 v31, v31
    s_setprio 1
    v_sub_f32 v0, v0, v78
    v_exp_f32 v0, v0
    v_sub_f32 v1, v1, v78
    v_exp_f32 v1, v1
    v_smfmac_f32_32x32x32_bf16 a[104:119], a[52:55], v[24:31], v68
    v_sub_f32 v2, v2, v78
    v_exp_f32 v2, v2
    v_sub_f32 v3, v3, v78
    v_exp_f32 v3, v3
    v_sub_f32 v4, v4, v78
    v_exp_f32 v4, v4
    v_sub_f32 v5, v5, v78
    v_exp_f32 v5, v5
    v_mfma_f32_32x32x8bf16_1k v[16:31], a[34:35], a[166:167], 0
    v_sub_f32 v6, v6, v78
    v_exp_f32 v6, v6
    v_sub_f32 v7, v7, v78
    v_exp_f32 v7, v7
    v_sub_f32 v8, v8, v78
    v_exp_f32 v8, v8
    v_sub_f32 v9, v9, v78
    v_exp_f32 v9, v9
    v_mfma_f32_32x32x16_bf16 v[16:31], a[12:15], a[160:163], v[16:31]
    v_sub_f32 v10, v10, v78
    v_exp_f32 v10, v10
    v_sub_f32 v11, v11, v78
    v_exp_f32 v11, v11
    v_sub_f32 v12, v12, v78
    v_exp_f32 v12, v12
    v_sub_f32 v13, v13, v78
    v_exp_f32 v13, v13
    v_smfmac_f32_32x32x32_bf16 a[104:119], a[56:59], v[0:7], v68
    s_add_u32 m0, s49, 73728
    s_nop 0
    buffer_load_dwordx4 v75, s[32:35], s54 offen nt lds
    s_add_u32 s49, s49, 6144
    s_add_u32 s54, s54, 6144
    v_sub_f32 v14, v14, v78
    v_exp_f32 v14, v14
    v_sub_f32 v15, v15, v78
    v_exp_f32 v15, v15
    s_setprio 0
    v_sub_f32 v16, v16, v78
    v_exp_f32 v16, v16
    v_sub_f32 v17, v17, v78
    v_exp_f32 v17, v17
    v_smfmac_f32_32x32x32_bf16 a[104:119], a[60:63], v[8:15], v68
    v_sub_f32 v18, v18, v78
    v_exp_f32 v18, v18
    v_sub_f32 v19, v19, v78
    v_exp_f32 v19, v19
    v_sub_f32 v20, v20, v78
    v_exp_f32 v20, v20
    v_sub_f32 v21, v21, v78
    v_exp_f32 v21, v21
    v_mfma_f32_32x32x8bf16_1k v[0:15], a[36:37], a[164:165], 0
    v_sub_f32 v22, v22, v78
    v_exp_f32 v22, v22
    v_sub_f32 v23, v23, v78
    v_exp_f32 v23, v23
    v_sub_f32 v24, v24, v78
    v_exp_f32 v24, v24
    v_sub_f32 v25, v25, v78
    v_exp_f32 v25, v25
    v_mfma_f32_32x32x16_bf16 v[0:15], a[16:19], a[160:163], v[0:15]
    v_sub_f32 v26, v26, v78
    v_exp_f32 v26, v26
    v_sub_f32 v27, v27, v78
    v_exp_f32 v27, v27
    v_sub_f32 v28, v28, v78
    v_exp_f32 v28, v28
    v_sub_f32 v29, v29, v78
    v_exp_f32 v29, v29
    v_smfmac_f32_32x32x32_bf16 a[104:119], a[64:67], v[16:23], v68
    v_sub_f32 v30, v30, v78
    v_exp_f32 v30, v30
    v_sub_f32 v31, v31, v78
    v_exp_f32 v31, v31
    s_waitcnt lgkmcnt(0)
    s_barrier
    s_setprio 3
    v_sub_f32 v0, v0, v78
    v_exp_f32 v0, v0
    ds_read_b128 a[168:171], v74
    v_add_u32 v74, 1152, v74
    v_sub_f32 v1, v1, v78
    v_exp_f32 v1, v1
    v_smfmac_f32_32x32x32_bf16 a[104:119], a[68:71], v[24:31], v68
    v_sub_f32 v2, v2, v78
    v_exp_f32 v2, v2
    v_sub_f32 v3, v3, v78
    v_exp_f32 v3, v3
    v_sub_f32 v4, v4, v78
    v_exp_f32 v4, v4
    v_sub_f32 v5, v5, v78
    v_exp_f32 v5, v5
    v_mfma_f32_32x32x8bf16_1k v[16:31], a[36:37], a[166:167], 0
    v_sub_f32 v6, v6, v78
    v_exp_f32 v6, v6
    v_sub_f32 v7, v7, v78
    v_exp_f32 v7, v7
    v_sub_f32 v8, v8, v78
    v_exp_f32 v8, v8
    v_sub_f32 v9, v9, v78
    v_exp_f32 v9, v9
    v_mfma_f32_32x32x16_bf16 v[16:31], a[20:23], a[160:163], v[16:31]
    v_sub_f32 v10, v10, v78
    v_exp_f32 v10, v10
    v_sub_f32 v11, v11, v78
    v_exp_f32 v11, v11
    v_sub_f32 v12, v12, v78
    v_exp_f32 v12, v12
    s_waitcnt lgkmcnt(0)
    s_waitcnt vmcnt(7)
    v_smfmac_f32_16x16x64_bf16 v[32:35], a[168:171], a[120:127], v69
    v_sub_f32 v13, v13, v78
    v_exp_f32 v13, v13
    v_smfmac_f32_32x32x32_bf16 a[104:119], a[72:75], v[0:7], v68
    v_sub_f32 v14, v14, v78
    v_exp_f32 v14, v14
    s_add_u32 s58, s48, 0
    buffer_load_dwordx4 a[120:123], v75, s[20:23], s58 offen sc1
    buffer_load_dwordx4 a[124:127], v75, s[20:23], s58 offen offset:1024 sc1
    v_sub_f32 v15, v15, v78
    v_exp_f32 v15, v15
    s_setprio 3
    v_sub_f32 v16, v16, v78
    v_exp_f32 v16, v16
    v_sub_f32 v17, v17, v78
    v_exp_f32 v17, v17
    v_smfmac_f32_32x32x32_bf16 a[104:119], a[76:79], v[8:15], v68
    v_sub_f32 v18, v18, v78
    v_exp_f32 v18, v18
    v_sub_f32 v19, v19, v78
    v_exp_f32 v19, v19
    v_sub_f32 v20, v20, v78
    v_exp_f32 v20, v20
    v_smfmac_f32_16x16x64_bf16 v[36:39], a[168:171], a[128:135], v69
    v_sub_f32 v21, v21, v78
    v_exp_f32 v21, v21
    v_mfma_f32_32x32x8bf16_1k v[0:15], a[38:39], a[164:165], 0
    v_sub_f32 v22, v22, v78
    v_exp_f32 v22, v22
    v_sub_f32 v23, v23, v78
    v_exp_f32 v23, v23
    s_add_u32 s58, s48, 2048
    buffer_load_dwordx4 a[128:131], v75, s[20:23], s58 offen sc1
    buffer_load_dwordx4 a[132:135], v75, s[20:23], s58 offen offset:1024 sc1
    v_sub_f32 v24, v24, v78
    v_exp_f32 v24, v24
    v_sub_f32 v25, v25, v78
    v_exp_f32 v25, v25
    v_mfma_f32_32x32x16_bf16 v[0:15], a[24:27], a[160:163], v[0:15]
    v_sub_f32 v26, v26, v78
    v_exp_f32 v26, v26
    v_sub_f32 v27, v27, v78
    v_exp_f32 v27, v27
    v_sub_f32 v28, v28, v78
    v_exp_f32 v28, v28
    v_sub_f32 v29, v29, v78
    v_exp_f32 v29, v29
    v_smfmac_f32_32x32x32_bf16 a[104:119], a[80:83], v[16:23], v68
    v_sub_f32 v30, v30, v78
    v_exp_f32 v30, v30
    v_sub_f32 v31, v31, v78
    v_exp_f32 v31, v31
    s_setprio 2
    v_sub_f32 v0, v0, v78
    v_exp_f32 v0, v0
    v_sub_f32 v1, v1, v78
    v_exp_f32 v1, v1
    v_smfmac_f32_32x32x32_bf16 a[104:119], a[84:87], v[24:31], v68
    v_sub_f32 v2, v2, v78
    v_exp_f32 v2, v2
    v_sub_f32 v3, v3, v78
    v_exp_f32 v3, v3
    v_sub_f32 v4, v4, v78
    v_exp_f32 v4, v4
    v_smfmac_f32_16x16x64_bf16 v[40:43], a[168:171], a[136:143], v69
    v_sub_f32 v5, v5, v78
    v_exp_f32 v5, v5
    v_mfma_f32_32x32x8bf16_1k v[16:31], a[38:39], a[166:167], 0
    v_sub_f32 v6, v6, v78
    v_exp_f32 v6, v6
    v_sub_f32 v7, v7, v78
    v_exp_f32 v7, v7
    s_add_u32 s58, s48, 4096
    buffer_load_dwordx4 a[136:139], v75, s[20:23], s58 offen sc1
    buffer_load_dwordx4 a[140:143], v75, s[20:23], s58 offen offset:1024 sc1
    v_sub_f32 v8, v8, v78
    v_exp_f32 v8, v8
    v_sub_f32 v9, v9, v78
    v_exp_f32 v9, v9
    v_mfma_f32_32x32x16_bf16 v[16:31], a[28:31], a[160:163], v[16:31]
    v_sub_f32 v10, v10, v78
    v_exp_f32 v10, v10
    ds_read_b128 a[160:163], v76
    ds_read_b128 a[164:167], v76 offset:1024
    v_add_u32 v76, 2048, v76
    v_sub_f32 v11, v11, v78
    v_exp_f32 v11, v11
    v_sub_f32 v12, v12, v78
    v_exp_f32 v12, v12
    v_sub_f32 v13, v13, v78
    v_exp_f32 v13, v13
    v_smfmac_f32_32x32x32_bf16 a[104:119], a[88:91], v[0:7], v68
    v_sub_f32 v14, v14, v78
    v_exp_f32 v14, v14
    v_sub_f32 v15, v15, v78
    v_exp_f32 v15, v15
    s_setprio 1
    v_sub_f32 v16, v16, v78
    v_exp_f32 v16, v16
    v_sub_f32 v17, v17, v78
    v_exp_f32 v17, v17
    v_smfmac_f32_32x32x32_bf16 a[104:119], a[92:95], v[8:15], v68
    v_sub_f32 v18, v18, v78
    v_exp_f32 v18, v18
    v_sub_f32 v19, v19, v78
    v_exp_f32 v19, v19
    v_sub_f32 v20, v20, v78
    v_exp_f32 v20, v20
    s_waitcnt vmcnt(9)
    v_smfmac_f32_16x16x64_bf16 v[44:47], a[168:171], a[144:151], v69
    v_sub_f32 v21, v21, v78
    v_exp_f32 v21, v21
    s_waitcnt lgkmcnt(0)
    v_mfma_f32_32x32x8bf16_1k v[0:15], a[32:33], a[164:165], 0
    v_sub_f32 v22, v22, v78
    v_exp_f32 v22, v22
    v_sub_f32 v23, v23, v78
    v_exp_f32 v23, v23
    s_add_u32 s58, s48, 6144
    buffer_load_dwordx4 a[144:147], v75, s[20:23], s58 offen sc1
    buffer_load_dwordx4 a[148:151], v75, s[20:23], s58 offen offset:1024 sc1
    v_sub_f32 v24, v24, v78
    v_exp_f32 v24, v24
    v_sub_f32 v25, v25, v78
    v_exp_f32 v25, v25
    v_mfma_f32_32x32x16_bf16 v[0:15], a[0:3], a[160:163], v[0:15]
    v_sub_f32 v26, v26, v78
    v_exp_f32 v26, v26
    ds_read_b32 v67, v82
    s_waitcnt lgkmcnt(0)
    v_add_u32 v82, 128, v82
    v_sub_f32 v27, v27, v78
    v_exp_f32 v27, v27
    v_sub_f32 v28, v28, v78
    v_exp_f32 v28, v28
    v_smfmac_f32_16x16x64_bf16 v[48:51], a[168:171], a[152:159], v69
    v_sub_f32 v29, v29, v78
    v_exp_f32 v29, v29
    v_smfmac_f32_32x32x32_bf16 a[104:119], a[96:99], v[16:23], v68
    v_sub_f32 v30, v30, v78
    v_exp_f32 v30, v30
    s_add_u32 s58, s48, 8192
    buffer_load_dwordx4 a[152:155], v75, s[20:23], s58 offen sc1
    buffer_load_dwordx4 a[156:159], v75, s[20:23], s58 offen offset:1024 sc1
    v_sub_f32 v31, v31, v78
    v_exp_f32 v31, v31
    s_add_u32 s48, s48, 73728
    s_sub_u32 s55, s55, 1
    s_cmp_lg_u32 s55, 0
    v_mov_b32 v78, v67
    s_cbranch_scc1 L_b5x_loop
    s_branch L_b5_last
.p2align 3
L_b5n_loop:
    s_setprio 1
    v_sub_f32 v0, v0, v78
    v_exp_f32 v0, v0
    v_sub_f32 v1, v1, v78
    v_exp_f32 v1, v1
    v_smfmac_f32_32x32x32_bf16 a[104:119], a[100:103], v[24:31], v68
    v_sub_f32 v2, v2, v78
    v_exp_f32 v2, v2
    v_sub_f32 v3, v3, v78
    v_exp_f32 v3, v3
    v_sub_f32 v4, v4, v78
    v_exp_f32 v4, v4
    v_mfma_f32_32x32x8bf16_1k v[16:31], a[32:33], a[166:167], 0
    v_sub_f32 v5, v5, v78
    v_exp_f32 v5, v5
    v_sub_f32 v6, v6, v78
    v_exp_f32 v6, v6
    v_sub_f32 v7, v7, v78
    v_exp_f32 v7, v7
    v_sub_f32 v8, v8, v78
    v_exp_f32 v8, v8
    v_mfma_f32_32x32x16_bf16 v[16:31], a[4:7], a[160:163], v[16:31]
    ds_write_b128 v70, a[104:107]
    ds_write_b128 v70, a[108:111] offset:32
    ds_write_b64 v80, a[112:113]
    v_sub_f32 v9, v9, v78
    v_exp_f32 v9, v9
    s_setprio 0
    v_sub_f32 v10, v10, v78
    v_exp_f32 v10, v10
    v_sub_f32 v11, v11, v78
    v_exp_f32 v11, v11
    v_mfma_f32_32x32x8bf16_1k a[104:119], a[164:165], a[166:167], 0
    v_sub_f32 v12, v12, v78
    v_exp_f32 v12, v12
    v_sub_f32 v13, v13, v78
    v_exp_f32 v13, v13
    v_sub_f32 v14, v14, v78
    v_exp_f32 v14, v14
    v_sub_f32 v15, v15, v78
    v_exp_f32 v15, v15
    v_smfmac_f32_32x32x32_bf16 a[104:119], a[40:43], v[0:7], v68
    s_waitcnt lgkmcnt(0)
    s_barrier
    s_setprio 3
    v_sub_f32 v16, v16, v78
    v_exp_f32 v16, v16
    v_sub_f32 v17, v17, v78
    v_exp_f32 v17, v17
    v_sub_f32 v18, v18, v78
    v_exp_f32 v18, v18
    v_smfmac_f32_32x32x32_bf16 a[104:119], a[44:47], v[8:15], v68
    v_sub_f32 v19, v19, v78
    v_exp_f32 v19, v19
    v_sub_f32 v20, v20, v78
    v_exp_f32 v20, v20
    v_sub_f32 v21, v21, v78
    v_exp_f32 v21, v21
    v_mfma_f32_32x32x8bf16_1k v[0:15], a[34:35], a[164:165], 0
    v_sub_f32 v22, v22, v78
    v_exp_f32 v22, v22
    v_sub_f32 v23, v23, v78
    v_exp_f32 v23, v23
    s_setprio 2
    v_sub_f32 v24, v24, v78
    v_exp_f32 v24, v24
    v_sub_f32 v25, v25, v78
    v_exp_f32 v25, v25
    v_mfma_f32_32x32x16_bf16 v[0:15], a[8:11], a[160:163], v[0:15]
    v_sub_f32 v26, v26, v78
    v_exp_f32 v26, v26
    v_sub_f32 v27, v27, v78
    v_exp_f32 v27, v27
    v_sub_f32 v28, v28, v78
    v_exp_f32 v28, v28
    v_sub_f32 v29, v29, v78
    v_exp_f32 v29, v29
    v_smfmac_f32_32x32x32_bf16 a[104:119], a[48:51], v[16:23], v68
    v_sub_f32 v30, v30, v78
    v_exp_f32 v30, v30
    v_sub_f32 v31, v31, v78
    v_exp_f32 v31, v31
    s_setprio 1
    v_sub_f32 v0, v0, v78
    v_exp_f32 v0, v0
    v_sub_f32 v1, v1, v78
    v_exp_f32 v1, v1
    v_smfmac_f32_32x32x32_bf16 a[104:119], a[52:55], v[24:31], v68
    v_sub_f32 v2, v2, v78
    v_exp_f32 v2, v2
    v_sub_f32 v3, v3, v78
    v_exp_f32 v3, v3
    v_sub_f32 v4, v4, v78
    v_exp_f32 v4, v4
    v_sub_f32 v5, v5, v78
    v_exp_f32 v5, v5
    v_mfma_f32_32x32x8bf16_1k v[16:31], a[34:35], a[166:167], 0
    v_sub_f32 v6, v6, v78
    v_exp_f32 v6, v6
    v_sub_f32 v7, v7, v78
    v_exp_f32 v7, v7
    v_sub_f32 v8, v8, v78
    v_exp_f32 v8, v8
    v_sub_f32 v9, v9, v78
    v_exp_f32 v9, v9
    v_mfma_f32_32x32x16_bf16 v[16:31], a[12:15], a[160:163], v[16:31]
    v_sub_f32 v10, v10, v78
    v_exp_f32 v10, v10
    v_sub_f32 v11, v11, v78
    v_exp_f32 v11, v11
    v_sub_f32 v12, v12, v78
    v_exp_f32 v12, v12
    v_sub_f32 v13, v13, v78
    v_exp_f32 v13, v13
    v_smfmac_f32_32x32x32_bf16 a[104:119], a[56:59], v[0:7], v68
    v_sub_f32 v14, v14, v78
    v_exp_f32 v14, v14
    v_sub_f32 v15, v15, v78
    v_exp_f32 v15, v15
    s_setprio 0
    v_sub_f32 v16, v16, v78
    v_exp_f32 v16, v16
    v_sub_f32 v17, v17, v78
    v_exp_f32 v17, v17
    v_smfmac_f32_32x32x32_bf16 a[104:119], a[60:63], v[8:15], v68
    v_sub_f32 v18, v18, v78
    v_exp_f32 v18, v18
    v_sub_f32 v19, v19, v78
    v_exp_f32 v19, v19
    v_sub_f32 v20, v20, v78
    v_exp_f32 v20, v20
    v_sub_f32 v21, v21, v78
    v_exp_f32 v21, v21
    v_mfma_f32_32x32x8bf16_1k v[0:15], a[36:37], a[164:165], 0
    v_sub_f32 v22, v22, v78
    v_exp_f32 v22, v22
    v_sub_f32 v23, v23, v78
    v_exp_f32 v23, v23
    v_sub_f32 v24, v24, v78
    v_exp_f32 v24, v24
    v_sub_f32 v25, v25, v78
    v_exp_f32 v25, v25
    v_mfma_f32_32x32x16_bf16 v[0:15], a[16:19], a[160:163], v[0:15]
    v_sub_f32 v26, v26, v78
    v_exp_f32 v26, v26
    v_sub_f32 v27, v27, v78
    v_exp_f32 v27, v27
    v_sub_f32 v28, v28, v78
    v_exp_f32 v28, v28
    v_sub_f32 v29, v29, v78
    v_exp_f32 v29, v29
    v_smfmac_f32_32x32x32_bf16 a[104:119], a[64:67], v[16:23], v68
    v_sub_f32 v30, v30, v78
    v_exp_f32 v30, v30
    v_sub_f32 v31, v31, v78
    v_exp_f32 v31, v31
    s_waitcnt lgkmcnt(0)
    s_barrier
    s_setprio 3
    v_sub_f32 v0, v0, v78
    v_exp_f32 v0, v0
    ds_read_b128 a[168:171], v74
    v_add_u32 v74, 1152, v74
    v_sub_f32 v1, v1, v78
    v_exp_f32 v1, v1
    v_smfmac_f32_32x32x32_bf16 a[104:119], a[68:71], v[24:31], v68
    v_sub_f32 v2, v2, v78
    v_exp_f32 v2, v2
    v_sub_f32 v3, v3, v78
    v_exp_f32 v3, v3
    v_sub_f32 v4, v4, v78
    v_exp_f32 v4, v4
    v_sub_f32 v5, v5, v78
    v_exp_f32 v5, v5
    v_mfma_f32_32x32x8bf16_1k v[16:31], a[36:37], a[166:167], 0
    v_sub_f32 v6, v6, v78
    v_exp_f32 v6, v6
    v_sub_f32 v7, v7, v78
    v_exp_f32 v7, v7
    v_sub_f32 v8, v8, v78
    v_exp_f32 v8, v8
    v_sub_f32 v9, v9, v78
    v_exp_f32 v9, v9
    v_mfma_f32_32x32x16_bf16 v[16:31], a[20:23], a[160:163], v[16:31]
    v_sub_f32 v10, v10, v78
    v_exp_f32 v10, v10
    v_sub_f32 v11, v11, v78
    v_exp_f32 v11, v11
    v_sub_f32 v12, v12, v78
    v_exp_f32 v12, v12
    s_waitcnt lgkmcnt(0)
    s_waitcnt vmcnt(4)
    v_smfmac_f32_16x16x64_bf16 v[32:35], a[168:171], a[120:127], v69
    v_sub_f32 v13, v13, v78
    v_exp_f32 v13, v13
    v_smfmac_f32_32x32x32_bf16 a[104:119], a[72:75], v[0:7], v68
    v_sub_f32 v14, v14, v78
    v_exp_f32 v14, v14
    s_add_u32 s58, s48, 0
    buffer_load_dwordx4 a[120:123], v75, s[20:23], s58 offen sc1
    buffer_load_dwordx4 a[124:127], v75, s[20:23], s58 offen offset:1024 sc1
    v_sub_f32 v15, v15, v78
    v_exp_f32 v15, v15
    s_setprio 3
    v_sub_f32 v16, v16, v78
    v_exp_f32 v16, v16
    v_sub_f32 v17, v17, v78
    v_exp_f32 v17, v17
    v_smfmac_f32_32x32x32_bf16 a[104:119], a[76:79], v[8:15], v68
    v_sub_f32 v18, v18, v78
    v_exp_f32 v18, v18
    v_sub_f32 v19, v19, v78
    v_exp_f32 v19, v19
    v_sub_f32 v20, v20, v78
    v_exp_f32 v20, v20
    v_smfmac_f32_16x16x64_bf16 v[36:39], a[168:171], a[128:135], v69
    v_sub_f32 v21, v21, v78
    v_exp_f32 v21, v21
    v_mfma_f32_32x32x8bf16_1k v[0:15], a[38:39], a[164:165], 0
    v_sub_f32 v22, v22, v78
    v_exp_f32 v22, v22
    v_sub_f32 v23, v23, v78
    v_exp_f32 v23, v23
    s_add_u32 s58, s48, 2048
    buffer_load_dwordx4 a[128:131], v75, s[20:23], s58 offen sc1
    buffer_load_dwordx4 a[132:135], v75, s[20:23], s58 offen offset:1024 sc1
    v_sub_f32 v24, v24, v78
    v_exp_f32 v24, v24
    v_sub_f32 v25, v25, v78
    v_exp_f32 v25, v25
    v_mfma_f32_32x32x16_bf16 v[0:15], a[24:27], a[160:163], v[0:15]
    v_sub_f32 v26, v26, v78
    v_exp_f32 v26, v26
    v_sub_f32 v27, v27, v78
    v_exp_f32 v27, v27
    v_sub_f32 v28, v28, v78
    v_exp_f32 v28, v28
    v_sub_f32 v29, v29, v78
    v_exp_f32 v29, v29
    v_smfmac_f32_32x32x32_bf16 a[104:119], a[80:83], v[16:23], v68
    v_sub_f32 v30, v30, v78
    v_exp_f32 v30, v30
    v_sub_f32 v31, v31, v78
    v_exp_f32 v31, v31
    s_setprio 2
    v_sub_f32 v0, v0, v78
    v_exp_f32 v0, v0
    v_sub_f32 v1, v1, v78
    v_exp_f32 v1, v1
    v_smfmac_f32_32x32x32_bf16 a[104:119], a[84:87], v[24:31], v68
    v_sub_f32 v2, v2, v78
    v_exp_f32 v2, v2
    v_sub_f32 v3, v3, v78
    v_exp_f32 v3, v3
    v_sub_f32 v4, v4, v78
    v_exp_f32 v4, v4
    v_smfmac_f32_16x16x64_bf16 v[40:43], a[168:171], a[136:143], v69
    v_sub_f32 v5, v5, v78
    v_exp_f32 v5, v5
    v_mfma_f32_32x32x8bf16_1k v[16:31], a[38:39], a[166:167], 0
    v_sub_f32 v6, v6, v78
    v_exp_f32 v6, v6
    v_sub_f32 v7, v7, v78
    v_exp_f32 v7, v7
    s_add_u32 s58, s48, 4096
    buffer_load_dwordx4 a[136:139], v75, s[20:23], s58 offen sc1
    buffer_load_dwordx4 a[140:143], v75, s[20:23], s58 offen offset:1024 sc1
    v_sub_f32 v8, v8, v78
    v_exp_f32 v8, v8
    v_sub_f32 v9, v9, v78
    v_exp_f32 v9, v9
    v_mfma_f32_32x32x16_bf16 v[16:31], a[28:31], a[160:163], v[16:31]
    v_sub_f32 v10, v10, v78
    v_exp_f32 v10, v10
    ds_read_b128 a[160:163], v76
    ds_read_b128 a[164:167], v76 offset:1024
    v_add_u32 v76, 2048, v76
    v_sub_f32 v11, v11, v78
    v_exp_f32 v11, v11
    v_sub_f32 v12, v12, v78
    v_exp_f32 v12, v12
    v_sub_f32 v13, v13, v78
    v_exp_f32 v13, v13
    v_smfmac_f32_32x32x32_bf16 a[104:119], a[88:91], v[0:7], v68
    v_sub_f32 v14, v14, v78
    v_exp_f32 v14, v14
    v_sub_f32 v15, v15, v78
    v_exp_f32 v15, v15
    s_setprio 1
    v_sub_f32 v16, v16, v78
    v_exp_f32 v16, v16
    v_sub_f32 v17, v17, v78
    v_exp_f32 v17, v17
    v_smfmac_f32_32x32x32_bf16 a[104:119], a[92:95], v[8:15], v68
    v_sub_f32 v18, v18, v78
    v_exp_f32 v18, v18
    v_sub_f32 v19, v19, v78
    v_exp_f32 v19, v19
    v_sub_f32 v20, v20, v78
    v_exp_f32 v20, v20
    s_waitcnt vmcnt(6)
    v_smfmac_f32_16x16x64_bf16 v[44:47], a[168:171], a[144:151], v69
    v_sub_f32 v21, v21, v78
    v_exp_f32 v21, v21
    s_waitcnt lgkmcnt(0)
    v_mfma_f32_32x32x8bf16_1k v[0:15], a[32:33], a[164:165], 0
    v_sub_f32 v22, v22, v78
    v_exp_f32 v22, v22
    v_sub_f32 v23, v23, v78
    v_exp_f32 v23, v23
    s_add_u32 s58, s48, 6144
    buffer_load_dwordx4 a[144:147], v75, s[20:23], s58 offen sc1
    buffer_load_dwordx4 a[148:151], v75, s[20:23], s58 offen offset:1024 sc1
    v_sub_f32 v24, v24, v78
    v_exp_f32 v24, v24
    v_sub_f32 v25, v25, v78
    v_exp_f32 v25, v25
    v_mfma_f32_32x32x16_bf16 v[0:15], a[0:3], a[160:163], v[0:15]
    v_sub_f32 v26, v26, v78
    v_exp_f32 v26, v26
    ds_read_b32 v67, v82
    s_waitcnt lgkmcnt(0)
    v_add_u32 v82, 128, v82
    v_sub_f32 v27, v27, v78
    v_exp_f32 v27, v27
    v_sub_f32 v28, v28, v78
    v_exp_f32 v28, v28
    v_smfmac_f32_16x16x64_bf16 v[48:51], a[168:171], a[152:159], v69
    v_sub_f32 v29, v29, v78
    v_exp_f32 v29, v29
    v_smfmac_f32_32x32x32_bf16 a[104:119], a[96:99], v[16:23], v68
    v_sub_f32 v30, v30, v78
    v_exp_f32 v30, v30
    s_add_u32 s58, s48, 8192
    buffer_load_dwordx4 a[152:155], v75, s[20:23], s58 offen sc1
    buffer_load_dwordx4 a[156:159], v75, s[20:23], s58 offen offset:1024 sc1
    v_sub_f32 v31, v31, v78
    v_exp_f32 v31, v31
    s_add_u32 s48, s48, 73728
    s_sub_u32 s55, s55, 1
    s_cmp_lg_u32 s55, 0
    v_mov_b32 v78, v67
    s_cbranch_scc1 L_b5n_loop
L_b5_last:
    s_setprio 1
    v_sub_f32 v0, v0, v78
    v_exp_f32 v0, v0
    v_sub_f32 v1, v1, v78
    v_exp_f32 v1, v1
    v_smfmac_f32_32x32x32_bf16 a[104:119], a[100:103], v[24:31], v68
    v_sub_f32 v2, v2, v78
    v_exp_f32 v2, v2
    v_sub_f32 v3, v3, v78
    v_exp_f32 v3, v3
    v_sub_f32 v4, v4, v78
    v_exp_f32 v4, v4
    v_mfma_f32_32x32x8bf16_1k v[16:31], a[32:33], a[166:167], 0
    v_sub_f32 v5, v5, v78
    v_exp_f32 v5, v5
    v_sub_f32 v6, v6, v78
    v_exp_f32 v6, v6
    v_sub_f32 v7, v7, v78
    v_exp_f32 v7, v7
    v_sub_f32 v8, v8, v78
    v_exp_f32 v8, v8
    v_mfma_f32_32x32x16_bf16 v[16:31], a[4:7], a[160:163], v[16:31]
    ds_write_b128 v70, a[104:107]
    ds_write_b128 v70, a[108:111] offset:32
    ds_write_b64 v80, a[112:113]
    v_sub_f32 v9, v9, v78
    v_exp_f32 v9, v9
    s_setprio 0
    v_sub_f32 v10, v10, v78
    v_exp_f32 v10, v10
    v_sub_f32 v11, v11, v78
    v_exp_f32 v11, v11
    v_mfma_f32_32x32x8bf16_1k a[104:119], a[164:165], a[166:167], 0
    v_sub_f32 v12, v12, v78
    v_exp_f32 v12, v12
    v_sub_f32 v13, v13, v78
    v_exp_f32 v13, v13
    v_sub_f32 v14, v14, v78
    v_exp_f32 v14, v14
    v_sub_f32 v15, v15, v78
    v_exp_f32 v15, v15
    v_smfmac_f32_32x32x32_bf16 a[104:119], a[40:43], v[0:7], v68
    s_waitcnt lgkmcnt(0)
    s_barrier
    s_setprio 3
    v_sub_f32 v16, v16, v78
    v_exp_f32 v16, v16
    v_sub_f32 v17, v17, v78
    v_exp_f32 v17, v17
    v_sub_f32 v18, v18, v78
    v_exp_f32 v18, v18
    v_smfmac_f32_32x32x32_bf16 a[104:119], a[44:47], v[8:15], v68
    v_sub_f32 v19, v19, v78
    v_exp_f32 v19, v19
    v_sub_f32 v20, v20, v78
    v_exp_f32 v20, v20
    v_sub_f32 v21, v21, v78
    v_exp_f32 v21, v21
    v_mfma_f32_32x32x8bf16_1k v[0:15], a[34:35], a[164:165], 0
    v_sub_f32 v22, v22, v78
    v_exp_f32 v22, v22
    v_sub_f32 v23, v23, v78
    v_exp_f32 v23, v23
    s_setprio 2
    v_sub_f32 v24, v24, v78
    v_exp_f32 v24, v24
    v_sub_f32 v25, v25, v78
    v_exp_f32 v25, v25
    v_mfma_f32_32x32x16_bf16 v[0:15], a[8:11], a[160:163], v[0:15]
    v_sub_f32 v26, v26, v78
    v_exp_f32 v26, v26
    s_add_u32 s58, s48, 73728
    buffer_load_dwordx4 a[0:3], v75, s[20:23], s58 offen sc1
    buffer_load_dwordx4 a[4:7], v75, s[20:23], s58 offen offset:1024 sc1
    v_sub_f32 v27, v27, v78
    v_exp_f32 v27, v27
    v_sub_f32 v28, v28, v78
    v_exp_f32 v28, v28
    v_sub_f32 v29, v29, v78
    v_exp_f32 v29, v29
    v_smfmac_f32_32x32x32_bf16 a[104:119], a[48:51], v[16:23], v68
    s_add_u32 s58, s48, 75776
    buffer_load_dwordx4 a[40:43], v75, s[20:23], s58 offen sc1
    buffer_load_dwordx4 a[44:47], v75, s[20:23], s58 offen offset:1024 sc1
    v_sub_f32 v30, v30, v78
    v_exp_f32 v30, v30
    v_sub_f32 v31, v31, v78
    v_exp_f32 v31, v31
    s_setprio 1
    v_sub_f32 v0, v0, v78
    v_exp_f32 v0, v0
    v_sub_f32 v1, v1, v78
    v_exp_f32 v1, v1
    v_smfmac_f32_32x32x32_bf16 a[104:119], a[52:55], v[24:31], v68
    v_sub_f32 v2, v2, v78
    v_exp_f32 v2, v2
    v_sub_f32 v3, v3, v78
    v_exp_f32 v3, v3
    v_sub_f32 v4, v4, v78
    v_exp_f32 v4, v4
    v_sub_f32 v5, v5, v78
    v_exp_f32 v5, v5
    v_mfma_f32_32x32x8bf16_1k v[16:31], a[34:35], a[166:167], 0
    v_sub_f32 v6, v6, v78
    v_exp_f32 v6, v6
    v_sub_f32 v7, v7, v78
    v_exp_f32 v7, v7
    v_sub_f32 v8, v8, v78
    v_exp_f32 v8, v8
    v_sub_f32 v9, v9, v78
    v_exp_f32 v9, v9
    v_mfma_f32_32x32x16_bf16 v[16:31], a[12:15], a[160:163], v[16:31]
    v_sub_f32 v10, v10, v78
    v_exp_f32 v10, v10
    s_add_u32 s58, s48, 77824
    buffer_load_dwordx4 a[48:51], v75, s[20:23], s58 offen sc1
    buffer_load_dwordx4 a[52:55], v75, s[20:23], s58 offen offset:1024 sc1
    v_sub_f32 v11, v11, v78
    v_exp_f32 v11, v11
    v_sub_f32 v12, v12, v78
    v_exp_f32 v12, v12
    v_sub_f32 v13, v13, v78
    v_exp_f32 v13, v13
    v_smfmac_f32_32x32x32_bf16 a[104:119], a[56:59], v[0:7], v68
    v_sub_f32 v14, v14, v78
    v_exp_f32 v14, v14
    v_sub_f32 v15, v15, v78
    v_exp_f32 v15, v15
    s_setprio 0
    v_sub_f32 v16, v16, v78
    v_exp_f32 v16, v16
    v_sub_f32 v17, v17, v78
    v_exp_f32 v17, v17
    v_smfmac_f32_32x32x32_bf16 a[104:119], a[60:63], v[8:15], v68
    v_sub_f32 v18, v18, v78
    v_exp_f32 v18, v18
    v_sub_f32 v19, v19, v78
    v_exp_f32 v19, v19
    v_sub_f32 v20, v20, v78
    v_exp_f32 v20, v20
    v_sub_f32 v21, v21, v78
    v_exp_f32 v21, v21
    v_mfma_f32_32x32x8bf16_1k v[0:15], a[36:37], a[164:165], 0
    v_sub_f32 v22, v22, v78
    v_exp_f32 v22, v22
    v_sub_f32 v23, v23, v78
    v_exp_f32 v23, v23
    v_sub_f32 v24, v24, v78
    v_exp_f32 v24, v24
    v_sub_f32 v25, v25, v78
    v_exp_f32 v25, v25
    v_mfma_f32_32x32x16_bf16 v[0:15], a[16:19], a[160:163], v[0:15]
    v_sub_f32 v26, v26, v78
    v_exp_f32 v26, v26
    s_add_u32 s58, s48, 79872
    buffer_load_dwordx4 a[8:11], v75, s[20:23], s58 offen sc1
    buffer_load_dwordx4 a[12:15], v75, s[20:23], s58 offen offset:1024 sc1
    v_sub_f32 v27, v27, v78
    v_exp_f32 v27, v27
    v_sub_f32 v28, v28, v78
    v_exp_f32 v28, v28
    v_sub_f32 v29, v29, v78
    v_exp_f32 v29, v29
    v_smfmac_f32_32x32x32_bf16 a[104:119], a[64:67], v[16:23], v68
    s_add_u32 s58, s48, 81920
    buffer_load_dwordx4 a[56:59], v75, s[20:23], s58 offen sc1
    buffer_load_dwordx4 a[60:63], v75, s[20:23], s58 offen offset:1024 sc1
    v_sub_f32 v30, v30, v78
    v_exp_f32 v30, v30
    v_sub_f32 v31, v31, v78
    v_exp_f32 v31, v31
    s_waitcnt lgkmcnt(0)
    s_barrier
    s_setprio 3
    v_sub_f32 v0, v0, v78
    v_exp_f32 v0, v0
    ds_read_b128 a[168:171], v74
    v_add_u32 v74, 1152, v74
    v_sub_f32 v1, v1, v78
    v_exp_f32 v1, v1
    v_smfmac_f32_32x32x32_bf16 a[104:119], a[68:71], v[24:31], v68
    v_sub_f32 v2, v2, v78
    v_exp_f32 v2, v2
    v_sub_f32 v3, v3, v78
    v_exp_f32 v3, v3
    v_sub_f32 v4, v4, v78
    v_exp_f32 v4, v4
    v_sub_f32 v5, v5, v78
    v_exp_f32 v5, v5
    v_mfma_f32_32x32x8bf16_1k v[16:31], a[36:37], a[166:167], 0
    v_sub_f32 v6, v6, v78
    v_exp_f32 v6, v6
    v_sub_f32 v7, v7, v78
    v_exp_f32 v7, v7
    v_sub_f32 v8, v8, v78
    v_exp_f32 v8, v8
    v_sub_f32 v9, v9, v78
    v_exp_f32 v9, v9
    v_mfma_f32_32x32x16_bf16 v[16:31], a[20:23], a[160:163], v[16:31]
    v_sub_f32 v10, v10, v78
    v_exp_f32 v10, v10
    v_sub_f32 v11, v11, v78
    v_exp_f32 v11, v11
    v_sub_f32 v12, v12, v78
    v_exp_f32 v12, v12
    s_waitcnt lgkmcnt(0)
    s_waitcnt vmcnt(18)
    v_smfmac_f32_16x16x64_bf16 v[32:35], a[168:171], a[120:127], v69
    v_sub_f32 v13, v13, v78
    v_exp_f32 v13, v13
    v_smfmac_f32_32x32x32_bf16 a[104:119], a[72:75], v[0:7], v68
    v_sub_f32 v14, v14, v78
    v_exp_f32 v14, v14
    s_add_u32 s58, s48, 0
    buffer_load_dwordx4 a[120:123], v75, s[20:23], s58 offen sc1
    buffer_load_dwordx4 a[124:127], v75, s[20:23], s58 offen offset:1024 sc1
    v_sub_f32 v15, v15, v78
    v_exp_f32 v15, v15
    s_setprio 3
    v_sub_f32 v16, v16, v78
    v_exp_f32 v16, v16
    v_sub_f32 v17, v17, v78
    v_exp_f32 v17, v17
    v_smfmac_f32_32x32x32_bf16 a[104:119], a[76:79], v[8:15], v68
    v_sub_f32 v18, v18, v78
    v_exp_f32 v18, v18
    v_sub_f32 v19, v19, v78
    v_exp_f32 v19, v19
    v_sub_f32 v20, v20, v78
    v_exp_f32 v20, v20
    s_waitcnt vmcnt(18)
    v_smfmac_f32_16x16x64_bf16 v[36:39], a[168:171], a[128:135], v69
    v_sub_f32 v21, v21, v78
    v_exp_f32 v21, v21
    v_mfma_f32_32x32x8bf16_1k v[0:15], a[38:39], a[164:165], 0
    v_sub_f32 v22, v22, v78
    v_exp_f32 v22, v22
    v_sub_f32 v23, v23, v78
    v_exp_f32 v23, v23
    s_add_u32 s58, s48, 2048
    buffer_load_dwordx4 a[128:131], v75, s[20:23], s58 offen sc1
    buffer_load_dwordx4 a[132:135], v75, s[20:23], s58 offen offset:1024 sc1
    v_sub_f32 v24, v24, v78
    v_exp_f32 v24, v24
    v_sub_f32 v25, v25, v78
    v_exp_f32 v25, v25
    v_mfma_f32_32x32x16_bf16 v[0:15], a[24:27], a[160:163], v[0:15]
    v_sub_f32 v26, v26, v78
    v_exp_f32 v26, v26
    v_sub_f32 v27, v27, v78
    v_exp_f32 v27, v27
    v_sub_f32 v28, v28, v78
    v_exp_f32 v28, v28
    v_sub_f32 v29, v29, v78
    v_exp_f32 v29, v29
    v_smfmac_f32_32x32x32_bf16 a[104:119], a[80:83], v[16:23], v68
    v_sub_f32 v30, v30, v78
    v_exp_f32 v30, v30
    v_sub_f32 v31, v31, v78
    v_exp_f32 v31, v31
    s_setprio 2
    v_sub_f32 v0, v0, v78
    v_exp_f32 v0, v0
    v_sub_f32 v1, v1, v78
    v_exp_f32 v1, v1
    v_smfmac_f32_32x32x32_bf16 a[104:119], a[84:87], v[24:31], v68
    v_sub_f32 v2, v2, v78
    v_exp_f32 v2, v2
    v_sub_f32 v3, v3, v78
    v_exp_f32 v3, v3
    v_sub_f32 v4, v4, v78
    v_exp_f32 v4, v4
    s_waitcnt vmcnt(18)
    v_smfmac_f32_16x16x64_bf16 v[40:43], a[168:171], a[136:143], v69
    v_sub_f32 v5, v5, v78
    v_exp_f32 v5, v5
    v_mfma_f32_32x32x8bf16_1k v[16:31], a[38:39], a[166:167], 0
    v_sub_f32 v6, v6, v78
    v_exp_f32 v6, v6
    v_sub_f32 v7, v7, v78
    v_exp_f32 v7, v7
    s_add_u32 s58, s48, 4096
    buffer_load_dwordx4 a[136:139], v75, s[20:23], s58 offen sc1
    buffer_load_dwordx4 a[140:143], v75, s[20:23], s58 offen offset:1024 sc1
    v_sub_f32 v8, v8, v78
    v_exp_f32 v8, v8
    v_sub_f32 v9, v9, v78
    v_exp_f32 v9, v9
    v_mfma_f32_32x32x16_bf16 v[16:31], a[28:31], a[160:163], v[16:31]
    v_sub_f32 v10, v10, v78
    v_exp_f32 v10, v10
    v_sub_f32 v11, v11, v78
    v_exp_f32 v11, v11
    v_sub_f32 v12, v12, v78
    v_exp_f32 v12, v12
    v_sub_f32 v13, v13, v78
    v_exp_f32 v13, v13
    v_smfmac_f32_32x32x32_bf16 a[104:119], a[88:91], v[0:7], v68
    v_sub_f32 v14, v14, v78
    v_exp_f32 v14, v14
    v_sub_f32 v15, v15, v78
    v_exp_f32 v15, v15
    s_setprio 1
    v_sub_f32 v16, v16, v78
    v_exp_f32 v16, v16
    v_sub_f32 v17, v17, v78
    v_exp_f32 v17, v17
    v_smfmac_f32_32x32x32_bf16 a[104:119], a[92:95], v[8:15], v68
    v_sub_f32 v18, v18, v78
    v_exp_f32 v18, v18
    v_lshlrev_b32 v82, 2, v79
    s_lshl_b32 s59, s2, 3
    s_add_u32 s59, s59, s18
    s_mul_i32 s59, s59, 1152
    buffer_load_dwordx4 v[0:3], v75, s[36:39], s59 offen
    buffer_load_dword v4, v82, s[36:39], s59 offen offset:1024
    buffer_load_dwordx4 v[6:9], v75, s[44:47], 0 offen
    buffer_load_dword v10, v82, s[44:47], 0 offen offset:1024
    v_sub_f32 v19, v19, v78
    v_exp_f32 v19, v19
    v_sub_f32 v20, v20, v78
    v_exp_f32 v20, v20
    s_waitcnt vmcnt(22)
    v_smfmac_f32_16x16x64_bf16 v[44:47], a[168:171], a[144:151], v69
    v_sub_f32 v21, v21, v78
    v_exp_f32 v21, v21
    v_sub_f32 v22, v22, v78
    v_exp_f32 v22, v22
    v_sub_f32 v23, v23, v78
    v_exp_f32 v23, v23
    s_add_u32 s58, s48, 6144
    buffer_load_dwordx4 a[144:147], v75, s[20:23], s58 offen sc1
    buffer_load_dwordx4 a[148:151], v75, s[20:23], s58 offen offset:1024 sc1
    v_sub_f32 v24, v24, v78
    v_exp_f32 v24, v24
    v_sub_f32 v25, v25, v78
    v_exp_f32 v25, v25
    v_sub_f32 v26, v26, v78
    v_exp_f32 v26, v26
    v_sub_f32 v27, v27, v78
    v_exp_f32 v27, v27
    v_sub_f32 v28, v28, v78
    v_exp_f32 v28, v28
    s_waitcnt vmcnt(22)
    v_smfmac_f32_16x16x64_bf16 v[48:51], a[168:171], a[152:159], v69
    v_sub_f32 v29, v29, v78
    v_exp_f32 v29, v29
    v_smfmac_f32_32x32x32_bf16 a[104:119], a[96:99], v[16:23], v68
    v_sub_f32 v30, v30, v78
    v_exp_f32 v30, v30
    s_add_u32 s58, s48, 8192
    buffer_load_dwordx4 a[152:155], v75, s[20:23], s58 offen sc1
    buffer_load_dwordx4 a[156:159], v75, s[20:23], s58 offen offset:1024 sc1
    v_sub_f32 v31, v31, v78
    v_exp_f32 v31, v31
    s_setprio 0
    s_nop 0
    v_smfmac_f32_32x32x32_bf16 a[104:119], a[100:103], v[24:31], v68
    s_nop 9
    ds_write_b128 v70, a[104:107]
    ds_write_b128 v70, a[108:111] offset:32
    ds_write_b64 v80, a[112:113]
    s_waitcnt lgkmcnt(0)
    s_barrier
    ds_read2st64_b64 v[52:55], v71 offset0:0 offset1:5
    ds_read2st64_b64 v[56:59], v71 offset0:10 offset1:15
    ds_read2st64_b64 v[60:63], v71 offset0:20 offset1:25
    ds_read2st64_b64 v[64:67], v71 offset0:30 offset1:35
    v_and_b32 v22, 15, v79
    v_bfe_u32 v23, v79, 4, 1
    v_mul_u32_u24 v23, 10304, v23
    v_lshl_add_u32 v22, v22, 2, v23
    s_lshl_b32 s58, s56, 6
    s_add_u32 s58, s58, 110592
    v_add_u32 v22, s58, v22
    v_lshrrev_b32 v23, 5, v79
    v_lshl_add_u32 v23, v23, 6, v22
    v_add_u32 v24, 128, v23
    s_waitcnt lgkmcnt(2)
    v_add_f32 v52, v52, v54
    v_add_f32 v53, v53, v55
    v_add_f32 v56, v56, v58
    v_add_f32 v57, v57, v59
    v_add_f32 v52, v52, v56
    v_add_f32 v53, v53, v57
    s_waitcnt lgkmcnt(0)
    v_add_f32 v60, v60, v62
    v_add_f32 v61, v61, v63
    v_add_f32 v64, v64, v66
    v_add_f32 v65, v65, v67
    v_add_f32 v60, v60, v64
    v_add_f32 v61, v61, v65
    v_add_f32 v52, v52, v60
    v_add_f32 v53, v53, v61
    s_nop 0
    v_rcp_f32_dpp v54, v52 row_newbcast:9 row_mask:0xf bank_mask:0xf
    s_nop 0
    v_mul_f32 v52, v52, v54
    v_mul_f32 v53, v53, v54
    v_cvt_pk_bf16_f32 v56, v52, v53
    ds_write_b32 v72, v56
    s_waitcnt vmcnt(4)
    v_lshlrev_b32 v12, 16, v0
    v_and_b32 v13, 0xffff0000, v0
    v_lshlrev_b32 v14, 16, v1
    v_and_b32 v15, 0xffff0000, v1
    v_lshlrev_b32 v16, 16, v2
    v_and_b32 v17, 0xffff0000, v2
    v_lshlrev_b32 v18, 16, v3
    v_and_b32 v19, 0xffff0000, v3
    v_lshlrev_b32 v20, 16, v4
    v_and_b32 v21, 0xffff0000, v4
    s_waitcnt lgkmcnt(0)
    s_barrier
    ds_read_b128 a[160:163], v74 offset:1152
    ds_read_b128 a[168:171], v74
    v_mov_b32 v60, 0
    v_mov_b32 v61, 0x3f803f80
    s_mul_i32 s58, s18, 2560
    s_lshr_b32 s59, s18, 2
    s_lshl_b32 s59, s59, 6
    s_add_u32 s58, s58, s59
    s_add_u32 s58, s58, 110592
    v_lshl_add_u32 v62, v79, 5, s58
    v_lshl_add_u32 v63, v79, 3, s58
    v_dot2c_f32_bf16 v60, v6, v61
    v_dot2c_f32_bf16 v60, v7, v61
    v_dot2c_f32_bf16 v60, v8, v61
    v_dot2c_f32_bf16 v60, v9, v61
    v_dot2c_f32_bf16 v60, v10, v61
    s_waitcnt lgkmcnt(1)
    v_smfmac_f32_16x16x64_bf16 v[32:35], a[160:163], a[0:7], v69
    v_smfmac_f32_16x16x64_bf16 v[36:39], a[160:163], a[40:47], v69
    v_smfmac_f32_16x16x64_bf16 v[40:43], a[160:163], a[48:55], v69
    v_smfmac_f32_16x16x64_bf16 v[44:47], a[160:163], a[8:15], v69
    v_smfmac_f32_16x16x64_bf16 v[48:51], a[160:163], a[56:63], v69
    s_waitcnt lgkmcnt(0)
    v_smfmac_f32_16x16x64_bf16 v[32:35], a[168:171], a[120:127], v69
    v_smfmac_f32_16x16x64_bf16 v[36:39], a[168:171], a[128:135], v69
    v_smfmac_f32_16x16x64_bf16 v[40:43], a[168:171], a[136:143], v69
    s_waitcnt vmcnt(2)
    v_smfmac_f32_16x16x64_bf16 v[44:47], a[168:171], a[144:151], v69
    s_waitcnt vmcnt(0)
    v_smfmac_f32_16x16x64_bf16 v[48:51], a[168:171], a[152:159], v69
    s_nop 4
    v_permlane32_swap_b32 v32, v36
    v_permlane32_swap_b32 v33, v37
    v_permlane32_swap_b32 v34, v38
    v_permlane32_swap_b32 v35, v39
    v_add_f32 v32, v32, v36
    v_add_f32 v33, v33, v37
    v_add_f32 v34, v34, v38
    v_add_f32 v35, v35, v39
    ds_write2st64_b32 v23, v32, v33 offset0:0 offset1:10
    ds_write2st64_b32 v23, v34, v35 offset0:20 offset1:30
    v_permlane32_swap_b32 v40, v44
    v_permlane32_swap_b32 v41, v45
    v_permlane32_swap_b32 v42, v46
    v_permlane32_swap_b32 v43, v47
    v_add_f32 v40, v40, v44
    v_add_f32 v41, v41, v45
    v_add_f32 v42, v42, v46
    v_add_f32 v43, v43, v47
    ds_write2st64_b32 v24, v40, v41 offset0:0 offset1:10
    ds_write2st64_b32 v24, v42, v43 offset0:20 offset1:30
    v_mov_b32 v56, v48
    v_mov_b32 v57, v49
    v_mov_b32 v58, v50
    v_mov_b32 v59, v51
    v_permlane32_swap_b32 v48, v56
    v_permlane32_swap_b32 v49, v57
    v_permlane32_swap_b32 v50, v58
    v_permlane32_swap_b32 v51, v59
    v_add_f32 v48, v48, v56
    v_add_f32 v49, v49, v57
    v_add_f32 v50, v50, v58
    v_add_f32 v51, v51, v59
    ds_write2st64_b32 v22, v48, v49 offset0:1 offset1:11
    ds_write2st64_b32 v22, v50, v51 offset0:21 offset1:31
    s_branch L_tail
L_s4:
    s_waitcnt lgkmcnt(0)
    v_mfma_f32_32x32x8bf16_1k v[0:15], a[32:33], a[164:165], 0
    v_mfma_f32_32x32x16_bf16 v[0:15], a[0:3], a[160:163], v[0:15]
    v_mfma_f32_32x32x8bf16_1k a[104:119], a[164:165], a[166:167], 0
    ds_read_b32 v78, v82
    v_add_u32 v82, 128, v82
    s_waitcnt lgkmcnt(0)
    s_nop 5
    s_setprio 1
    v_sub_f32 v0, v0, v78
    v_exp_f32 v0, v0
    v_sub_f32 v1, v1, v78
    v_exp_f32 v1, v1
    v_sub_f32 v2, v2, v78
    v_exp_f32 v2, v2
    v_sub_f32 v3, v3, v78
    v_exp_f32 v3, v3
    v_sub_f32 v4, v4, v78
    v_exp_f32 v4, v4
    v_sub_f32 v5, v5, v78
    v_exp_f32 v5, v5
    v_mfma_f32_32x32x8bf16_1k v[16:31], a[32:33], a[166:167], 0
    v_sub_f32 v6, v6, v78
    v_exp_f32 v6, v6
    v_sub_f32 v7, v7, v78
    v_exp_f32 v7, v7
    v_sub_f32 v8, v8, v78
    v_exp_f32 v8, v8
    v_sub_f32 v9, v9, v78
    v_exp_f32 v9, v9
    v_mfma_f32_32x32x16_bf16 v[16:31], a[4:7], a[160:163], v[16:31]
    v_sub_f32 v10, v10, v78
    v_exp_f32 v10, v10
    v_sub_f32 v11, v11, v78
    v_exp_f32 v11, v11
    v_sub_f32 v12, v12, v78
    v_exp_f32 v12, v12
    v_sub_f32 v13, v13, v78
    v_exp_f32 v13, v13
    v_smfmac_f32_32x32x32_bf16 a[104:119], a[40:43], v[0:7], v68
    v_sub_f32 v14, v14, v78
    v_exp_f32 v14, v14
    v_sub_f32 v15, v15, v78
    v_exp_f32 v15, v15
    s_setprio 3
    v_sub_f32 v16, v16, v78
    v_exp_f32 v16, v16
    v_sub_f32 v17, v17, v78
    v_exp_f32 v17, v17
    v_smfmac_f32_32x32x32_bf16 a[104:119], a[44:47], v[8:15], v68
    v_sub_f32 v18, v18, v78
    v_exp_f32 v18, v18
    v_sub_f32 v19, v19, v78
    v_exp_f32 v19, v19
    v_sub_f32 v20, v20, v78
    v_exp_f32 v20, v20
    v_sub_f32 v21, v21, v78
    v_exp_f32 v21, v21
    v_mfma_f32_32x32x8bf16_1k v[0:15], a[34:35], a[164:165], 0
    v_sub_f32 v22, v22, v78
    v_exp_f32 v22, v22
    v_sub_f32 v23, v23, v78
    v_exp_f32 v23, v23
    v_sub_f32 v24, v24, v78
    v_exp_f32 v24, v24
    v_sub_f32 v25, v25, v78
    v_exp_f32 v25, v25
    v_mfma_f32_32x32x16_bf16 v[0:15], a[8:11], a[160:163], v[0:15]
    v_sub_f32 v26, v26, v78
    v_exp_f32 v26, v26
    v_sub_f32 v27, v27, v78
    v_exp_f32 v27, v27
    v_sub_f32 v28, v28, v78
    v_exp_f32 v28, v28
    v_sub_f32 v29, v29, v78
    v_exp_f32 v29, v29
    v_smfmac_f32_32x32x32_bf16 a[104:119], a[48:51], v[16:23], v68
    v_sub_f32 v30, v30, v78
    v_exp_f32 v30, v30
    v_sub_f32 v31, v31, v78
    v_exp_f32 v31, v31
    s_setprio 2
    v_sub_f32 v0, v0, v78
    v_exp_f32 v0, v0
    v_sub_f32 v1, v1, v78
    v_exp_f32 v1, v1
    v_smfmac_f32_32x32x32_bf16 a[104:119], a[52:55], v[24:31], v68
    v_sub_f32 v2, v2, v78
    v_exp_f32 v2, v2
    v_sub_f32 v3, v3, v78
    v_exp_f32 v3, v3
    v_sub_f32 v4, v4, v78
    v_exp_f32 v4, v4
    v_sub_f32 v5, v5, v78
    v_exp_f32 v5, v5
    v_mfma_f32_32x32x8bf16_1k v[16:31], a[34:35], a[166:167], 0
    v_sub_f32 v6, v6, v78
    v_exp_f32 v6, v6
    v_sub_f32 v7, v7, v78
    v_exp_f32 v7, v7
    v_sub_f32 v8, v8, v78
    v_exp_f32 v8, v8
    v_sub_f32 v9, v9, v78
    v_exp_f32 v9, v9
    v_mfma_f32_32x32x16_bf16 v[16:31], a[12:15], a[160:163], v[16:31]
    v_sub_f32 v10, v10, v78
    v_exp_f32 v10, v10
    v_sub_f32 v11, v11, v78
    v_exp_f32 v11, v11
    v_sub_f32 v12, v12, v78
    v_exp_f32 v12, v12
    v_sub_f32 v13, v13, v78
    v_exp_f32 v13, v13
    v_smfmac_f32_32x32x32_bf16 a[104:119], a[56:59], v[0:7], v68
    v_sub_f32 v14, v14, v78
    v_exp_f32 v14, v14
    v_sub_f32 v15, v15, v78
    v_exp_f32 v15, v15
    s_setprio 1
    v_sub_f32 v16, v16, v78
    v_exp_f32 v16, v16
    v_sub_f32 v17, v17, v78
    v_exp_f32 v17, v17
    v_smfmac_f32_32x32x32_bf16 a[104:119], a[60:63], v[8:15], v68
    v_sub_f32 v18, v18, v78
    v_exp_f32 v18, v18
    v_sub_f32 v19, v19, v78
    v_exp_f32 v19, v19
    v_sub_f32 v20, v20, v78
    v_exp_f32 v20, v20
    v_sub_f32 v21, v21, v78
    v_exp_f32 v21, v21
    v_mfma_f32_32x32x8bf16_1k v[0:15], a[36:37], a[164:165], 0
    v_sub_f32 v22, v22, v78
    v_exp_f32 v22, v22
    v_sub_f32 v23, v23, v78
    v_exp_f32 v23, v23
    v_sub_f32 v24, v24, v78
    v_exp_f32 v24, v24
    v_sub_f32 v25, v25, v78
    v_exp_f32 v25, v25
    v_mfma_f32_32x32x16_bf16 v[0:15], a[16:19], a[160:163], v[0:15]
    v_sub_f32 v26, v26, v78
    v_exp_f32 v26, v26
    v_sub_f32 v27, v27, v78
    v_exp_f32 v27, v27
    v_sub_f32 v28, v28, v78
    v_exp_f32 v28, v28
    v_sub_f32 v29, v29, v78
    v_exp_f32 v29, v29
    v_smfmac_f32_32x32x32_bf16 a[104:119], a[64:67], v[16:23], v68
    v_sub_f32 v30, v30, v78
    v_exp_f32 v30, v30
    v_sub_f32 v31, v31, v78
    v_exp_f32 v31, v31
    s_setprio 3
    v_sub_f32 v0, v0, v78
    v_exp_f32 v0, v0
    v_sub_f32 v1, v1, v78
    v_exp_f32 v1, v1
    v_smfmac_f32_32x32x32_bf16 a[104:119], a[68:71], v[24:31], v68
    v_sub_f32 v2, v2, v78
    v_exp_f32 v2, v2
    v_sub_f32 v3, v3, v78
    v_exp_f32 v3, v3
    v_sub_f32 v4, v4, v78
    v_exp_f32 v4, v4
    v_sub_f32 v5, v5, v78
    v_exp_f32 v5, v5
    v_mfma_f32_32x32x8bf16_1k v[16:31], a[36:37], a[166:167], 0
    v_sub_f32 v6, v6, v78
    v_exp_f32 v6, v6
    v_sub_f32 v7, v7, v78
    v_exp_f32 v7, v7
    v_sub_f32 v8, v8, v78
    v_exp_f32 v8, v8
    v_sub_f32 v9, v9, v78
    v_exp_f32 v9, v9
    v_mfma_f32_32x32x16_bf16 v[16:31], a[20:23], a[160:163], v[16:31]
    v_sub_f32 v10, v10, v78
    v_exp_f32 v10, v10
    v_sub_f32 v11, v11, v78
    v_exp_f32 v11, v11
    v_sub_f32 v12, v12, v78
    v_exp_f32 v12, v12
    v_sub_f32 v13, v13, v78
    v_exp_f32 v13, v13
    v_smfmac_f32_32x32x32_bf16 a[104:119], a[72:75], v[0:7], v68
    v_sub_f32 v14, v14, v78
    v_exp_f32 v14, v14
    v_sub_f32 v15, v15, v78
    v_exp_f32 v15, v15
    s_setprio 3
    v_sub_f32 v16, v16, v78
    v_exp_f32 v16, v16
    v_sub_f32 v17, v17, v78
    v_exp_f32 v17, v17
    v_smfmac_f32_32x32x32_bf16 a[104:119], a[76:79], v[8:15], v68
    v_sub_f32 v18, v18, v78
    v_exp_f32 v18, v18
    v_sub_f32 v19, v19, v78
    v_exp_f32 v19, v19
    v_sub_f32 v20, v20, v78
    v_exp_f32 v20, v20
    v_sub_f32 v21, v21, v78
    v_exp_f32 v21, v21
    v_mfma_f32_32x32x8bf16_1k v[0:15], a[38:39], a[164:165], 0
    v_sub_f32 v22, v22, v78
    v_exp_f32 v22, v22
    v_sub_f32 v23, v23, v78
    v_exp_f32 v23, v23
    v_sub_f32 v24, v24, v78
    v_exp_f32 v24, v24
    v_sub_f32 v25, v25, v78
    v_exp_f32 v25, v25
    v_mfma_f32_32x32x16_bf16 v[0:15], a[24:27], a[160:163], v[0:15]
    v_sub_f32 v26, v26, v78
    v_exp_f32 v26, v26
    v_sub_f32 v27, v27, v78
    v_exp_f32 v27, v27
    s_add_u32 s58, s48, 0
    buffer_load_dwordx4 a[120:123], v75, s[20:23], s58 offen sc1
    buffer_load_dwordx4 a[124:127], v75, s[20:23], s58 offen offset:1024 sc1
    v_sub_f32 v28, v28, v78
    v_exp_f32 v28, v28
    v_sub_f32 v29, v29, v78
    v_exp_f32 v29, v29
    v_smfmac_f32_32x32x32_bf16 a[104:119], a[80:83], v[16:23], v68
    v_sub_f32 v30, v30, v78
    v_exp_f32 v30, v30
    v_sub_f32 v31, v31, v78
    v_exp_f32 v31, v31
    s_setprio 2
    v_sub_f32 v0, v0, v78
    v_exp_f32 v0, v0
    s_add_u32 s58, s48, 2048
    buffer_load_dwordx4 a[128:131], v75, s[20:23], s58 offen sc1
    buffer_load_dwordx4 a[132:135], v75, s[20:23], s58 offen offset:1024 sc1
    v_sub_f32 v1, v1, v78
    v_exp_f32 v1, v1
    v_smfmac_f32_32x32x32_bf16 a[104:119], a[84:87], v[24:31], v68
    v_sub_f32 v2, v2, v78
    v_exp_f32 v2, v2
    v_sub_f32 v3, v3, v78
    v_exp_f32 v3, v3
    v_sub_f32 v4, v4, v78
    v_exp_f32 v4, v4
    v_sub_f32 v5, v5, v78
    v_exp_f32 v5, v5
    v_mfma_f32_32x32x8bf16_1k v[16:31], a[38:39], a[166:167], 0
    v_sub_f32 v6, v6, v78
    v_exp_f32 v6, v6
    v_sub_f32 v7, v7, v78
    v_exp_f32 v7, v7
    s_add_u32 s58, s48, 4096
    buffer_load_dwordx4 a[136:139], v75, s[20:23], s58 offen sc1
    buffer_load_dwordx4 a[140:143], v75, s[20:23], s58 offen offset:1024 sc1
    v_sub_f32 v8, v8, v78
    v_exp_f32 v8, v8
    v_sub_f32 v9, v9, v78
    v_exp_f32 v9, v9
    v_mfma_f32_32x32x16_bf16 v[16:31], a[28:31], a[160:163], v[16:31]
    v_sub_f32 v10, v10, v78
    v_exp_f32 v10, v10
    ds_read_b128 a[160:163], v76
    ds_read_b128 a[164:167], v76 offset:1024
    v_add_u32 v76, 2048, v76
    v_sub_f32 v11, v11, v78
    v_exp_f32 v11, v11
    v_sub_f32 v12, v12, v78
    v_exp_f32 v12, v12
    v_sub_f32 v13, v13, v78
    v_exp_f32 v13, v13
    v_smfmac_f32_32x32x32_bf16 a[104:119], a[88:91], v[0:7], v68
    v_sub_f32 v14, v14, v78
    v_exp_f32 v14, v14
    v_sub_f32 v15, v15, v78
    v_exp_f32 v15, v15
    s_setprio 1
    v_sub_f32 v16, v16, v78
    v_exp_f32 v16, v16
    s_add_u32 s58, s48, 6144
    buffer_load_dwordx4 a[144:147], v75, s[20:23], s58 offen sc1
    buffer_load_dwordx4 a[148:151], v75, s[20:23], s58 offen offset:1024 sc1
    v_sub_f32 v17, v17, v78
    v_exp_f32 v17, v17
    v_smfmac_f32_32x32x32_bf16 a[104:119], a[92:95], v[8:15], v68
    v_sub_f32 v18, v18, v78
    v_exp_f32 v18, v18
    v_sub_f32 v19, v19, v78
    v_exp_f32 v19, v19
    v_sub_f32 v20, v20, v78
    v_exp_f32 v20, v20
    v_sub_f32 v21, v21, v78
    v_exp_f32 v21, v21
    s_waitcnt lgkmcnt(0)
    v_mfma_f32_32x32x8bf16_1k v[0:15], a[32:33], a[164:165], 0
    v_sub_f32 v22, v22, v78
    v_exp_f32 v22, v22
    v_sub_f32 v23, v23, v78
    v_exp_f32 v23, v23
    v_sub_f32 v24, v24, v78
    v_exp_f32 v24, v24
    v_sub_f32 v25, v25, v78
    v_exp_f32 v25, v25
    v_mfma_f32_32x32x16_bf16 v[0:15], a[0:3], a[160:163], v[0:15]
    v_sub_f32 v26, v26, v78
    v_exp_f32 v26, v26
    ds_read_b32 v67, v82
    s_waitcnt lgkmcnt(0)
    v_add_u32 v82, 128, v82
    v_sub_f32 v27, v27, v78
    v_exp_f32 v27, v27
    v_sub_f32 v28, v28, v78
    v_exp_f32 v28, v28
    v_sub_f32 v29, v29, v78
    v_exp_f32 v29, v29
    v_smfmac_f32_32x32x32_bf16 a[104:119], a[96:99], v[16:23], v68
    v_sub_f32 v30, v30, v78
    v_exp_f32 v30, v30
    v_sub_f32 v31, v31, v78
    v_exp_f32 v31, v31
    s_add_u32 s48, s48, 73728
    v_mov_b32 v78, v67
    s_mov_b32 s55, 6
    s_cmp_eq_u32 s52, 0
    s_cbranch_scc1 L_b4n_loop
.p2align 3
L_b4x_loop:
    s_setprio 1
    v_sub_f32 v0, v0, v78
    v_exp_f32 v0, v0
    v_sub_f32 v1, v1, v78
    v_exp_f32 v1, v1
    v_smfmac_f32_32x32x32_bf16 a[104:119], a[100:103], v[24:31], v68
    v_sub_f32 v2, v2, v78
    v_exp_f32 v2, v2
    v_sub_f32 v3, v3, v78
    v_exp_f32 v3, v3
    v_sub_f32 v4, v4, v78
    v_exp_f32 v4, v4
    v_mfma_f32_32x32x8bf16_1k v[16:31], a[32:33], a[166:167], 0
    v_sub_f32 v5, v5, v78
    v_exp_f32 v5, v5
    v_sub_f32 v6, v6, v78
    v_exp_f32 v6, v6
    v_sub_f32 v7, v7, v78
    v_exp_f32 v7, v7
    v_sub_f32 v8, v8, v78
    v_exp_f32 v8, v8
    v_mfma_f32_32x32x16_bf16 v[16:31], a[4:7], a[160:163], v[16:31]
    ds_write_b128 v70, a[104:107]
    ds_write_b128 v70, a[108:111] offset:32
    ds_write_b64 v80, a[112:113]
    v_sub_f32 v9, v9, v78
    v_exp_f32 v9, v9
    s_setprio 0
    v_sub_f32 v10, v10, v78
    v_exp_f32 v10, v10
    v_sub_f32 v11, v11, v78
    v_exp_f32 v11, v11
    v_mfma_f32_32x32x8bf16_1k a[104:119], a[164:165], a[166:167], 0
    v_sub_f32 v12, v12, v78
    v_exp_f32 v12, v12
    v_sub_f32 v13, v13, v78
    v_exp_f32 v13, v13
    s_add_u32 m0, s49, 0
    s_nop 0
    buffer_load_dwordx4 v77, s[24:27], s53 offen nt lds
    v_sub_f32 v14, v14, v78
    v_exp_f32 v14, v14
    v_sub_f32 v15, v15, v78
    v_exp_f32 v15, v15
    v_smfmac_f32_32x32x32_bf16 a[104:119], a[40:43], v[0:7], v68
    s_waitcnt lgkmcnt(0)
    s_barrier
    s_setprio 3
    v_sub_f32 v16, v16, v78
    v_exp_f32 v16, v16
    ds_read2st64_b32 v[52:53], v49 offset0:0 offset1:10
    v_sub_f32 v17, v17, v78
    v_exp_f32 v17, v17
    v_sub_f32 v18, v18, v78
    v_exp_f32 v18, v18
    v_smfmac_f32_32x32x32_bf16 a[104:119], a[44:47], v[8:15], v68
    ds_read2st64_b32 v[54:55], v49 offset0:20 offset1:30
    v_sub_f32 v19, v19, v78
    v_exp_f32 v19, v19
    v_sub_f32 v20, v20, v78
    v_exp_f32 v20, v20
    ds_read2st64_b32 v[56:57], v49 offset0:40 offset1:50
    v_sub_f32 v21, v21, v78
    v_exp_f32 v21, v21
    v_mfma_f32_32x32x8bf16_1k v[0:15], a[34:35], a[164:165], 0
    v_sub_f32 v22, v22, v78
    v_exp_f32 v22, v22
    ds_read2st64_b32 v[58:59], v49 offset0:60 offset1:70
    v_sub_f32 v23, v23, v78
    v_exp_f32 v23, v23
    v_sub_f32 v24, v24, v78
    v_exp_f32 v24, v24
    ds_read2st64_b64 v[60:63], v48 offset0:0 offset1:5
    v_sub_f32 v25, v25, v78
    v_exp_f32 v25, v25
    v_mfma_f32_32x32x16_bf16 v[0:15], a[8:11], a[160:163], v[0:15]
    v_sub_f32 v26, v26, v78
    v_exp_f32 v26, v26
    ds_read2st64_b64 v[64:67], v48 offset0:10 offset1:15
    v_sub_f32 v27, v27, v78
    v_exp_f32 v27, v27
    v_sub_f32 v28, v28, v78
    v_exp_f32 v28, v28
    s_waitcnt lgkmcnt(2)
    v_add_f32 v52, v52, v53
    v_add_f32 v54, v54, v55
    v_sub_f32 v29, v29, v78
    v_exp_f32 v29, v29
    v_smfmac_f32_32x32x32_bf16 a[104:119], a[48:51], v[16:23], v68
    v_add_f32 v56, v56, v57
    v_add_f32 v58, v58, v59
    s_add_u32 m0, s49, 36864
    s_nop 0
    buffer_load_dwordx4 v77, s[28:31], s53 offen nt lds
    s_add_u32 s53, s53, 884736
    v_sub_f32 v30, v30, v78
    v_exp_f32 v30, v30
    v_add_f32 v52, v52, v54
    v_add_f32 v56, v56, v58
    v_sub_f32 v31, v31, v78
    v_exp_f32 v31, v31
    s_setprio 2
    v_sub_f32 v0, v0, v78
    v_exp_f32 v0, v0
    v_add_f32 v81, v52, v56
    v_sub_f32 v1, v1, v78
    v_exp_f32 v1, v1
    v_smfmac_f32_32x32x32_bf16 a[104:119], a[52:55], v[24:31], v68
    ds_read2st64_b64 v[52:55], v48 offset0:20 offset1:25
    v_sub_f32 v2, v2, v78
    v_exp_f32 v2, v2
    ds_read2st64_b64 v[56:59], v48 offset0:30 offset1:35
    v_sub_f32 v3, v3, v78
    v_exp_f32 v3, v3
    v_rcp_f32_dpp v73, v81 quad_perm:[2,2,2,2] row_mask:0xf bank_mask:0xf
    v_sub_f32 v4, v4, v78
    v_exp_f32 v4, v4
    s_waitcnt lgkmcnt(2)
    v_add_f32 v60, v60, v62
    v_add_f32 v61, v61, v63
    v_sub_f32 v5, v5, v78
    v_exp_f32 v5, v5
    v_mfma_f32_32x32x8bf16_1k v[16:31], a[34:35], a[166:167], 0
    v_sub_f32 v6, v6, v78
    v_exp_f32 v6, v6
    v_add_f32 v64, v64, v66
    v_add_f32 v65, v65, v67
    v_sub_f32 v7, v7, v78
    v_exp_f32 v7, v7
    v_mul_f32 v81, v81, v73
    v_sub_f32 v8, v8, v78
    v_exp_f32 v8, v8
    v_add_f32 v60, v60, v64
    v_add_f32 v61, v61, v65
    v_sub_f32 v9, v9, v78
    v_exp_f32 v9, v9
    v_mfma_f32_32x32x16_bf16 v[16:31], a[12:15], a[160:163], v[16:31]
    v_sub_f32 v10, v10, v78
    v_exp_f32 v10, v10
    v_cvt_pk_bf16_f32 v81, v81, v81
    v_sub_f32 v11, v11, v78
    v_exp_f32 v11, v11
    s_waitcnt lgkmcnt(0)
    v_add_f32 v52, v52, v54
    v_add_f32 v53, v53, v55
    v_sub_f32 v12, v12, v78
    v_exp_f32 v12, v12
    ds_write_b16 v51, v81
    v_sub_f32 v13, v13, v78
    v_exp_f32 v13, v13
    v_smfmac_f32_32x32x32_bf16 a[104:119], a[56:59], v[0:7], v68
    s_add_u32 m0, s49, 73728
    s_nop 0
    buffer_load_dwordx4 v75, s[32:35], s54 offen nt lds
    s_add_u32 s49, s49, 6144
    s_add_u32 s54, s54, 6144
    v_sub_f32 v14, v14, v78
    v_exp_f32 v14, v14
    v_add_f32 v56, v56, v58
    v_add_f32 v57, v57, v59
    v_sub_f32 v15, v15, v78
    v_exp_f32 v15, v15
    s_setprio 1
    v_add_f32 v52, v52, v56
    v_add_f32 v53, v53, v57
    v_sub_f32 v16, v16, v78
    v_exp_f32 v16, v16
    v_sub_f32 v17, v17, v78
    v_exp_f32 v17, v17
    v_smfmac_f32_32x32x32_bf16 a[104:119], a[60:63], v[8:15], v68
    v_add_f32 v52, v52, v60
    v_add_f32 v53, v53, v61
    v_sub_f32 v18, v18, v78
    v_exp_f32 v18, v18
    v_sub_f32 v19, v19, v78
    v_exp_f32 v19, v19
    v_mul_f32 v52, v52, v73
    v_mul_f32 v53, v53, v73
    v_sub_f32 v20, v20, v78
    v_exp_f32 v20, v20
    v_cvt_pk_bf16_f32 v56, v52, v53
    v_sub_f32 v21, v21, v78
    v_exp_f32 v21, v21
    v_mfma_f32_32x32x8bf16_1k v[0:15], a[36:37], a[164:165], 0
    v_sub_f32 v22, v22, v78
    v_exp_f32 v22, v22
    ds_write_b32 v50, v56
    v_sub_f32 v23, v23, v78
    v_exp_f32 v23, v23
    v_add_u32 v51, 16, v51
    v_sub_f32 v24, v24, v78
    v_exp_f32 v24, v24
    v_add_u32 v50, 1152, v50
    v_sub_f32 v25, v25, v78
    v_exp_f32 v25, v25
    v_mfma_f32_32x32x16_bf16 v[0:15], a[16:19], a[160:163], v[0:15]
    v_sub_f32 v26, v26, v78
    v_exp_f32 v26, v26
    v_sub_f32 v27, v27, v78
    v_exp_f32 v27, v27
    s_setprio 0
    v_sub_f32 v28, v28, v78
    v_exp_f32 v28, v28
    v_sub_f32 v29, v29, v78
    v_exp_f32 v29, v29
    v_smfmac_f32_32x32x32_bf16 a[104:119], a[64:67], v[16:23], v68
    v_sub_f32 v30, v30, v78
    v_exp_f32 v30, v30
    v_sub_f32 v31, v31, v78
    v_exp_f32 v31, v31
    s_waitcnt lgkmcnt(0)
    s_barrier
    s_setprio 3
    v_sub_f32 v0, v0, v78
    v_exp_f32 v0, v0
    ds_read_b128 a[168:171], v74
    v_add_u32 v74, 1152, v74
    v_sub_f32 v1, v1, v78
    v_exp_f32 v1, v1
    v_smfmac_f32_32x32x32_bf16 a[104:119], a[68:71], v[24:31], v68
    v_sub_f32 v2, v2, v78
    v_exp_f32 v2, v2
    v_sub_f32 v3, v3, v78
    v_exp_f32 v3, v3
    v_sub_f32 v4, v4, v78
    v_exp_f32 v4, v4
    v_sub_f32 v5, v5, v78
    v_exp_f32 v5, v5
    v_mfma_f32_32x32x8bf16_1k v[16:31], a[36:37], a[166:167], 0
    v_sub_f32 v6, v6, v78
    v_exp_f32 v6, v6
    v_sub_f32 v7, v7, v78
    v_exp_f32 v7, v7
    v_sub_f32 v8, v8, v78
    v_exp_f32 v8, v8
    v_sub_f32 v9, v9, v78
    v_exp_f32 v9, v9
    v_mfma_f32_32x32x16_bf16 v[16:31], a[20:23], a[160:163], v[16:31]
    v_sub_f32 v10, v10, v78
    v_exp_f32 v10, v10
    v_sub_f32 v11, v11, v78
    v_exp_f32 v11, v11
    v_sub_f32 v12, v12, v78
    v_exp_f32 v12, v12
    s_waitcnt lgkmcnt(0)
    s_waitcnt vmcnt(5)
    v_smfmac_f32_16x16x64_bf16 v[32:35], a[168:171], a[120:127], v69
    v_sub_f32 v13, v13, v78
    v_exp_f32 v13, v13
    v_smfmac_f32_32x32x32_bf16 a[104:119], a[72:75], v[0:7], v68
    v_sub_f32 v14, v14, v78
    v_exp_f32 v14, v14
    s_add_u32 s58, s48, 0
    buffer_load_dwordx4 a[120:123], v75, s[20:23], s58 offen sc1
    buffer_load_dwordx4 a[124:127], v75, s[20:23], s58 offen offset:1024 sc1
    v_sub_f32 v15, v15, v78
    v_exp_f32 v15, v15
    s_setprio 3
    v_sub_f32 v16, v16, v78
    v_exp_f32 v16, v16
    v_sub_f32 v17, v17, v78
    v_exp_f32 v17, v17
    v_smfmac_f32_32x32x32_bf16 a[104:119], a[76:79], v[8:15], v68
    v_sub_f32 v18, v18, v78
    v_exp_f32 v18, v18
    v_sub_f32 v19, v19, v78
    v_exp_f32 v19, v19
    v_sub_f32 v20, v20, v78
    v_exp_f32 v20, v20
    v_smfmac_f32_16x16x64_bf16 v[36:39], a[168:171], a[128:135], v69
    v_sub_f32 v21, v21, v78
    v_exp_f32 v21, v21
    v_mfma_f32_32x32x8bf16_1k v[0:15], a[38:39], a[164:165], 0
    v_sub_f32 v22, v22, v78
    v_exp_f32 v22, v22
    v_sub_f32 v23, v23, v78
    v_exp_f32 v23, v23
    s_add_u32 s58, s48, 2048
    buffer_load_dwordx4 a[128:131], v75, s[20:23], s58 offen sc1
    buffer_load_dwordx4 a[132:135], v75, s[20:23], s58 offen offset:1024 sc1
    v_sub_f32 v24, v24, v78
    v_exp_f32 v24, v24
    v_sub_f32 v25, v25, v78
    v_exp_f32 v25, v25
    v_mfma_f32_32x32x16_bf16 v[0:15], a[24:27], a[160:163], v[0:15]
    v_sub_f32 v26, v26, v78
    v_exp_f32 v26, v26
    v_sub_f32 v27, v27, v78
    v_exp_f32 v27, v27
    v_sub_f32 v28, v28, v78
    v_exp_f32 v28, v28
    v_sub_f32 v29, v29, v78
    v_exp_f32 v29, v29
    v_smfmac_f32_32x32x32_bf16 a[104:119], a[80:83], v[16:23], v68
    v_sub_f32 v30, v30, v78
    v_exp_f32 v30, v30
    v_sub_f32 v31, v31, v78
    v_exp_f32 v31, v31
    s_setprio 2
    v_sub_f32 v0, v0, v78
    v_exp_f32 v0, v0
    v_sub_f32 v1, v1, v78
    v_exp_f32 v1, v1
    v_smfmac_f32_32x32x32_bf16 a[104:119], a[84:87], v[24:31], v68
    v_sub_f32 v2, v2, v78
    v_exp_f32 v2, v2
    v_sub_f32 v3, v3, v78
    v_exp_f32 v3, v3
    v_sub_f32 v4, v4, v78
    v_exp_f32 v4, v4
    v_smfmac_f32_16x16x64_bf16 v[40:43], a[168:171], a[136:143], v69
    v_sub_f32 v5, v5, v78
    v_exp_f32 v5, v5
    v_mfma_f32_32x32x8bf16_1k v[16:31], a[38:39], a[166:167], 0
    v_sub_f32 v6, v6, v78
    v_exp_f32 v6, v6
    v_sub_f32 v7, v7, v78
    v_exp_f32 v7, v7
    s_add_u32 s58, s48, 4096
    buffer_load_dwordx4 a[136:139], v75, s[20:23], s58 offen sc1
    buffer_load_dwordx4 a[140:143], v75, s[20:23], s58 offen offset:1024 sc1
    v_sub_f32 v8, v8, v78
    v_exp_f32 v8, v8
    v_sub_f32 v9, v9, v78
    v_exp_f32 v9, v9
    v_mfma_f32_32x32x16_bf16 v[16:31], a[28:31], a[160:163], v[16:31]
    v_sub_f32 v10, v10, v78
    v_exp_f32 v10, v10
    ds_read_b128 a[160:163], v76
    ds_read_b128 a[164:167], v76 offset:1024
    v_add_u32 v76, 2048, v76
    v_sub_f32 v11, v11, v78
    v_exp_f32 v11, v11
    v_sub_f32 v12, v12, v78
    v_exp_f32 v12, v12
    v_sub_f32 v13, v13, v78
    v_exp_f32 v13, v13
    v_smfmac_f32_32x32x32_bf16 a[104:119], a[88:91], v[0:7], v68
    v_sub_f32 v14, v14, v78
    v_exp_f32 v14, v14
    v_sub_f32 v15, v15, v78
    v_exp_f32 v15, v15
    s_setprio 1
    v_sub_f32 v16, v16, v78
    v_exp_f32 v16, v16
    v_sub_f32 v17, v17, v78
    v_exp_f32 v17, v17
    v_smfmac_f32_32x32x32_bf16 a[104:119], a[92:95], v[8:15], v68
    v_sub_f32 v18, v18, v78
    v_exp_f32 v18, v18
    v_sub_f32 v19, v19, v78
    v_exp_f32 v19, v19
    v_sub_f32 v20, v20, v78
    v_exp_f32 v20, v20
    s_waitcnt vmcnt(9)
    v_smfmac_f32_16x16x64_bf16 v[44:47], a[168:171], a[144:151], v69
    v_sub_f32 v21, v21, v78
    v_exp_f32 v21, v21
    s_waitcnt lgkmcnt(0)
    v_mfma_f32_32x32x8bf16_1k v[0:15], a[32:33], a[164:165], 0
    v_sub_f32 v22, v22, v78
    v_exp_f32 v22, v22
    v_sub_f32 v23, v23, v78
    v_exp_f32 v23, v23
    s_add_u32 s58, s48, 6144
    buffer_load_dwordx4 a[144:147], v75, s[20:23], s58 offen sc1
    buffer_load_dwordx4 a[148:151], v75, s[20:23], s58 offen offset:1024 sc1
    v_sub_f32 v24, v24, v78
    v_exp_f32 v24, v24
    v_sub_f32 v25, v25, v78
    v_exp_f32 v25, v25
    v_mfma_f32_32x32x16_bf16 v[0:15], a[0:3], a[160:163], v[0:15]
    v_sub_f32 v26, v26, v78
    v_exp_f32 v26, v26
    ds_read_b32 v67, v82
    s_waitcnt lgkmcnt(0)
    v_add_u32 v82, 128, v82
    v_sub_f32 v27, v27, v78
    v_exp_f32 v27, v27
    v_sub_f32 v28, v28, v78
    v_exp_f32 v28, v28
    v_sub_f32 v29, v29, v78
    v_exp_f32 v29, v29
    v_smfmac_f32_32x32x32_bf16 a[104:119], a[96:99], v[16:23], v68
    v_sub_f32 v30, v30, v78
    v_exp_f32 v30, v30
    v_sub_f32 v31, v31, v78
    v_exp_f32 v31, v31
    s_add_u32 s48, s48, 73728
    s_sub_u32 s55, s55, 1
    s_cmp_lg_u32 s55, 0
    v_mov_b32 v78, v67
    s_cbranch_scc1 L_b4x_loop
    s_branch L_b4_last
.p2align 3
L_b4n_loop:
    s_setprio 1
    v_sub_f32 v0, v0, v78
    v_exp_f32 v0, v0
    v_sub_f32 v1, v1, v78
    v_exp_f32 v1, v1
    v_smfmac_f32_32x32x32_bf16 a[104:119], a[100:103], v[24:31], v68
    v_sub_f32 v2, v2, v78
    v_exp_f32 v2, v2
    v_sub_f32 v3, v3, v78
    v_exp_f32 v3, v3
    v_sub_f32 v4, v4, v78
    v_exp_f32 v4, v4
    v_mfma_f32_32x32x8bf16_1k v[16:31], a[32:33], a[166:167], 0
    v_sub_f32 v5, v5, v78
    v_exp_f32 v5, v5
    v_sub_f32 v6, v6, v78
    v_exp_f32 v6, v6
    v_sub_f32 v7, v7, v78
    v_exp_f32 v7, v7
    v_sub_f32 v8, v8, v78
    v_exp_f32 v8, v8
    v_mfma_f32_32x32x16_bf16 v[16:31], a[4:7], a[160:163], v[16:31]
    ds_write_b128 v70, a[104:107]
    ds_write_b128 v70, a[108:111] offset:32
    ds_write_b64 v80, a[112:113]
    v_sub_f32 v9, v9, v78
    v_exp_f32 v9, v9
    s_setprio 0
    v_sub_f32 v10, v10, v78
    v_exp_f32 v10, v10
    v_sub_f32 v11, v11, v78
    v_exp_f32 v11, v11
    v_mfma_f32_32x32x8bf16_1k a[104:119], a[164:165], a[166:167], 0
    v_sub_f32 v12, v12, v78
    v_exp_f32 v12, v12
    v_sub_f32 v13, v13, v78
    v_exp_f32 v13, v13
    v_sub_f32 v14, v14, v78
    v_exp_f32 v14, v14
    v_sub_f32 v15, v15, v78
    v_exp_f32 v15, v15
    v_smfmac_f32_32x32x32_bf16 a[104:119], a[40:43], v[0:7], v68
    s_waitcnt lgkmcnt(0)
    s_barrier
    s_setprio 3
    v_sub_f32 v16, v16, v78
    v_exp_f32 v16, v16
    ds_read2st64_b32 v[52:53], v49 offset0:0 offset1:10
    v_sub_f32 v17, v17, v78
    v_exp_f32 v17, v17
    v_sub_f32 v18, v18, v78
    v_exp_f32 v18, v18
    v_smfmac_f32_32x32x32_bf16 a[104:119], a[44:47], v[8:15], v68
    ds_read2st64_b32 v[54:55], v49 offset0:20 offset1:30
    v_sub_f32 v19, v19, v78
    v_exp_f32 v19, v19
    v_sub_f32 v20, v20, v78
    v_exp_f32 v20, v20
    ds_read2st64_b32 v[56:57], v49 offset0:40 offset1:50
    v_sub_f32 v21, v21, v78
    v_exp_f32 v21, v21
    v_mfma_f32_32x32x8bf16_1k v[0:15], a[34:35], a[164:165], 0
    v_sub_f32 v22, v22, v78
    v_exp_f32 v22, v22
    ds_read2st64_b32 v[58:59], v49 offset0:60 offset1:70
    v_sub_f32 v23, v23, v78
    v_exp_f32 v23, v23
    v_sub_f32 v24, v24, v78
    v_exp_f32 v24, v24
    ds_read2st64_b64 v[60:63], v48 offset0:0 offset1:5
    v_sub_f32 v25, v25, v78
    v_exp_f32 v25, v25
    v_mfma_f32_32x32x16_bf16 v[0:15], a[8:11], a[160:163], v[0:15]
    v_sub_f32 v26, v26, v78
    v_exp_f32 v26, v26
    ds_read2st64_b64 v[64:67], v48 offset0:10 offset1:15
    v_sub_f32 v27, v27, v78
    v_exp_f32 v27, v27
    v_sub_f32 v28, v28, v78
    v_exp_f32 v28, v28
    s_waitcnt lgkmcnt(2)
    v_add_f32 v52, v52, v53
    v_add_f32 v54, v54, v55
    v_sub_f32 v29, v29, v78
    v_exp_f32 v29, v29
    v_smfmac_f32_32x32x32_bf16 a[104:119], a[48:51], v[16:23], v68
    v_add_f32 v56, v56, v57
    v_add_f32 v58, v58, v59
    v_sub_f32 v30, v30, v78
    v_exp_f32 v30, v30
    v_add_f32 v52, v52, v54
    v_add_f32 v56, v56, v58
    v_sub_f32 v31, v31, v78
    v_exp_f32 v31, v31
    s_setprio 2
    v_sub_f32 v0, v0, v78
    v_exp_f32 v0, v0
    v_add_f32 v81, v52, v56
    v_sub_f32 v1, v1, v78
    v_exp_f32 v1, v1
    v_smfmac_f32_32x32x32_bf16 a[104:119], a[52:55], v[24:31], v68
    ds_read2st64_b64 v[52:55], v48 offset0:20 offset1:25
    v_sub_f32 v2, v2, v78
    v_exp_f32 v2, v2
    ds_read2st64_b64 v[56:59], v48 offset0:30 offset1:35
    v_sub_f32 v3, v3, v78
    v_exp_f32 v3, v3
    v_rcp_f32_dpp v73, v81 quad_perm:[2,2,2,2] row_mask:0xf bank_mask:0xf
    v_sub_f32 v4, v4, v78
    v_exp_f32 v4, v4
    s_waitcnt lgkmcnt(2)
    v_add_f32 v60, v60, v62
    v_add_f32 v61, v61, v63
    v_sub_f32 v5, v5, v78
    v_exp_f32 v5, v5
    v_mfma_f32_32x32x8bf16_1k v[16:31], a[34:35], a[166:167], 0
    v_sub_f32 v6, v6, v78
    v_exp_f32 v6, v6
    v_add_f32 v64, v64, v66
    v_add_f32 v65, v65, v67
    v_sub_f32 v7, v7, v78
    v_exp_f32 v7, v7
    v_mul_f32 v81, v81, v73
    v_sub_f32 v8, v8, v78
    v_exp_f32 v8, v8
    v_add_f32 v60, v60, v64
    v_add_f32 v61, v61, v65
    v_sub_f32 v9, v9, v78
    v_exp_f32 v9, v9
    v_mfma_f32_32x32x16_bf16 v[16:31], a[12:15], a[160:163], v[16:31]
    v_sub_f32 v10, v10, v78
    v_exp_f32 v10, v10
    v_cvt_pk_bf16_f32 v81, v81, v81
    v_sub_f32 v11, v11, v78
    v_exp_f32 v11, v11
    s_waitcnt lgkmcnt(0)
    v_add_f32 v52, v52, v54
    v_add_f32 v53, v53, v55
    v_sub_f32 v12, v12, v78
    v_exp_f32 v12, v12
    ds_write_b16 v51, v81
    v_sub_f32 v13, v13, v78
    v_exp_f32 v13, v13
    v_smfmac_f32_32x32x32_bf16 a[104:119], a[56:59], v[0:7], v68
    v_sub_f32 v14, v14, v78
    v_exp_f32 v14, v14
    v_add_f32 v56, v56, v58
    v_add_f32 v57, v57, v59
    v_sub_f32 v15, v15, v78
    v_exp_f32 v15, v15
    s_setprio 1
    v_add_f32 v52, v52, v56
    v_add_f32 v53, v53, v57
    v_sub_f32 v16, v16, v78
    v_exp_f32 v16, v16
    v_sub_f32 v17, v17, v78
    v_exp_f32 v17, v17
    v_smfmac_f32_32x32x32_bf16 a[104:119], a[60:63], v[8:15], v68
    v_add_f32 v52, v52, v60
    v_add_f32 v53, v53, v61
    v_sub_f32 v18, v18, v78
    v_exp_f32 v18, v18
    v_sub_f32 v19, v19, v78
    v_exp_f32 v19, v19
    v_mul_f32 v52, v52, v73
    v_mul_f32 v53, v53, v73
    v_sub_f32 v20, v20, v78
    v_exp_f32 v20, v20
    v_cvt_pk_bf16_f32 v56, v52, v53
    v_sub_f32 v21, v21, v78
    v_exp_f32 v21, v21
    v_mfma_f32_32x32x8bf16_1k v[0:15], a[36:37], a[164:165], 0
    v_sub_f32 v22, v22, v78
    v_exp_f32 v22, v22
    ds_write_b32 v50, v56
    v_sub_f32 v23, v23, v78
    v_exp_f32 v23, v23
    v_add_u32 v51, 16, v51
    v_sub_f32 v24, v24, v78
    v_exp_f32 v24, v24
    v_add_u32 v50, 1152, v50
    v_sub_f32 v25, v25, v78
    v_exp_f32 v25, v25
    v_mfma_f32_32x32x16_bf16 v[0:15], a[16:19], a[160:163], v[0:15]
    v_sub_f32 v26, v26, v78
    v_exp_f32 v26, v26
    v_sub_f32 v27, v27, v78
    v_exp_f32 v27, v27
    s_setprio 0
    v_sub_f32 v28, v28, v78
    v_exp_f32 v28, v28
    v_sub_f32 v29, v29, v78
    v_exp_f32 v29, v29
    v_smfmac_f32_32x32x32_bf16 a[104:119], a[64:67], v[16:23], v68
    v_sub_f32 v30, v30, v78
    v_exp_f32 v30, v30
    v_sub_f32 v31, v31, v78
    v_exp_f32 v31, v31
    s_waitcnt lgkmcnt(0)
    s_barrier
    s_setprio 3
    v_sub_f32 v0, v0, v78
    v_exp_f32 v0, v0
    ds_read_b128 a[168:171], v74
    v_add_u32 v74, 1152, v74
    v_sub_f32 v1, v1, v78
    v_exp_f32 v1, v1
    v_smfmac_f32_32x32x32_bf16 a[104:119], a[68:71], v[24:31], v68
    v_sub_f32 v2, v2, v78
    v_exp_f32 v2, v2
    v_sub_f32 v3, v3, v78
    v_exp_f32 v3, v3
    v_sub_f32 v4, v4, v78
    v_exp_f32 v4, v4
    v_sub_f32 v5, v5, v78
    v_exp_f32 v5, v5
    v_mfma_f32_32x32x8bf16_1k v[16:31], a[36:37], a[166:167], 0
    v_sub_f32 v6, v6, v78
    v_exp_f32 v6, v6
    v_sub_f32 v7, v7, v78
    v_exp_f32 v7, v7
    v_sub_f32 v8, v8, v78
    v_exp_f32 v8, v8
    v_sub_f32 v9, v9, v78
    v_exp_f32 v9, v9
    v_mfma_f32_32x32x16_bf16 v[16:31], a[20:23], a[160:163], v[16:31]
    v_sub_f32 v10, v10, v78
    v_exp_f32 v10, v10
    v_sub_f32 v11, v11, v78
    v_exp_f32 v11, v11
    v_sub_f32 v12, v12, v78
    v_exp_f32 v12, v12
    s_waitcnt lgkmcnt(0)
    s_waitcnt vmcnt(2)
    v_smfmac_f32_16x16x64_bf16 v[32:35], a[168:171], a[120:127], v69
    v_sub_f32 v13, v13, v78
    v_exp_f32 v13, v13
    v_smfmac_f32_32x32x32_bf16 a[104:119], a[72:75], v[0:7], v68
    v_sub_f32 v14, v14, v78
    v_exp_f32 v14, v14
    s_add_u32 s58, s48, 0
    buffer_load_dwordx4 a[120:123], v75, s[20:23], s58 offen sc1
    buffer_load_dwordx4 a[124:127], v75, s[20:23], s58 offen offset:1024 sc1
    v_sub_f32 v15, v15, v78
    v_exp_f32 v15, v15
    s_setprio 3
    v_sub_f32 v16, v16, v78
    v_exp_f32 v16, v16
    v_sub_f32 v17, v17, v78
    v_exp_f32 v17, v17
    v_smfmac_f32_32x32x32_bf16 a[104:119], a[76:79], v[8:15], v68
    v_sub_f32 v18, v18, v78
    v_exp_f32 v18, v18
    v_sub_f32 v19, v19, v78
    v_exp_f32 v19, v19
    v_sub_f32 v20, v20, v78
    v_exp_f32 v20, v20
    v_smfmac_f32_16x16x64_bf16 v[36:39], a[168:171], a[128:135], v69
    v_sub_f32 v21, v21, v78
    v_exp_f32 v21, v21
    v_mfma_f32_32x32x8bf16_1k v[0:15], a[38:39], a[164:165], 0
    v_sub_f32 v22, v22, v78
    v_exp_f32 v22, v22
    v_sub_f32 v23, v23, v78
    v_exp_f32 v23, v23
    s_add_u32 s58, s48, 2048
    buffer_load_dwordx4 a[128:131], v75, s[20:23], s58 offen sc1
    buffer_load_dwordx4 a[132:135], v75, s[20:23], s58 offen offset:1024 sc1
    v_sub_f32 v24, v24, v78
    v_exp_f32 v24, v24
    v_sub_f32 v25, v25, v78
    v_exp_f32 v25, v25
    v_mfma_f32_32x32x16_bf16 v[0:15], a[24:27], a[160:163], v[0:15]
    v_sub_f32 v26, v26, v78
    v_exp_f32 v26, v26
    v_sub_f32 v27, v27, v78
    v_exp_f32 v27, v27
    v_sub_f32 v28, v28, v78
    v_exp_f32 v28, v28
    v_sub_f32 v29, v29, v78
    v_exp_f32 v29, v29
    v_smfmac_f32_32x32x32_bf16 a[104:119], a[80:83], v[16:23], v68
    v_sub_f32 v30, v30, v78
    v_exp_f32 v30, v30
    v_sub_f32 v31, v31, v78
    v_exp_f32 v31, v31
    s_setprio 2
    v_sub_f32 v0, v0, v78
    v_exp_f32 v0, v0
    v_sub_f32 v1, v1, v78
    v_exp_f32 v1, v1
    v_smfmac_f32_32x32x32_bf16 a[104:119], a[84:87], v[24:31], v68
    v_sub_f32 v2, v2, v78
    v_exp_f32 v2, v2
    v_sub_f32 v3, v3, v78
    v_exp_f32 v3, v3
    v_sub_f32 v4, v4, v78
    v_exp_f32 v4, v4
    v_smfmac_f32_16x16x64_bf16 v[40:43], a[168:171], a[136:143], v69
    v_sub_f32 v5, v5, v78
    v_exp_f32 v5, v5
    v_mfma_f32_32x32x8bf16_1k v[16:31], a[38:39], a[166:167], 0
    v_sub_f32 v6, v6, v78
    v_exp_f32 v6, v6
    v_sub_f32 v7, v7, v78
    v_exp_f32 v7, v7
    s_add_u32 s58, s48, 4096
    buffer_load_dwordx4 a[136:139], v75, s[20:23], s58 offen sc1
    buffer_load_dwordx4 a[140:143], v75, s[20:23], s58 offen offset:1024 sc1
    v_sub_f32 v8, v8, v78
    v_exp_f32 v8, v8
    v_sub_f32 v9, v9, v78
    v_exp_f32 v9, v9
    v_mfma_f32_32x32x16_bf16 v[16:31], a[28:31], a[160:163], v[16:31]
    v_sub_f32 v10, v10, v78
    v_exp_f32 v10, v10
    ds_read_b128 a[160:163], v76
    ds_read_b128 a[164:167], v76 offset:1024
    v_add_u32 v76, 2048, v76
    v_sub_f32 v11, v11, v78
    v_exp_f32 v11, v11
    v_sub_f32 v12, v12, v78
    v_exp_f32 v12, v12
    v_sub_f32 v13, v13, v78
    v_exp_f32 v13, v13
    v_smfmac_f32_32x32x32_bf16 a[104:119], a[88:91], v[0:7], v68
    v_sub_f32 v14, v14, v78
    v_exp_f32 v14, v14
    v_sub_f32 v15, v15, v78
    v_exp_f32 v15, v15
    s_setprio 1
    v_sub_f32 v16, v16, v78
    v_exp_f32 v16, v16
    v_sub_f32 v17, v17, v78
    v_exp_f32 v17, v17
    v_smfmac_f32_32x32x32_bf16 a[104:119], a[92:95], v[8:15], v68
    v_sub_f32 v18, v18, v78
    v_exp_f32 v18, v18
    v_sub_f32 v19, v19, v78
    v_exp_f32 v19, v19
    v_sub_f32 v20, v20, v78
    v_exp_f32 v20, v20
    s_waitcnt vmcnt(6)
    v_smfmac_f32_16x16x64_bf16 v[44:47], a[168:171], a[144:151], v69
    v_sub_f32 v21, v21, v78
    v_exp_f32 v21, v21
    s_waitcnt lgkmcnt(0)
    v_mfma_f32_32x32x8bf16_1k v[0:15], a[32:33], a[164:165], 0
    v_sub_f32 v22, v22, v78
    v_exp_f32 v22, v22
    v_sub_f32 v23, v23, v78
    v_exp_f32 v23, v23
    s_add_u32 s58, s48, 6144
    buffer_load_dwordx4 a[144:147], v75, s[20:23], s58 offen sc1
    buffer_load_dwordx4 a[148:151], v75, s[20:23], s58 offen offset:1024 sc1
    v_sub_f32 v24, v24, v78
    v_exp_f32 v24, v24
    v_sub_f32 v25, v25, v78
    v_exp_f32 v25, v25
    v_mfma_f32_32x32x16_bf16 v[0:15], a[0:3], a[160:163], v[0:15]
    v_sub_f32 v26, v26, v78
    v_exp_f32 v26, v26
    ds_read_b32 v67, v82
    s_waitcnt lgkmcnt(0)
    v_add_u32 v82, 128, v82
    v_sub_f32 v27, v27, v78
    v_exp_f32 v27, v27
    v_sub_f32 v28, v28, v78
    v_exp_f32 v28, v28
    v_sub_f32 v29, v29, v78
    v_exp_f32 v29, v29
    v_smfmac_f32_32x32x32_bf16 a[104:119], a[96:99], v[16:23], v68
    v_sub_f32 v30, v30, v78
    v_exp_f32 v30, v30
    v_sub_f32 v31, v31, v78
    v_exp_f32 v31, v31
    s_add_u32 s48, s48, 73728
    s_sub_u32 s55, s55, 1
    s_cmp_lg_u32 s55, 0
    v_mov_b32 v78, v67
    s_cbranch_scc1 L_b4n_loop
L_b4_last:
    s_setprio 1
    v_sub_f32 v0, v0, v78
    v_exp_f32 v0, v0
    v_sub_f32 v1, v1, v78
    v_exp_f32 v1, v1
    v_smfmac_f32_32x32x32_bf16 a[104:119], a[100:103], v[24:31], v68
    v_sub_f32 v2, v2, v78
    v_exp_f32 v2, v2
    v_sub_f32 v3, v3, v78
    v_exp_f32 v3, v3
    v_sub_f32 v4, v4, v78
    v_exp_f32 v4, v4
    v_mfma_f32_32x32x8bf16_1k v[16:31], a[32:33], a[166:167], 0
    v_sub_f32 v5, v5, v78
    v_exp_f32 v5, v5
    v_sub_f32 v6, v6, v78
    v_exp_f32 v6, v6
    v_sub_f32 v7, v7, v78
    v_exp_f32 v7, v7
    v_sub_f32 v8, v8, v78
    v_exp_f32 v8, v8
    v_mfma_f32_32x32x16_bf16 v[16:31], a[4:7], a[160:163], v[16:31]
    ds_write_b128 v70, a[104:107]
    ds_write_b128 v70, a[108:111] offset:32
    ds_write_b64 v80, a[112:113]
    v_sub_f32 v9, v9, v78
    v_exp_f32 v9, v9
    s_setprio 0
    v_sub_f32 v10, v10, v78
    v_exp_f32 v10, v10
    v_sub_f32 v11, v11, v78
    v_exp_f32 v11, v11
    v_mfma_f32_32x32x8bf16_1k a[104:119], a[164:165], a[166:167], 0
    v_sub_f32 v12, v12, v78
    v_exp_f32 v12, v12
    v_sub_f32 v13, v13, v78
    v_exp_f32 v13, v13
    v_sub_f32 v14, v14, v78
    v_exp_f32 v14, v14
    v_sub_f32 v15, v15, v78
    v_exp_f32 v15, v15
    v_smfmac_f32_32x32x32_bf16 a[104:119], a[40:43], v[0:7], v68
    s_waitcnt lgkmcnt(0)
    s_barrier
    s_setprio 3
    v_sub_f32 v16, v16, v78
    v_exp_f32 v16, v16
    ds_read2st64_b32 v[52:53], v49 offset0:0 offset1:10
    v_sub_f32 v17, v17, v78
    v_exp_f32 v17, v17
    v_sub_f32 v18, v18, v78
    v_exp_f32 v18, v18
    v_smfmac_f32_32x32x32_bf16 a[104:119], a[44:47], v[8:15], v68
    ds_read2st64_b32 v[54:55], v49 offset0:20 offset1:30
    v_sub_f32 v19, v19, v78
    v_exp_f32 v19, v19
    v_sub_f32 v20, v20, v78
    v_exp_f32 v20, v20
    ds_read2st64_b32 v[56:57], v49 offset0:40 offset1:50
    v_sub_f32 v21, v21, v78
    v_exp_f32 v21, v21
    v_mfma_f32_32x32x8bf16_1k v[0:15], a[34:35], a[164:165], 0
    v_sub_f32 v22, v22, v78
    v_exp_f32 v22, v22
    ds_read2st64_b32 v[58:59], v49 offset0:60 offset1:70
    v_sub_f32 v23, v23, v78
    v_exp_f32 v23, v23
    v_sub_f32 v24, v24, v78
    v_exp_f32 v24, v24
    ds_read2st64_b64 v[60:63], v48 offset0:0 offset1:5
    v_sub_f32 v25, v25, v78
    v_exp_f32 v25, v25
    v_mfma_f32_32x32x16_bf16 v[0:15], a[8:11], a[160:163], v[0:15]
    v_sub_f32 v26, v26, v78
    v_exp_f32 v26, v26
    ds_read2st64_b64 v[64:67], v48 offset0:10 offset1:15
    s_add_u32 s58, s48, 73728
    buffer_load_dwordx4 a[0:3], v75, s[20:23], s58 offen sc1
    buffer_load_dwordx4 a[4:7], v75, s[20:23], s58 offen offset:1024 sc1
    v_sub_f32 v27, v27, v78
    v_exp_f32 v27, v27
    v_sub_f32 v28, v28, v78
    v_exp_f32 v28, v28
    s_waitcnt lgkmcnt(2)
    v_add_f32 v52, v52, v53
    v_add_f32 v54, v54, v55
    v_sub_f32 v29, v29, v78
    v_exp_f32 v29, v29
    v_smfmac_f32_32x32x32_bf16 a[104:119], a[48:51], v[16:23], v68
    v_add_f32 v56, v56, v57
    v_add_f32 v58, v58, v59
    s_add_u32 s58, s48, 75776
    buffer_load_dwordx4 a[40:43], v75, s[20:23], s58 offen sc1
    buffer_load_dwordx4 a[44:47], v75, s[20:23], s58 offen offset:1024 sc1
    v_sub_f32 v30, v30, v78
    v_exp_f32 v30, v30
    v_add_f32 v52, v52, v54
    v_add_f32 v56, v56, v58
    v_sub_f32 v31, v31, v78
    v_exp_f32 v31, v31
    s_setprio 2
    v_sub_f32 v0, v0, v78
    v_exp_f32 v0, v0
    v_add_f32 v81, v52, v56
    v_sub_f32 v1, v1, v78
    v_exp_f32 v1, v1
    v_smfmac_f32_32x32x32_bf16 a[104:119], a[52:55], v[24:31], v68
    ds_read2st64_b64 v[52:55], v48 offset0:20 offset1:25
    v_sub_f32 v2, v2, v78
    v_exp_f32 v2, v2
    ds_read2st64_b64 v[56:59], v48 offset0:30 offset1:35
    v_sub_f32 v3, v3, v78
    v_exp_f32 v3, v3
    v_rcp_f32_dpp v73, v81 quad_perm:[2,2,2,2] row_mask:0xf bank_mask:0xf
    v_sub_f32 v4, v4, v78
    v_exp_f32 v4, v4
    s_waitcnt lgkmcnt(2)
    v_add_f32 v60, v60, v62
    v_add_f32 v61, v61, v63
    v_sub_f32 v5, v5, v78
    v_exp_f32 v5, v5
    v_mfma_f32_32x32x8bf16_1k v[16:31], a[34:35], a[166:167], 0
    v_sub_f32 v6, v6, v78
    v_exp_f32 v6, v6
    v_add_f32 v64, v64, v66
    v_add_f32 v65, v65, v67
    v_sub_f32 v7, v7, v78
    v_exp_f32 v7, v7
    v_mul_f32 v81, v81, v73
    v_sub_f32 v8, v8, v78
    v_exp_f32 v8, v8
    v_add_f32 v60, v60, v64
    v_add_f32 v61, v61, v65
    v_sub_f32 v9, v9, v78
    v_exp_f32 v9, v9
    v_mfma_f32_32x32x16_bf16 v[16:31], a[12:15], a[160:163], v[16:31]
    v_sub_f32 v10, v10, v78
    v_exp_f32 v10, v10
    v_cvt_pk_bf16_f32 v81, v81, v81
    s_add_u32 s58, s48, 77824
    buffer_load_dwordx4 a[48:51], v75, s[20:23], s58 offen sc1
    buffer_load_dwordx4 a[52:55], v75, s[20:23], s58 offen offset:1024 sc1
    v_sub_f32 v11, v11, v78
    v_exp_f32 v11, v11
    s_waitcnt lgkmcnt(0)
    v_add_f32 v52, v52, v54
    v_add_f32 v53, v53, v55
    v_sub_f32 v12, v12, v78
    v_exp_f32 v12, v12
    ds_write_b16 v51, v81
    v_sub_f32 v13, v13, v78
    v_exp_f32 v13, v13
    v_smfmac_f32_32x32x32_bf16 a[104:119], a[56:59], v[0:7], v68
    v_sub_f32 v14, v14, v78
    v_exp_f32 v14, v14
    v_add_f32 v56, v56, v58
    v_add_f32 v57, v57, v59
    v_sub_f32 v15, v15, v78
    v_exp_f32 v15, v15
    s_setprio 1
    v_add_f32 v52, v52, v56
    v_add_f32 v53, v53, v57
    v_sub_f32 v16, v16, v78
    v_exp_f32 v16, v16
    v_sub_f32 v17, v17, v78
    v_exp_f32 v17, v17
    v_smfmac_f32_32x32x32_bf16 a[104:119], a[60:63], v[8:15], v68
    v_add_f32 v52, v52, v60
    v_add_f32 v53, v53, v61
    v_sub_f32 v18, v18, v78
    v_exp_f32 v18, v18
    v_sub_f32 v19, v19, v78
    v_exp_f32 v19, v19
    v_mul_f32 v52, v52, v73
    v_mul_f32 v53, v53, v73
    v_sub_f32 v20, v20, v78
    v_exp_f32 v20, v20
    v_cvt_pk_bf16_f32 v56, v52, v53
    v_sub_f32 v21, v21, v78
    v_exp_f32 v21, v21
    v_mfma_f32_32x32x8bf16_1k v[0:15], a[36:37], a[164:165], 0
    v_sub_f32 v22, v22, v78
    v_exp_f32 v22, v22
    ds_write_b32 v50, v56
    v_sub_f32 v23, v23, v78
    v_exp_f32 v23, v23
    v_add_u32 v51, 16, v51
    v_sub_f32 v24, v24, v78
    v_exp_f32 v24, v24
    v_add_u32 v50, 1152, v50
    v_sub_f32 v25, v25, v78
    v_exp_f32 v25, v25
    v_mfma_f32_32x32x16_bf16 v[0:15], a[16:19], a[160:163], v[0:15]
    v_sub_f32 v26, v26, v78
    v_exp_f32 v26, v26
    s_add_u32 s58, s48, 79872
    buffer_load_dwordx4 a[8:11], v75, s[20:23], s58 offen sc1
    buffer_load_dwordx4 a[12:15], v75, s[20:23], s58 offen offset:1024 sc1
    v_sub_f32 v27, v27, v78
    v_exp_f32 v27, v27
    s_setprio 0
    v_sub_f32 v28, v28, v78
    v_exp_f32 v28, v28
    v_sub_f32 v29, v29, v78
    v_exp_f32 v29, v29
    v_smfmac_f32_32x32x32_bf16 a[104:119], a[64:67], v[16:23], v68
    v_sub_f32 v30, v30, v78
    v_exp_f32 v30, v30
    v_sub_f32 v31, v31, v78
    v_exp_f32 v31, v31
    s_waitcnt lgkmcnt(0)
    s_barrier
    s_setprio 3
    v_sub_f32 v0, v0, v78
    v_exp_f32 v0, v0
    ds_read_b128 a[168:171], v74
    v_add_u32 v74, 1152, v74
    v_sub_f32 v1, v1, v78
    v_exp_f32 v1, v1
    v_smfmac_f32_32x32x32_bf16 a[104:119], a[68:71], v[24:31], v68
    v_sub_f32 v2, v2, v78
    v_exp_f32 v2, v2
    v_sub_f32 v3, v3, v78
    v_exp_f32 v3, v3
    v_sub_f32 v4, v4, v78
    v_exp_f32 v4, v4
    v_sub_f32 v5, v5, v78
    v_exp_f32 v5, v5
    v_mfma_f32_32x32x8bf16_1k v[16:31], a[36:37], a[166:167], 0
    v_sub_f32 v6, v6, v78
    v_exp_f32 v6, v6
    v_sub_f32 v7, v7, v78
    v_exp_f32 v7, v7
    v_sub_f32 v8, v8, v78
    v_exp_f32 v8, v8
    v_sub_f32 v9, v9, v78
    v_exp_f32 v9, v9
    v_mfma_f32_32x32x16_bf16 v[16:31], a[20:23], a[160:163], v[16:31]
    v_sub_f32 v10, v10, v78
    v_exp_f32 v10, v10
    v_sub_f32 v11, v11, v78
    v_exp_f32 v11, v11
    v_sub_f32 v12, v12, v78
    v_exp_f32 v12, v12
    s_waitcnt lgkmcnt(0)
    s_waitcnt vmcnt(14)
    v_smfmac_f32_16x16x64_bf16 v[32:35], a[168:171], a[120:127], v69
    v_sub_f32 v13, v13, v78
    v_exp_f32 v13, v13
    v_smfmac_f32_32x32x32_bf16 a[104:119], a[72:75], v[0:7], v68
    v_sub_f32 v14, v14, v78
    v_exp_f32 v14, v14
    s_add_u32 s58, s48, 0
    buffer_load_dwordx4 a[120:123], v75, s[20:23], s58 offen sc1
    buffer_load_dwordx4 a[124:127], v75, s[20:23], s58 offen offset:1024 sc1
    v_sub_f32 v15, v15, v78
    v_exp_f32 v15, v15
    s_setprio 3
    v_sub_f32 v16, v16, v78
    v_exp_f32 v16, v16
    v_sub_f32 v17, v17, v78
    v_exp_f32 v17, v17
    v_smfmac_f32_32x32x32_bf16 a[104:119], a[76:79], v[8:15], v68
    v_sub_f32 v18, v18, v78
    v_exp_f32 v18, v18
    v_sub_f32 v19, v19, v78
    v_exp_f32 v19, v19
    v_sub_f32 v20, v20, v78
    v_exp_f32 v20, v20
    s_waitcnt vmcnt(14)
    v_smfmac_f32_16x16x64_bf16 v[36:39], a[168:171], a[128:135], v69
    v_sub_f32 v21, v21, v78
    v_exp_f32 v21, v21
    v_mfma_f32_32x32x8bf16_1k v[0:15], a[38:39], a[164:165], 0
    v_sub_f32 v22, v22, v78
    v_exp_f32 v22, v22
    v_sub_f32 v23, v23, v78
    v_exp_f32 v23, v23
    s_add_u32 s58, s48, 2048
    buffer_load_dwordx4 a[128:131], v75, s[20:23], s58 offen sc1
    buffer_load_dwordx4 a[132:135], v75, s[20:23], s58 offen offset:1024 sc1
    v_sub_f32 v24, v24, v78
    v_exp_f32 v24, v24
    v_sub_f32 v25, v25, v78
    v_exp_f32 v25, v25
    v_mfma_f32_32x32x16_bf16 v[0:15], a[24:27], a[160:163], v[0:15]
    v_sub_f32 v26, v26, v78
    v_exp_f32 v26, v26
    v_sub_f32 v27, v27, v78
    v_exp_f32 v27, v27
    v_sub_f32 v28, v28, v78
    v_exp_f32 v28, v28
    v_sub_f32 v29, v29, v78
    v_exp_f32 v29, v29
    v_smfmac_f32_32x32x32_bf16 a[104:119], a[80:83], v[16:23], v68
    v_sub_f32 v30, v30, v78
    v_exp_f32 v30, v30
    v_sub_f32 v31, v31, v78
    v_exp_f32 v31, v31
    s_setprio 2
    v_sub_f32 v0, v0, v78
    v_exp_f32 v0, v0
    v_sub_f32 v1, v1, v78
    v_exp_f32 v1, v1
    v_smfmac_f32_32x32x32_bf16 a[104:119], a[84:87], v[24:31], v68
    v_sub_f32 v2, v2, v78
    v_exp_f32 v2, v2
    v_sub_f32 v3, v3, v78
    v_exp_f32 v3, v3
    v_sub_f32 v4, v4, v78
    v_exp_f32 v4, v4
    s_waitcnt vmcnt(14)
    v_smfmac_f32_16x16x64_bf16 v[40:43], a[168:171], a[136:143], v69
    v_sub_f32 v5, v5, v78
    v_exp_f32 v5, v5
    v_mfma_f32_32x32x8bf16_1k v[16:31], a[38:39], a[166:167], 0
    v_sub_f32 v6, v6, v78
    v_exp_f32 v6, v6
    v_sub_f32 v7, v7, v78
    v_exp_f32 v7, v7
    s_add_u32 s58, s48, 4096
    buffer_load_dwordx4 a[136:139], v75, s[20:23], s58 offen sc1
    buffer_load_dwordx4 a[140:143], v75, s[20:23], s58 offen offset:1024 sc1
    v_sub_f32 v8, v8, v78
    v_exp_f32 v8, v8
    v_sub_f32 v9, v9, v78
    v_exp_f32 v9, v9
    v_mfma_f32_32x32x16_bf16 v[16:31], a[28:31], a[160:163], v[16:31]
    v_sub_f32 v10, v10, v78
    v_exp_f32 v10, v10
    v_sub_f32 v11, v11, v78
    v_exp_f32 v11, v11
    v_sub_f32 v12, v12, v78
    v_exp_f32 v12, v12
    v_sub_f32 v13, v13, v78
    v_exp_f32 v13, v13
    v_smfmac_f32_32x32x32_bf16 a[104:119], a[88:91], v[0:7], v68
    v_sub_f32 v14, v14, v78
    v_exp_f32 v14, v14
    v_sub_f32 v15, v15, v78
    v_exp_f32 v15, v15
    s_setprio 1
    v_sub_f32 v16, v16, v78
    v_exp_f32 v16, v16
    v_sub_f32 v17, v17, v78
    v_exp_f32 v17, v17
    v_smfmac_f32_32x32x32_bf16 a[104:119], a[92:95], v[8:15], v68
    v_sub_f32 v18, v18, v78
    v_exp_f32 v18, v18
    v_lshlrev_b32 v82, 2, v79
    s_lshl_b32 s59, s2, 3
    s_add_u32 s59, s59, s18
    s_mul_i32 s59, s59, 1152
    buffer_load_dwordx4 v[0:3], v75, s[36:39], s59 offen
    buffer_load_dword v4, v82, s[36:39], s59 offen offset:1024
    buffer_load_dwordx4 v[6:9], v75, s[44:47], 0 offen
    buffer_load_dword v10, v82, s[44:47], 0 offen offset:1024
    v_sub_f32 v19, v19, v78
    v_exp_f32 v19, v19
    v_sub_f32 v20, v20, v78
    v_exp_f32 v20, v20
    s_waitcnt vmcnt(18)
    v_smfmac_f32_16x16x64_bf16 v[44:47], a[168:171], a[144:151], v69
    v_sub_f32 v21, v21, v78
    v_exp_f32 v21, v21
    v_sub_f32 v22, v22, v78
    v_exp_f32 v22, v22
    v_sub_f32 v23, v23, v78
    v_exp_f32 v23, v23
    s_add_u32 s58, s48, 6144
    buffer_load_dwordx4 a[144:147], v75, s[20:23], s58 offen sc1
    buffer_load_dwordx4 a[148:151], v75, s[20:23], s58 offen offset:1024 sc1
    v_sub_f32 v24, v24, v78
    v_exp_f32 v24, v24
    v_sub_f32 v25, v25, v78
    v_exp_f32 v25, v25
    v_sub_f32 v26, v26, v78
    v_exp_f32 v26, v26
    v_sub_f32 v27, v27, v78
    v_exp_f32 v27, v27
    v_sub_f32 v28, v28, v78
    v_exp_f32 v28, v28
    v_sub_f32 v29, v29, v78
    v_exp_f32 v29, v29
    v_smfmac_f32_32x32x32_bf16 a[104:119], a[96:99], v[16:23], v68
    v_sub_f32 v30, v30, v78
    v_exp_f32 v30, v30
    v_sub_f32 v31, v31, v78
    v_exp_f32 v31, v31
    s_setprio 0
    s_nop 0
    v_smfmac_f32_32x32x32_bf16 a[104:119], a[100:103], v[24:31], v68
    s_nop 9
    ds_write_b128 v70, a[104:107]
    ds_write_b128 v70, a[108:111] offset:32
    ds_write_b64 v80, a[112:113]
    s_waitcnt lgkmcnt(0)
    s_barrier
    ds_read2st64_b64 v[52:55], v71 offset0:0 offset1:5
    ds_read2st64_b64 v[56:59], v71 offset0:10 offset1:15
    ds_read2st64_b64 v[60:63], v71 offset0:20 offset1:25
    ds_read2st64_b64 v[64:67], v71 offset0:30 offset1:35
    v_and_b32 v22, 15, v79
    v_bfe_u32 v23, v79, 4, 1
    v_mul_u32_u24 v23, 10304, v23
    v_lshl_add_u32 v22, v22, 2, v23
    s_lshl_b32 s58, s56, 6
    s_add_u32 s58, s58, 110592
    v_add_u32 v22, s58, v22
    v_lshrrev_b32 v23, 5, v79
    v_lshl_add_u32 v23, v23, 6, v22
    v_add_u32 v24, 128, v23
    s_waitcnt lgkmcnt(2)
    v_add_f32 v52, v52, v54
    v_add_f32 v53, v53, v55
    v_add_f32 v56, v56, v58
    v_add_f32 v57, v57, v59
    v_add_f32 v52, v52, v56
    v_add_f32 v53, v53, v57
    s_waitcnt lgkmcnt(0)
    v_add_f32 v60, v60, v62
    v_add_f32 v61, v61, v63
    v_add_f32 v64, v64, v66
    v_add_f32 v65, v65, v67
    v_add_f32 v60, v60, v64
    v_add_f32 v61, v61, v65
    v_add_f32 v52, v52, v60
    v_add_f32 v53, v53, v61
    s_nop 0
    v_rcp_f32_dpp v54, v52 row_newbcast:9 row_mask:0xf bank_mask:0xf
    s_nop 0
    v_mul_f32 v52, v52, v54
    v_mul_f32 v53, v53, v54
    v_cvt_pk_bf16_f32 v56, v52, v53
    ds_write_b32 v72, v56
    s_waitcnt vmcnt(2)
    v_lshlrev_b32 v12, 16, v0
    v_and_b32 v13, 0xffff0000, v0
    v_lshlrev_b32 v14, 16, v1
    v_and_b32 v15, 0xffff0000, v1
    v_lshlrev_b32 v16, 16, v2
    v_and_b32 v17, 0xffff0000, v2
    v_lshlrev_b32 v18, 16, v3
    v_and_b32 v19, 0xffff0000, v3
    v_lshlrev_b32 v20, 16, v4
    v_and_b32 v21, 0xffff0000, v4
    s_waitcnt lgkmcnt(0)
    s_barrier
    ds_read_b128 a[160:163], v74 offset:1152
    ds_read_b128 a[168:171], v74
    v_mov_b32 v60, 0
    v_mov_b32 v61, 0x3f803f80
    s_mul_i32 s58, s18, 2560
    s_lshr_b32 s59, s18, 2
    s_lshl_b32 s59, s59, 6
    s_add_u32 s58, s58, s59
    s_add_u32 s58, s58, 110592
    v_lshl_add_u32 v62, v79, 5, s58
    v_lshl_add_u32 v63, v79, 3, s58
    v_dot2c_f32_bf16 v60, v6, v61
    v_dot2c_f32_bf16 v60, v7, v61
    v_dot2c_f32_bf16 v60, v8, v61
    v_dot2c_f32_bf16 v60, v9, v61
    v_dot2c_f32_bf16 v60, v10, v61
    s_waitcnt lgkmcnt(1)
    v_smfmac_f32_16x16x64_bf16 v[32:35], a[160:163], a[0:7], v69
    v_smfmac_f32_16x16x64_bf16 v[36:39], a[160:163], a[40:47], v69
    v_smfmac_f32_16x16x64_bf16 v[40:43], a[160:163], a[48:55], v69
    v_smfmac_f32_16x16x64_bf16 v[44:47], a[160:163], a[8:15], v69
    s_waitcnt lgkmcnt(0)
    v_smfmac_f32_16x16x64_bf16 v[32:35], a[168:171], a[120:127], v69
    v_smfmac_f32_16x16x64_bf16 v[36:39], a[168:171], a[128:135], v69
    v_smfmac_f32_16x16x64_bf16 v[40:43], a[168:171], a[136:143], v69
    s_waitcnt vmcnt(0)
    v_smfmac_f32_16x16x64_bf16 v[44:47], a[168:171], a[144:151], v69
    s_nop 5
    v_permlane32_swap_b32 v32, v36
    v_permlane32_swap_b32 v33, v37
    v_permlane32_swap_b32 v34, v38
    v_permlane32_swap_b32 v35, v39
    v_add_f32 v32, v32, v36
    v_add_f32 v33, v33, v37
    v_add_f32 v34, v34, v38
    v_add_f32 v35, v35, v39
    ds_write2st64_b32 v23, v32, v33 offset0:0 offset1:10
    ds_write2st64_b32 v23, v34, v35 offset0:20 offset1:30
    v_permlane32_swap_b32 v40, v44
    v_permlane32_swap_b32 v41, v45
    v_permlane32_swap_b32 v42, v46
    v_permlane32_swap_b32 v43, v47
    v_add_f32 v40, v40, v44
    v_add_f32 v41, v41, v45
    v_add_f32 v42, v42, v46
    v_add_f32 v43, v43, v47
    ds_write2st64_b32 v24, v40, v41 offset0:0 offset1:10
    ds_write2st64_b32 v24, v42, v43 offset0:20 offset1:30
    s_branch L_tail
L_k2_exit:
    s_endpgm
.section .rodata,"a"
.p2align 6
.amdhsa_kernel sequential_preLN__grouped_kv_mqa__moe_arch_mod__prompt_kernel
  .amdhsa_next_free_vgpr 256
  .amdhsa_next_free_sgpr 100
  .amdhsa_accum_offset 84
  .amdhsa_group_segment_fixed_size 0
  .amdhsa_kernarg_size 104
  .amdhsa_user_sgpr_count 2
  .amdhsa_user_sgpr_kernarg_segment_ptr 1
  .amdhsa_system_sgpr_workgroup_id_x 1
  .amdhsa_float_denorm_mode_32 3
.end_amdhsa_kernel
```
